```python
import torch

def _softmax(x, axis=-1):
    return torch.softmax(x, dim=axis)
def _gelu(x):
    return torch.nn.functional.gelu(x, approximate="tanh")
def _silu(x):
    return torch.nn.functional.silu(x)
def _sigmoid(x):
    return torch.sigmoid(x)
def _layernorm(x, axis=-1, eps=1e-5):
    m = x.mean(dim=axis, keepdim=True)
    v = x.var(dim=axis, keepdim=True, unbiased=False)
    return (x - m) / torch.sqrt(v + eps)
def _scatter_add(tgt, idx, src, axis=0):
    return tgt.clone().index_add_(axis, idx, src)
def _segment_sum(src, seg, n):
    out = torch.zeros((n,) + src.shape[1:], dtype=src.dtype)
    return out.index_add_(0, seg, src)
def _pad(x, pw):
    flat = tuple(v for pair in reversed(pw) for v in pair)
    return torch.nn.functional.pad(x, flat)

kernel_name = 'parallel_sum__softmax_full_mha__dense_activation_squared_relu__prompt'

def setup_inputs():

    _w = (lambda a: (lambda t: t.to(torch.bfloat16) if t.is_floating_point() else t)(torch.as_tensor(a)))
    def _A_setup():
        B, S, D = 1, 2048, 640
        return {
            "x": _w((lambda *s: torch.randn(*s, dtype=torch.bfloat16) * 0.05)(B, S, D)),
            "wqkv": _w((lambda *s: torch.randn(*s, dtype=torch.bfloat16) * 0.2)(D, 3 * D)),
            "wo": _w((lambda *s: torch.randn(*s, dtype=torch.bfloat16) * 0.1)(D, D)),
        }
    _A_in = _A_setup()

    def _B_setup():
        B, S, D, F = 1, 2048, 640, 1728
        return {
            "x": _w((lambda *s: torch.randn(*s, dtype=torch.bfloat16) * 0.05)(B, S, D)),
            "w1": _w((lambda *s: torch.randn(*s, dtype=torch.bfloat16) * 0.1)(D, F)),
            "b1": _w((lambda *s: torch.randn(*s, dtype=torch.bfloat16) * 0.1)(F)),
            "w2": _w((lambda *s: torch.randn(*s, dtype=torch.bfloat16) * 0.1)(F, D)),
            "b2": _w((lambda *s: torch.randn(*s, dtype=torch.bfloat16) * 0.1)(D)),
        }
    _B_in = _B_setup()

    return {
        "A_x": _A_in["x"],
        "A_wqkv": _A_in["wqkv"],
        "A_wo": _A_in["wo"],
        "B_x": _B_in["x"],
        "B_w1": _B_in["w1"],
        "B_b1": _B_in["b1"],
        "B_w2": _B_in["w2"],
        "B_b2": _B_in["b2"],
    }

def reference(A_x, A_wqkv, A_wo, B_x, B_w1, B_b1, B_w2, B_b2):
    def _A_ref(x, wqkv, wo):
        B, S, D = x.shape
        H = 32; Dh = D // H
        qkv = (lambda x, *d: x.permute(*d))((x @ wqkv).reshape(B, S, 3, H, Dh), 2, 0, 3, 1, 4)
        q, k, v = qkv[0], qkv[1], qkv[2]
        scale = Dh ** -0.5
        scores = torch.einsum("bhqd,bhkd->bhqk", q, k) * scale
        p = _softmax(scores, axis=-1)
        o = torch.einsum("bhqk,bhkd->bhqd", p, v)
        return (lambda x, *d: x.permute(*d))(o, 0, 2, 1, 3).reshape(B, S, D) @ wo

    def _B_ref(x, w1, b1, w2, b2):
        h = torch.einsum("bsd,df->bsf", x, w1) + b1
        zero = torch.zeros_like(h)
        r = torch.where(h > zero, h, zero)
        h = r * r
        out = torch.einsum("bsf,fd->bsd", h, w2) + b2
        return out

    x = A_x
    xn = _layernorm(x, axis=-1)
    return x + _A_ref(xn, A_wqkv, A_wo) + _B_ref(xn, B_w1, B_b1, B_w2, B_b2)
```

```asm
; @launch grid=(256,1,1) block=(768,1,1) lds=163840
.amdgcn_target "amdgcn-amd-amdhsa--gfx950"
.text
.p2align 12
.globl parallel_sum__softmax_full_mha__dense_activation_squared_relu__prompt_kernel
.p2align 8
.type parallel_sum__softmax_full_mha__dense_activation_squared_relu__prompt_kernel,@function
parallel_sum__softmax_full_mha__dense_activation_squared_relu__prompt_kernel:
    s_cmp_ge_u32 s2, 256
    s_cbranch_scc1 L_done
    s_load_dwordx4 s[4:7], s[0:1], 0
    s_load_dwordx2 s[8:9], s[0:1], 16
    s_load_dwordx8 s[12:19], s[0:1], 32
    s_load_dwordx2 s[20:21], s[0:1], 64
    s_load_dwordx2 s[22:23], s[0:1], 80
    v_lshrrev_b32 v1, 6, v0
    v_and_b32 v0, 63, v0
    v_readfirstlane_b32 s28, v1
    s_and_b32 s36, s2, 3
    s_lshr_b32 s30, s2, 6
    s_lshl2_add_u32 s30, s36, s30
    s_lshl_b32 s30, s30, 2
    s_bitcmp0_b32 s2, 1
    s_mov_b32 s34, 0x73cbd654
    s_cmov_b32 s34, 0xfa98e210
    s_lshr_b32 s30, s34, s30
    s_and_b32 s30, s30, 15
    s_bfe_u32 s34, s2, 0x10003
    s_lshl_b32 s34, s34, 3
    s_and_b32 s35, s30, 7
    s_cmp_eq_u32 s35, 7
    s_cselect_b32 s34, s34, 0
    s_xor_b32 s30, s30, s34
    s_bfe_u32 s35, s2, 0x30003
    s_bfe_u32 s37, s2, 0x10002
    s_lshl3_add_u32 s29, s37, s35
    s_cmp_lt_u32 s28, 4
    s_cbranch_scc1 L_x
    s_cmp_ge_u32 s28, 8
    s_cbranch_scc1 L_helper
    s_setprio 3
    s_and_b32 s40, s28, 3
    s_lshl1_add_u32 s47, s36, s35
    s_mul_i32 s47, s47, 5
    s_lshl1_add_u32 s47, s37, s47
    s_lshr_b32 s47, s47, 2
    s_cmp_ge_u32 s47, 10
    s_cselect_b32 s34, 10, 0
    s_sub_u32 s47, s47, s34
    v_lshrrev_b32 v1, 3, v0
    v_lshrrev_b32 v2, 4, v0
    v_and_b32 v3, 7, v0
    v_xor_b32 v3, v3, v2
    s_lshr_b32 s34, s40, 1
    s_lshl1_add_u32 s34, s29, s34
    s_lshl_b32 s34, s34, 6
    s_and_b32 s35, s40, 1
    s_add_u32 s34, s34, s35
    s_mul_i32 s41, s34, 10
    s_add_u32 s41, s41, s47
    s_lshl_b32 s41, s41, 7
    s_lshl_b32 s35, s35, 2
    v_xor_b32 v3, s35, v3
    v_mul_u32_u24 v5, 0xa0, v1
    v_xor_b32 v4, 4, v3
    v_add_lshl_u32 v8, v5, v3, 4
    v_add_lshl_u32 v4, v5, v4, 4
    v_add_u32 v9, 19456, v4
    v_add_u32 v10, 38912, v8
    v_add_u32 v11, 58368, v4
    s_cmp_lt_u32 s30, 15
    s_cselect_b32 s50, 2621440, 0
    s_cselect_b32 s45, s30, s29
    s_mov_b32 s51, 0x00020000
    s_lshl_b32 s44, s40, 12
    s_waitcnt lgkmcnt(0)
    s_mov_b32 s48, s4
    s_mov_b32 s49, s5
    s_add_u32 m0, s44, 81920
    s_mov_b32 s34, s41
    buffer_load_dwordx4 v8, s[48:51], s34 offen offset:0 lds
    buffer_load_dwordx4 v9, s[48:51], s34 offen offset:1024 lds
    buffer_load_dwordx4 v10, s[48:51], s34 offen offset:2048 lds
    buffer_load_dwordx4 v11, s[48:51], s34 offen offset:3072 lds
    v_and_b32 v6, 15, v0
    v_lshlrev_b32 v7, 2, v2
    v_xor_b32 v6, v6, v7
    v_mul_u32_u24 v7, 0xf0, v2
    v_add_lshl_u32 v12, v7, v6, 4
    v_add_u32 v13, 14336, v12
    v_add_u32 v14, 28672, v12
    v_add_u32 v15, 43008, v12
    s_lshl2_add_u32 s35, s47, s40
    s_mul_i32 s42, s35, 61440
    s_lshl_b32 s36, s45, 8
    s_add_u32 s42, s42, s36
    s_cmp_lt_u32 s45, 15
    s_cselect_b32 s54, 2457600, 0
    s_mov_b32 s52, s6
    s_mov_b32 s53, s7
    s_mov_b32 s55, 0x00020000
L_p0:
    s_add_u32 m0, s44, 0
    s_mov_b32 s34, s42
    buffer_load_dwordx4 v12, s[52:55], s34 offen offset:0 lds
    buffer_load_dwordx4 v13, s[52:55], s34 offen offset:1024 lds
    buffer_load_dwordx4 v14, s[52:55], s34 offen offset:2048 lds
    buffer_load_dwordx4 v15, s[52:55], s34 offen offset:3072 lds
    s_add_u32 m0, s44, 98304
    s_cmp_ge_u32 s47, 9
    s_cselect_b32 s34, 1280, 0
    s_sub_u32 s34, s41, s34
    s_add_u32 s34, s34, 128
    buffer_load_dwordx4 v8, s[48:51], s34 offen offset:0 lds
    buffer_load_dwordx4 v9, s[48:51], s34 offen offset:1024 lds
    buffer_load_dwordx4 v10, s[48:51], s34 offen offset:2048 lds
    buffer_load_dwordx4 v11, s[48:51], s34 offen offset:3072 lds
    s_add_u32 m0, s44, 16384
    s_cmp_ge_u32 s47, 9
    s_cselect_b32 s34, 2457600, 0
    s_sub_u32 s34, s42, s34
    s_add_u32 s34, s34, 245760
    buffer_load_dwordx4 v12, s[52:55], s34 offen offset:0 lds
    buffer_load_dwordx4 v13, s[52:55], s34 offen offset:1024 lds
    buffer_load_dwordx4 v14, s[52:55], s34 offen offset:2048 lds
    buffer_load_dwordx4 v15, s[52:55], s34 offen offset:3072 lds
    s_setprio 0
    s_waitcnt lgkmcnt(0)
    s_mov_b32 s24, s22
    s_mov_b32 s25, s23
    s_mov_b32 s26, 18092032
    s_mov_b32 s27, 0x00020000
    s_and_b32 s31, s2, 7
    s_bfe_u32 s32, s2, 0x20003
    s_lshl2_add_u32 s31, s31, s32
    s_lshr_b32 s32, s2, 5
    s_mul_i32 s46, s35, 55296
    s_add_u32 s46, s46, s36
    v_mul_u32_u24 v7, 0xd8, v2
    v_add_lshl_u32 v16, v7, v6, 4
    v_add_u32 v17, 12800, v16
    v_add_u32 v18, 25600, v16
    v_add_u32 v19, 38400, v16
    s_cmp_lt_u32 s45, 14
    s_cselect_b32 s58, 2211840, 0
    s_mov_b32 s56, s12
    s_mov_b32 s57, s13
    s_mov_b32 s59, 0x00020000
    s_cmp_eq_u32 s30, 15
    s_cbranch_scc1 L_z_sum
    s_waitcnt vmcnt(8)
    s_barrier
    s_add_u32 m0, s44, 114688
    s_cmp_ge_u32 s47, 8
    s_cselect_b32 s34, 1280, 0
    s_sub_u32 s34, s41, s34
    s_add_u32 s34, s34, 256
    buffer_load_dwordx4 v8, s[48:51], s34 offen offset:0 lds
    buffer_load_dwordx4 v9, s[48:51], s34 offen offset:1024 lds
    buffer_load_dwordx4 v10, s[48:51], s34 offen offset:2048 lds
    buffer_load_dwordx4 v11, s[48:51], s34 offen offset:3072 lds
    s_add_u32 m0, s44, 32768
    s_cmp_ge_u32 s47, 8
    s_cselect_b32 s34, 2457600, 0
    s_sub_u32 s34, s42, s34
    s_add_u32 s34, s34, 491520
    buffer_load_dwordx4 v12, s[52:55], s34 offen offset:0 lds
    buffer_load_dwordx4 v13, s[52:55], s34 offen offset:1024 lds
    buffer_load_dwordx4 v14, s[52:55], s34 offen offset:2048 lds
    buffer_load_dwordx4 v15, s[52:55], s34 offen offset:3072 lds
    s_waitcnt vmcnt(8)
    s_barrier
    s_add_u32 m0, s44, 131072
    s_cmp_ge_u32 s47, 7
    s_cselect_b32 s34, 1280, 0
    s_sub_u32 s34, s41, s34
    s_add_u32 s34, s34, 384
    buffer_load_dwordx4 v8, s[48:51], s34 offen offset:0 lds
    buffer_load_dwordx4 v9, s[48:51], s34 offen offset:1024 lds
    buffer_load_dwordx4 v10, s[48:51], s34 offen offset:2048 lds
    buffer_load_dwordx4 v11, s[48:51], s34 offen offset:3072 lds
    s_add_u32 m0, s44, 49152
    s_cmp_ge_u32 s47, 7
    s_cselect_b32 s34, 2457600, 0
    s_sub_u32 s34, s42, s34
    s_add_u32 s34, s34, 737280
    buffer_load_dwordx4 v12, s[52:55], s34 offen offset:0 lds
    buffer_load_dwordx4 v13, s[52:55], s34 offen offset:1024 lds
    buffer_load_dwordx4 v14, s[52:55], s34 offen offset:2048 lds
    buffer_load_dwordx4 v15, s[52:55], s34 offen offset:3072 lds
    s_waitcnt vmcnt(8)
    s_barrier
    s_add_u32 m0, s44, 65536
    s_cmp_ge_u32 s47, 6
    s_cselect_b32 s34, 1280, 0
    s_sub_u32 s34, s41, s34
    s_add_u32 s34, s34, 512
    buffer_load_dwordx4 v8, s[48:51], s34 offen offset:0 lds
    buffer_load_dwordx4 v9, s[48:51], s34 offen offset:1024 lds
    buffer_load_dwordx4 v10, s[48:51], s34 offen offset:2048 lds
    buffer_load_dwordx4 v11, s[48:51], s34 offen offset:3072 lds
    s_add_u32 m0, s44, 0
    s_cmp_ge_u32 s47, 6
    s_cselect_b32 s34, 2457600, 0
    s_sub_u32 s34, s42, s34
    s_add_u32 s34, s34, 983040
    buffer_load_dwordx4 v12, s[52:55], s34 offen offset:0 lds
    buffer_load_dwordx4 v13, s[52:55], s34 offen offset:1024 lds
    buffer_load_dwordx4 v14, s[52:55], s34 offen offset:2048 lds
    buffer_load_dwordx4 v15, s[52:55], s34 offen offset:3072 lds
    s_waitcnt vmcnt(8)
    s_barrier
    s_add_u32 m0, s44, 16384
    s_cmp_ge_u32 s47, 8
    s_cselect_b32 s34, 2211840, 0
    s_sub_u32 s34, s46, s34
    s_add_u32 s34, s34, 442368
    buffer_load_dwordx4 v16, s[56:59], s34 offen offset:0 lds
    buffer_load_dwordx4 v17, s[56:59], s34 offen offset:1024 lds
    buffer_load_dwordx4 v18, s[56:59], s34 offen offset:2048 lds
    buffer_load_dwordx4 v19, s[56:59], s34 offen offset:3072 lds
    s_add_u32 m0, s44, 32768
    s_cmp_ge_u32 s47, 7
    s_cselect_b32 s34, 2211840, 0
    s_sub_u32 s34, s46, s34
    s_add_u32 s34, s34, 663552
    buffer_load_dwordx4 v16, s[56:59], s34 offen offset:0 lds
    buffer_load_dwordx4 v17, s[56:59], s34 offen offset:1024 lds
    buffer_load_dwordx4 v18, s[56:59], s34 offen offset:2048 lds
    s_waitcnt vmcnt(7)
    s_barrier
    s_add_u32 m0, s44, 32768
    s_cmp_ge_u32 s47, 7
    s_cselect_b32 s34, 2211840, 0
    s_sub_u32 s34, s46, s34
    s_add_u32 s34, s34, 663552
    buffer_load_dwordx4 v19, s[56:59], s34 offen offset:3072 lds
    s_add_u32 m0, s44, 49152
    s_cmp_ge_u32 s47, 6
    s_cselect_b32 s34, 2211840, 0
    s_sub_u32 s34, s46, s34
    s_add_u32 s34, s34, 884736
    buffer_load_dwordx4 v16, s[56:59], s34 offen offset:0 lds
    buffer_load_dwordx4 v17, s[56:59], s34 offen offset:1024 lds
    buffer_load_dwordx4 v18, s[56:59], s34 offen offset:2048 lds
    buffer_load_dwordx4 v19, s[56:59], s34 offen offset:3072 lds
    s_add_u32 m0, s44, 81920
    s_cmp_ge_u32 s47, 5
    s_cselect_b32 s34, 1280, 0
    s_sub_u32 s34, s41, s34
    s_add_u32 s34, s34, 640
    buffer_load_dwordx4 v8, s[48:51], s34 offen offset:0 lds
    buffer_load_dwordx4 v9, s[48:51], s34 offen offset:1024 lds
    s_waitcnt vmcnt(10)
    s_barrier
    s_add_u32 m0, s44, 81920
    s_cmp_ge_u32 s47, 5
    s_cselect_b32 s34, 1280, 0
    s_sub_u32 s34, s41, s34
    s_add_u32 s34, s34, 640
    buffer_load_dwordx4 v10, s[48:51], s34 offen offset:2048 lds
    buffer_load_dwordx4 v11, s[48:51], s34 offen offset:3072 lds
    s_add_u32 m0, s44, 0
    s_cmp_ge_u32 s47, 5
    s_cselect_b32 s34, 2457600, 0
    s_sub_u32 s34, s42, s34
    s_add_u32 s34, s34, 1228800
    buffer_load_dwordx4 v12, s[52:55], s34 offen offset:0 lds
    buffer_load_dwordx4 v13, s[52:55], s34 offen offset:1024 lds
    buffer_load_dwordx4 v14, s[52:55], s34 offen offset:2048 lds
    buffer_load_dwordx4 v15, s[52:55], s34 offen offset:3072 lds
    s_add_u32 m0, s44, 98304
    s_cmp_ge_u32 s47, 4
    s_cselect_b32 s34, 1280, 0
    s_sub_u32 s34, s41, s34
    s_add_u32 s34, s34, 768
    buffer_load_dwordx4 v8, s[48:51], s34 offen offset:0 lds
    s_waitcnt vmcnt(13)
    s_barrier
    s_add_u32 m0, s44, 98304
    s_cmp_ge_u32 s47, 4
    s_cselect_b32 s34, 1280, 0
    s_sub_u32 s34, s41, s34
    s_add_u32 s34, s34, 768
    buffer_load_dwordx4 v9, s[48:51], s34 offen offset:1024 lds
    buffer_load_dwordx4 v10, s[48:51], s34 offen offset:2048 lds
    buffer_load_dwordx4 v11, s[48:51], s34 offen offset:3072 lds
    s_add_u32 m0, s44, 16384
    s_cmp_ge_u32 s47, 4
    s_cselect_b32 s34, 2457600, 0
    s_sub_u32 s34, s42, s34
    s_add_u32 s34, s34, 1474560
    buffer_load_dwordx4 v12, s[52:55], s34 offen offset:0 lds
    buffer_load_dwordx4 v13, s[52:55], s34 offen offset:1024 lds
    buffer_load_dwordx4 v14, s[52:55], s34 offen offset:2048 lds
    buffer_load_dwordx4 v15, s[52:55], s34 offen offset:3072 lds
    s_waitcnt vmcnt(16)
    s_barrier
    s_add_u32 m0, s44, 114688
    s_cmp_ge_u32 s47, 3
    s_cselect_b32 s34, 1280, 0
    s_sub_u32 s34, s41, s34
    s_add_u32 s34, s34, 896
    buffer_load_dwordx4 v8, s[48:51], s34 offen offset:0 lds
    buffer_load_dwordx4 v9, s[48:51], s34 offen offset:1024 lds
    buffer_load_dwordx4 v10, s[48:51], s34 offen offset:2048 lds
    buffer_load_dwordx4 v11, s[48:51], s34 offen offset:3072 lds
    s_add_u32 m0, s44, 32768
    s_cmp_ge_u32 s47, 3
    s_cselect_b32 s34, 2457600, 0
    s_sub_u32 s34, s42, s34
    s_add_u32 s34, s34, 1720320
    buffer_load_dwordx4 v12, s[52:55], s34 offen offset:0 lds
    buffer_load_dwordx4 v13, s[52:55], s34 offen offset:1024 lds
    buffer_load_dwordx4 v14, s[52:55], s34 offen offset:2048 lds
    s_waitcnt vmcnt(15)
    s_barrier
    s_add_u32 m0, s44, 32768
    s_cmp_ge_u32 s47, 3
    s_cselect_b32 s34, 2457600, 0
    s_sub_u32 s34, s42, s34
    s_add_u32 s34, s34, 1720320
    buffer_load_dwordx4 v15, s[52:55], s34 offen offset:3072 lds
    s_add_u32 m0, s44, 131072
    s_cmp_ge_u32 s47, 2
    s_cselect_b32 s34, 1280, 0
    s_sub_u32 s34, s41, s34
    s_add_u32 s34, s34, 1024
    buffer_load_dwordx4 v8, s[48:51], s34 offen offset:0 lds
    buffer_load_dwordx4 v9, s[48:51], s34 offen offset:1024 lds
    buffer_load_dwordx4 v10, s[48:51], s34 offen offset:2048 lds
    buffer_load_dwordx4 v11, s[48:51], s34 offen offset:3072 lds
    s_add_u32 m0, s44, 49152
    s_cmp_ge_u32 s47, 2
    s_cselect_b32 s34, 2457600, 0
    s_sub_u32 s34, s42, s34
    s_add_u32 s34, s34, 1966080
    buffer_load_dwordx4 v12, s[52:55], s34 offen offset:0 lds
    buffer_load_dwordx4 v13, s[52:55], s34 offen offset:1024 lds
    s_waitcnt vmcnt(14)
    s_barrier
    s_add_u32 m0, s44, 49152
    s_cmp_ge_u32 s47, 2
    s_cselect_b32 s34, 2457600, 0
    s_sub_u32 s34, s42, s34
    s_add_u32 s34, s34, 1966080
    buffer_load_dwordx4 v14, s[52:55], s34 offen offset:2048 lds
    buffer_load_dwordx4 v15, s[52:55], s34 offen offset:3072 lds
    s_add_u32 m0, s44, 65536
    s_cmp_ge_u32 s47, 1
    s_cselect_b32 s34, 1280, 0
    s_sub_u32 s34, s41, s34
    s_add_u32 s34, s34, 1152
    buffer_load_dwordx4 v8, s[48:51], s34 offen offset:0 lds
    buffer_load_dwordx4 v9, s[48:51], s34 offen offset:1024 lds
    buffer_load_dwordx4 v10, s[48:51], s34 offen offset:2048 lds
    buffer_load_dwordx4 v11, s[48:51], s34 offen offset:3072 lds
    s_add_u32 m0, s44, 0
    s_cmp_ge_u32 s47, 1
    s_cselect_b32 s34, 2457600, 0
    s_sub_u32 s34, s42, s34
    s_add_u32 s34, s34, 2211840
    buffer_load_dwordx4 v12, s[52:55], s34 offen offset:0 lds
    s_waitcnt vmcnt(13)
    s_barrier
    s_add_u32 m0, s44, 0
    s_cmp_ge_u32 s47, 1
    s_cselect_b32 s34, 2457600, 0
    s_sub_u32 s34, s42, s34
    s_add_u32 s34, s34, 2211840
    buffer_load_dwordx4 v13, s[52:55], s34 offen offset:1024 lds
    buffer_load_dwordx4 v14, s[52:55], s34 offen offset:2048 lds
    buffer_load_dwordx4 v15, s[52:55], s34 offen offset:3072 lds
    s_add_u32 m0, s44, 16384
    s_cmp_ge_u32 s47, 5
    s_cselect_b32 s34, 2211840, 0
    s_sub_u32 s34, s46, s34
    s_add_u32 s34, s34, 1105920
    buffer_load_dwordx4 v16, s[56:59], s34 offen offset:0 lds
    buffer_load_dwordx4 v17, s[56:59], s34 offen offset:1024 lds
    buffer_load_dwordx4 v18, s[56:59], s34 offen offset:2048 lds
    buffer_load_dwordx4 v19, s[56:59], s34 offen offset:3072 lds
    s_waitcnt vmcnt(12)
    s_barrier
    s_add_u32 m0, s44, 32768
    s_cmp_ge_u32 s47, 4
    s_cselect_b32 s34, 2211840, 0
    s_sub_u32 s34, s46, s34
    s_add_u32 s34, s34, 1327104
    buffer_load_dwordx4 v16, s[56:59], s34 offen offset:0 lds
    buffer_load_dwordx4 v17, s[56:59], s34 offen offset:1024 lds
    buffer_load_dwordx4 v18, s[56:59], s34 offen offset:2048 lds
    buffer_load_dwordx4 v19, s[56:59], s34 offen offset:3072 lds
    s_waitcnt vmcnt(8)
    s_barrier
    s_add_u32 m0, s44, 49152
    s_cmp_ge_u32 s47, 3
    s_cselect_b32 s34, 2211840, 0
    s_sub_u32 s34, s46, s34
    s_add_u32 s34, s34, 1548288
    buffer_load_dwordx4 v16, s[56:59], s34 offen offset:0 lds
    buffer_load_dwordx4 v17, s[56:59], s34 offen offset:1024 lds
    buffer_load_dwordx4 v18, s[56:59], s34 offen offset:2048 lds
    buffer_load_dwordx4 v19, s[56:59], s34 offen offset:3072 lds
    s_waitcnt vmcnt(0)
    s_barrier
    s_add_u32 m0, s44, 0
    s_cmp_ge_u32 s47, 2
    s_cselect_b32 s34, 2211840, 0
    s_sub_u32 s34, s46, s34
    s_add_u32 s34, s34, 1769472
    buffer_load_dwordx4 v16, s[56:59], s34 offen offset:0 lds
    buffer_load_dwordx4 v17, s[56:59], s34 offen offset:1024 lds
    buffer_load_dwordx4 v18, s[56:59], s34 offen offset:2048 lds
    buffer_load_dwordx4 v19, s[56:59], s34 offen offset:3072 lds
    s_waitcnt vmcnt(0)
    s_barrier
    s_add_u32 m0, s44, 16384
    s_cmp_ge_u32 s47, 1
    s_cselect_b32 s34, 2211840, 0
    s_sub_u32 s34, s46, s34
    s_add_u32 s34, s34, 1990656
    buffer_load_dwordx4 v16, s[56:59], s34 offen offset:0 lds
    buffer_load_dwordx4 v17, s[56:59], s34 offen offset:1024 lds
    buffer_load_dwordx4 v18, s[56:59], s34 offen offset:2048 lds
    buffer_load_dwordx4 v19, s[56:59], s34 offen offset:3072 lds
    s_cmp_lt_u32 s30, 14
    s_cselect_b32 s50, 2621440, 0
    s_add_u32 m0, s44, 81920
    s_mov_b32 s34, s41
    buffer_load_dwordx4 v8, s[48:51], s34 offen offset:0 lds
    buffer_load_dwordx4 v9, s[48:51], s34 offen offset:1024 lds
    buffer_load_dwordx4 v10, s[48:51], s34 offen offset:2048 lds
    buffer_load_dwordx4 v11, s[48:51], s34 offen offset:3072 lds
    s_waitcnt vmcnt(4)
    s_barrier
    s_add_u32 m0, s44, 32768
    s_mov_b32 s34, s46
    buffer_load_dwordx4 v16, s[56:59], s34 offen offset:0 lds
    buffer_load_dwordx4 v17, s[56:59], s34 offen offset:1024 lds
    buffer_load_dwordx4 v18, s[56:59], s34 offen offset:2048 lds
    buffer_load_dwordx4 v19, s[56:59], s34 offen offset:3072 lds
    s_add_u32 m0, s44, 98304
    s_cmp_ge_u32 s47, 9
    s_cselect_b32 s34, 1280, 0
    s_sub_u32 s34, s41, s34
    s_add_u32 s34, s34, 128
    buffer_load_dwordx4 v8, s[48:51], s34 offen offset:0 lds
    buffer_load_dwordx4 v9, s[48:51], s34 offen offset:1024 lds
    buffer_load_dwordx4 v10, s[48:51], s34 offen offset:2048 lds
    buffer_load_dwordx4 v11, s[48:51], s34 offen offset:3072 lds
    s_add_u32 m0, s44, 49152
    s_cmp_ge_u32 s47, 9
    s_cselect_b32 s34, 2211840, 0
    s_sub_u32 s34, s46, s34
    s_add_u32 s34, s34, 221184
    buffer_load_dwordx4 v16, s[56:59], s34 offen offset:0 lds
    buffer_load_dwordx4 v17, s[56:59], s34 offen offset:1024 lds
    buffer_load_dwordx4 v18, s[56:59], s34 offen offset:2048 lds
    buffer_load_dwordx4 v19, s[56:59], s34 offen offset:3072 lds
    s_waitcnt vmcnt(8)
    s_barrier
    s_branch L_attn_z
L_x:
    s_getpc_b64 s[40:41]
L_pc:
    s_lshr_b32 s42, s2, 3
    s_lshl2_add_u32 s42, s42, s28
    s_lshl_b32 s42, s42, 9
    s_sub_u32 s40, s40, L_pc-L_p0
    s_subb_u32 s41, s41, 0
    s_mov_b32 s43, L_done-L_p0
    v_lshlrev_b32 v2, 7, v0
    v_add_u32 v2, s42, v2
    v_min_u32 v2, s43, v2
    v_mov_b32 v3, s41
    v_add_co_u32 v2, vcc, s40, v2
    s_mov_b64 exec, 15
    s_nop 0
    v_addc_co_u32 v3, vcc, 0, v3, vcc
    global_load_dword v167, v[2:3], off
    s_mov_b64 exec, -1
    s_and_b32 s31, s2, 7
    s_bfe_u32 s32, s2, 0x20003
    s_lshl2_add_u32 s31, s31, s32
    s_lshr_b32 s32, s2, 5
    s_sub_u32 s41, s28, 0
    s_and_b32 s40, s41, 1
    s_lshr_b32 s41, s41, 1
    v_lshrrev_b32 v2, 5, v0
    v_and_b32 v3, 31, v0
    v_mov_b32 v106, v3
    s_cmp_lt_u32 s30, 10
    s_cbranch_scc1 L_x_rows
    v_and_b32 v1, 1, v0
    v_lshrrev_b32 v106, 1, v3
    v_lshl_add_u32 v106, v1, 5, v106
L_x_rows:
    v_bfe_u32 v1, v106, 1, 3
    v_xor_b32 v1, v1, v2
    v_lshrrev_b32 v107, 5, v106
    v_lshlrev_b32 v107, 2, v107
    v_xor_b32 v1, v1, v107
    s_lshl_b32 s34, s40, 13
    s_add_u32 s34, s34, 81920
    v_lshlrev_b32 v106, 7, v106
    v_add_u32 v106, s34, v106
    v_xor_b32 v107, 0, v1
    v_lshl_add_u32 v4, v107, 4, v106
    v_xor_b32 v107, 2, v1
    v_lshl_add_u32 v5, v107, 4, v106
    v_xor_b32 v107, 4, v1
    v_lshl_add_u32 v6, v107, 4, v106
    v_xor_b32 v107, 6, v1
    v_lshl_add_u32 v7, v107, 4, v106
    v_lshrrev_b32 v1, 2, v0
    v_and_b32 v1, 3, v1
    v_lshl_add_u32 v106, v2, 3, v1
    v_lshlrev_b32 v106, 8, v106
    v_and_b32 v107, 3, v0
    v_lshl_add_u32 v106, v107, 3, v106
    v_and_b32 v107, 16, v0
    v_lshl_add_u32 v106, v107, 1, v106
    v_add_u32 v106, 0, v106
    s_lshl_b32 s34, s41, 1
    s_add_u32 s34, s34, s40
    v_xor_b32 v1, s34, v1
    s_lshl_b32 s34, s34, 8
    v_lshl_add_u32 v120, v3, 3, s34
    v_xor_b32 v121, 256, v120
    s_lshl_b32 s58, s30, 10
    s_add_u32 s58, s58, 17596416
    s_mov_b32 s59, -1
    v_lshl_add_u32 v8, v1, 6, v106
    v_xor_b32 v1, 1, v1
    v_lshl_add_u32 v9, v1, 6, v106
    s_mov_b32 s44, 1
    s_mov_b32 s45, 0
    s_mov_b32 s55, 5
    s_mov_b32 s69, 0
    s_waitcnt lgkmcnt(0)
    s_mov_b32 s24, s22
    s_mov_b32 s25, s23
    s_mov_b32 s26, 18092032
    s_mov_b32 s27, 0x00020000
    v_mov_b64 v[42:43], 0
    v_mov_b64 v[44:45], 0
    v_mov_b64 v[46:47], 0
    v_mov_b64 v[48:49], 0
    v_mov_b64 v[50:51], 0
    v_mov_b64 v[52:53], 0
    v_mov_b64 v[54:55], 0
    v_mov_b64 v[56:57], 0
    v_mov_b64 v[58:59], 0
    v_mov_b64 v[60:61], 0
    v_mov_b64 v[62:63], 0
    v_mov_b64 v[64:65], 0
    v_mov_b64 v[66:67], 0
    v_mov_b64 v[68:69], 0
    v_mov_b64 v[70:71], 0
    v_mov_b64 v[72:73], 0
    v_mov_b64 v[74:75], 0
    v_mov_b64 v[76:77], 0
    v_mov_b64 v[78:79], 0
    v_mov_b64 v[80:81], 0
    v_mov_b64 v[82:83], 0
    v_mov_b64 v[84:85], 0
    v_mov_b64 v[86:87], 0
    v_mov_b64 v[88:89], 0
    v_mov_b64 v[90:91], 0
    v_mov_b64 v[92:93], 0
    v_mov_b64 v[94:95], 0
    v_mov_b64 v[96:97], 0
    v_mov_b64 v[98:99], 0
    v_mov_b64 v[100:101], 0
    v_mov_b64 v[102:103], 0
    v_mov_b64 v[104:105], 0
    v_mov_b64 v[158:159], 0
    v_mov_b64 v[160:161], 0
    v_mov_b32 v162, 160256
    s_cmp_ge_u32 s30, 10
    s_cbranch_scc1 L_x_v
    s_cmp_lt_u32 s30, 5
    s_mov_b32 s53, 163840
    s_cmov_b32 s53, 81920
    s_cselect_b32 s54, 0x3ea52b5c, 1.0
    s_mov_b32 s34, 10240
    s_cmov_b32 s34, 5120
    s_mov_b32 s52, 2621440
    s_cmov_b32 s52, 0
    s_cselect_b32 s35, 0, 5
    s_mul_i32 s34, s34, s29
    s_add_u32 s52, s52, s34
    s_mul_i32 s34, s40, 2560
    s_add_u32 s52, s52, s34
    s_sub_u32 s35, s30, s35
    s_lshl_b32 s35, s35, 1
    s_add_u32 s35, s35, s41
    s_lshl_b32 s35, s35, 4
    s_sub_u32 s53, s53, 2560
    s_lshl_b32 s34, s40, 3
    s_add_u32 s35, s35, s34
    v_add_u32 v1, s35, v2
    v_lshlrev_b32 v118, 4, v3
    v_lshl_add_u32 v118, v1, 9, v118
    v_mul_u32_u24 v1, 205, v1
    v_add_u32 v116, 0, v1
    v_lshrrev_b32 v116, 10, v116
    v_mad_u32_u24 v106, v116, s53, v118
    v_add_u32 v116, 410, v1
    v_lshrrev_b32 v116, 10, v116
    v_mad_u32_u24 v107, v116, s53, v118
    v_add_u32 v116, 820, v1
    v_lshrrev_b32 v116, 10, v116
    v_mad_u32_u24 v108, v116, s53, v118
    v_add_u32 v116, 1230, v1
    v_lshrrev_b32 v116, 10, v116
    v_mad_u32_u24 v109, v116, s53, v118
    s_xor_b32 s35, s35, 8
    v_add_u32 v1, s35, v2
    v_lshlrev_b32 v118, 4, v3
    v_lshl_add_u32 v118, v1, 9, v118
    v_mul_u32_u24 v1, 205, v1
    v_add_u32 v116, 0, v1
    v_lshrrev_b32 v116, 10, v116
    v_mad_u32_u24 v110, v116, s53, v118
    v_add_u32 v116, 410, v1
    v_lshrrev_b32 v116, 10, v116
    v_mad_u32_u24 v111, v116, s53, v118
    v_add_u32 v116, 820, v1
    v_lshrrev_b32 v116, 10, v116
    v_mad_u32_u24 v112, v116, s53, v118
    v_add_u32 v116, 1230, v1
    v_lshrrev_b32 v116, 10, v116
    v_mad_u32_u24 v113, v116, s53, v118
    s_lshl_b32 s36, s40, 8
    s_add_u32 s36, s36, 158720
    v_lshl_add_u32 v119, v3, 3, s36
    v_lshl_add_u32 v114, v2, 9, v119
    s_setprio 1
L_ent_qk:
    s_barrier
    ds_read_b128 v[10:13], v4
    ds_read_b64_tr_b16 v[18:19], v8 offset:0
    ds_read_b64_tr_b16 v[20:21], v8 offset:1024
    ds_read_b64_tr_b16 v[22:23], v9 offset:0
    ds_read_b64_tr_b16 v[24:25], v9 offset:1024
    ds_read_b128 v[14:17], v6 offset:4096
L_loop_qk:
    s_waitcnt lgkmcnt(3)
    v_mfma_f32_32x32x16_bf16 v[42:57], v[18:21], v[10:13], v[42:57]
    ds_read_b128 v[26:29], v5
    ds_read_b64_tr_b16 v[34:35], v8 offset:4096
    ds_read_b64_tr_b16 v[36:37], v8 offset:5120
    s_waitcnt lgkmcnt(4)
    v_mfma_f32_32x32x16_bf16 v[58:73], v[22:25], v[10:13], v[58:73]
    ds_read_b64_tr_b16 v[38:39], v9 offset:4096
    ds_read_b64_tr_b16 v[40:41], v9 offset:5120
    ds_read_b128 v[30:33], v7 offset:4096
    s_waitcnt lgkmcnt(6)
    v_mfma_f32_32x32x16_bf16 v[90:105], v[22:25], v[14:17], v[90:105]
    s_add_u32 s44, s44, 1
    s_cmp_eq_u32 s44, 5
    s_mov_b32 s42, 16384
    s_cmov_b32 s42, -65536
    s_cselect_b32 s44, 0, s44
    v_mfma_f32_32x32x16_bf16 v[74:89], v[18:21], v[14:17], v[74:89]
    s_cmp_eq_u32 s55, s59
    s_cbranch_scc1 L_ld_qk
L_ldx_qk:
    s_waitcnt lgkmcnt(3)
    v_mfma_f32_32x32x16_bf16 v[42:57], v[34:37], v[26:29], v[42:57]
    ds_read_b128 v[10:13], v6
    ds_read_b64_tr_b16 v[18:19], v8 offset:8192
    ds_read_b64_tr_b16 v[20:21], v8 offset:9216
    s_waitcnt lgkmcnt(4)
    v_mfma_f32_32x32x16_bf16 v[58:73], v[38:41], v[26:29], v[58:73]
    ds_read_b64_tr_b16 v[22:23], v9 offset:8192
    ds_read_b64_tr_b16 v[24:25], v9 offset:9216
    ds_read_b128 v[14:17], v4 offset:4096
    s_waitcnt lgkmcnt(6)
    v_mfma_f32_32x32x16_bf16 v[90:105], v[38:41], v[30:33], v[90:105]
    s_add_u32 s45, s45, 1
    s_cmp_eq_u32 s45, 4
    s_mov_b32 s43, 16384
    s_cmov_b32 s43, -49152
    s_cselect_b32 s45, 0, s45
    v_mfma_f32_32x32x16_bf16 v[74:89], v[34:37], v[30:33], v[74:89]
    s_waitcnt lgkmcnt(3)
    v_mfma_f32_32x32x16_bf16 v[42:57], v[18:21], v[10:13], v[42:57]
    ds_read_b128 v[26:29], v7
    ds_read_b64_tr_b16 v[34:35], v8 offset:12288
    ds_read_b64_tr_b16 v[36:37], v8 offset:13312
    s_waitcnt lgkmcnt(4)
    v_mfma_f32_32x32x16_bf16 v[58:73], v[22:25], v[10:13], v[58:73]
    ds_read_b64_tr_b16 v[38:39], v9 offset:12288
    ds_read_b64_tr_b16 v[40:41], v9 offset:13312
    ds_read_b128 v[30:33], v5 offset:4096
    s_waitcnt lgkmcnt(6)
    v_mfma_f32_32x32x16_bf16 v[90:105], v[22:25], v[14:17], v[90:105]
    v_add_u32 v4, s42, v4
    v_add_u32 v8, s43, v8
    v_add_u32 v9, s43, v9
    v_mfma_f32_32x32x16_bf16 v[74:89], v[18:21], v[14:17], v[74:89]
    s_sub_u32 s55, s55, 1
    v_add_u32 v5, s42, v5
    v_add_u32 v6, s42, v6
    v_add_u32 v7, s42, v7
    s_cmp_eq_u32 s55, 0
    s_waitcnt lgkmcnt(0)
    s_cbranch_scc1 L_last_qk
    s_barrier
L_nob_qk:
    v_mfma_f32_32x32x16_bf16 v[42:57], v[34:37], v[26:29], v[42:57]
    ds_read_b128 v[10:13], v4
    ds_read_b64_tr_b16 v[18:19], v8 offset:0
    ds_read_b64_tr_b16 v[20:21], v8 offset:1024
    v_mfma_f32_32x32x16_bf16 v[58:73], v[38:41], v[26:29], v[58:73]
    ds_read_b64_tr_b16 v[22:23], v9 offset:0
    ds_read_b64_tr_b16 v[24:25], v9 offset:1024
    ds_read_b128 v[14:17], v6 offset:4096
    v_mfma_f32_32x32x16_bf16 v[90:105], v[38:41], v[30:33], v[90:105]
    v_mfma_f32_32x32x16_bf16 v[74:89], v[34:37], v[30:33], v[74:89]
    s_branch L_loop_qk
L_ld_qk:
    s_mov_b32 exec_hi, 0
    buffer_load_dwordx2 v[158:159], v120, s[24:27], s58 offen sc1
    buffer_load_dwordx2 v[160:161], v121, s[24:27], s58 offen sc1
    s_mov_b32 exec_hi, -1
    s_branch L_ldx_qk
L_pause_qk:
    s_barrier
    v_mfma_f32_32x32x16_bf16 v[42:57], v[34:37], v[26:29], v[42:57]
    s_mov_b32 s69, 0x80000000
    v_mfma_f32_32x32x16_bf16 v[58:73], v[38:41], v[26:29], v[58:73]
    s_mov_b32 s45, 0
    v_mfma_f32_32x32x16_bf16 v[90:105], v[38:41], v[30:33], v[90:105]
    s_mov_b32 s55, 5
    v_mfma_f32_32x32x16_bf16 v[74:89], v[34:37], v[30:33], v[74:89]
    s_mov_b32 s59, 2
    v_add_u32 v8, -16384, v8
    v_add_u32 v9, -16384, v9
    s_barrier
    s_barrier
    s_branch L_ent_qk
L_last_qk:
    s_bitcmp0_b32 s69, 31
    s_cbranch_scc1 L_pause_qk
    s_barrier
    ds_read_b32 v162, v162
    ds_read_b64 v[130:131], v114
    v_mfma_f32_32x32x16_bf16 v[42:57], v[34:37], v[26:29], v[42:57]
    ds_read_b64 v[138:139], v119 offset:1024
    v_mfma_f32_32x32x16_bf16 v[58:73], v[38:41], v[26:29], v[58:73]
    s_mov_b32 s59, 1048576
    s_waitcnt lgkmcnt(1)
    v_cvt_pk_bf16_f32 v122, v130, v130
    v_cvt_pk_bf16_f32 v124, v131, v131
    v_and_b32 v134, 0xffff0000, v122
    v_and_b32 v135, 0xffff0000, v124
    v_sub_f32 v134, v130, v134
    v_mfma_f32_32x32x16_bf16 v[90:105], v[38:41], v[30:33], v[90:105]
    v_sub_f32 v135, v131, v135
    v_cvt_pk_bf16_f32 v123, v134, v134
    v_cvt_pk_bf16_f32 v125, v135, v135
L_cs_qk:
    s_waitcnt vmcnt(0)
    v_cmp_ne_u32 vcc, v162, v159
    v_cmp_ne_u32 s[46:47], v162, v161
    s_nop 1
    s_or_b32 vcc_lo, vcc_lo, s46
    s_cbranch_scc0 L_csx_qk
    s_sub_u32 s59, s59, 1
    s_cbranch_scc1 L_csx_qk
    s_mov_b32 exec_hi, 0
    buffer_load_dwordx2 v[158:159], v120, s[24:27], s58 offen sc1
    buffer_load_dwordx2 v[160:161], v121, s[24:27], s58 offen sc1
    s_mov_b32 exec_hi, -1
    s_branch L_cs_qk
L_csx_qk:
    v_mfma_f32_32x32x16_bf16 v[74:89], v[34:37], v[30:33], v[74:89]
    v_cvt_pk_bf16_f32 v126, v158, v158
    v_cvt_pk_bf16_f32 v128, v160, v160
    v_and_b32 v136, 0xffff0000, v126
    v_and_b32 v137, 0xffff0000, v128
    v_sub_f32 v136, v158, v136
    v_sub_f32 v137, v160, v137
    v_cvt_pk_bf16_f32 v126, v158, v136
    v_cvt_pk_bf16_f32 v127, v158, v136
    v_cvt_pk_bf16_f32 v128, v160, v137
    v_cvt_pk_bf16_f32 v129, v160, v137
    s_nop 1
    v_mfma_f32_32x32x8_bf16 v[42:57], v[126:127], v[122:123], v[42:57]
    v_mfma_f32_32x32x8_bf16 v[58:73], v[128:129], v[122:123], v[58:73]
    v_mfma_f32_32x32x8_bf16 v[90:105], v[128:129], v[124:125], v[90:105]
    v_mfma_f32_32x32x8_bf16 v[74:89], v[126:127], v[124:125], v[74:89]
    s_setprio 0
    s_waitcnt lgkmcnt(0)
    v_mul_f32 v138, s54, v138
    v_mul_f32 v139, s54, v139
    s_nop 5
    v_mul_f32 v58, v138, v58
    v_mul_f32 v59, v138, v59
    v_mul_f32 v60, v138, v60
    v_mul_f32 v61, v138, v61
    v_cvt_pk_bf16_f32 v10, v58, v59
    v_cvt_pk_bf16_f32 v11, v60, v61
    v_mul_f32 v90, v139, v90
    v_mul_f32 v91, v139, v91
    v_mul_f32 v92, v139, v92
    v_mul_f32 v93, v139, v93
    v_cvt_pk_bf16_f32 v12, v90, v91
    v_cvt_pk_bf16_f32 v13, v92, v93
    buffer_store_dwordx4 v[10:13], v110, s[24:27], s52 offen offset:0 sc1
    v_mul_f32 v62, v138, v62
    v_mul_f32 v63, v138, v63
    v_mul_f32 v64, v138, v64
    v_mul_f32 v65, v138, v65
    v_cvt_pk_bf16_f32 v14, v62, v63
    v_cvt_pk_bf16_f32 v15, v64, v65
    v_mul_f32 v94, v139, v94
    v_mul_f32 v95, v139, v95
    v_mul_f32 v96, v139, v96
    v_mul_f32 v97, v139, v97
    v_cvt_pk_bf16_f32 v16, v94, v95
    v_cvt_pk_bf16_f32 v17, v96, v97
    buffer_store_dwordx4 v[14:17], v111, s[24:27], s52 offen offset:1024 sc1
    v_mul_f32 v66, v138, v66
    v_mul_f32 v67, v138, v67
    v_mul_f32 v68, v138, v68
    v_mul_f32 v69, v138, v69
    v_cvt_pk_bf16_f32 v18, v66, v67
    v_cvt_pk_bf16_f32 v19, v68, v69
    v_mul_f32 v98, v139, v98
    v_mul_f32 v99, v139, v99
    v_mul_f32 v100, v139, v100
    v_mul_f32 v101, v139, v101
    v_cvt_pk_bf16_f32 v20, v98, v99
    v_cvt_pk_bf16_f32 v21, v100, v101
    buffer_store_dwordx4 v[18:21], v112, s[24:27], s52 offen offset:2048 sc1
    v_mul_f32 v70, v138, v70
    v_mul_f32 v71, v138, v71
    v_mul_f32 v72, v138, v72
    v_mul_f32 v73, v138, v73
    v_cvt_pk_bf16_f32 v22, v70, v71
    v_cvt_pk_bf16_f32 v23, v72, v73
    v_mul_f32 v102, v139, v102
    v_mul_f32 v103, v139, v103
    v_mul_f32 v104, v139, v104
    v_mul_f32 v105, v139, v105
    v_cvt_pk_bf16_f32 v24, v102, v103
    v_cvt_pk_bf16_f32 v25, v104, v105
    buffer_store_dwordx4 v[22:25], v113, s[24:27], s52 offen offset:3072 sc1
    v_mul_f32 v42, v138, v42
    v_mul_f32 v43, v138, v43
    v_mul_f32 v44, v138, v44
    v_mul_f32 v45, v138, v45
    v_cvt_pk_bf16_f32 v26, v42, v43
    v_cvt_pk_bf16_f32 v27, v44, v45
    v_mul_f32 v74, v139, v74
    v_mul_f32 v75, v139, v75
    v_mul_f32 v76, v139, v76
    v_mul_f32 v77, v139, v77
    v_cvt_pk_bf16_f32 v28, v74, v75
    v_cvt_pk_bf16_f32 v29, v76, v77
    buffer_store_dwordx4 v[26:29], v106, s[24:27], s52 offen offset:0 sc1
    v_mul_f32 v46, v138, v46
    v_mul_f32 v47, v138, v47
    v_mul_f32 v48, v138, v48
    v_mul_f32 v49, v138, v49
    v_cvt_pk_bf16_f32 v30, v46, v47
    v_cvt_pk_bf16_f32 v31, v48, v49
    v_mul_f32 v78, v139, v78
    v_mul_f32 v79, v139, v79
    v_mul_f32 v80, v139, v80
    v_mul_f32 v81, v139, v81
    v_cvt_pk_bf16_f32 v32, v78, v79
    v_cvt_pk_bf16_f32 v33, v80, v81
    buffer_store_dwordx4 v[30:33], v107, s[24:27], s52 offen offset:1024 sc1
    v_mul_f32 v50, v138, v50
    v_mul_f32 v51, v138, v51
    v_mul_f32 v52, v138, v52
    v_mul_f32 v53, v138, v53
    v_cvt_pk_bf16_f32 v34, v50, v51
    v_cvt_pk_bf16_f32 v35, v52, v53
    v_mul_f32 v82, v139, v82
    v_mul_f32 v83, v139, v83
    v_mul_f32 v84, v139, v84
    v_mul_f32 v85, v139, v85
    v_cvt_pk_bf16_f32 v36, v82, v83
    v_cvt_pk_bf16_f32 v37, v84, v85
    buffer_store_dwordx4 v[34:37], v108, s[24:27], s52 offen offset:2048 sc1
    v_mul_f32 v54, v138, v54
    v_mul_f32 v55, v138, v55
    v_mul_f32 v56, v138, v56
    v_mul_f32 v57, v138, v57
    v_cvt_pk_bf16_f32 v38, v54, v55
    v_cvt_pk_bf16_f32 v39, v56, v57
    v_mul_f32 v86, v139, v86
    v_mul_f32 v87, v139, v87
    v_mul_f32 v88, v139, v88
    v_mul_f32 v89, v139, v89
    v_cvt_pk_bf16_f32 v40, v86, v87
    v_cvt_pk_bf16_f32 v41, v88, v89
    buffer_store_dwordx4 v[38:41], v109, s[24:27], s52 offen offset:3072 sc1
    s_branch L_x_sig
L_x_v:
    s_cmp_ge_u32 s30, 15
    s_cbranch_scc1 L_x_idle
    s_lshl_b32 s36, s40, 8
    s_add_u32 s36, s36, 158720
    s_mul_i32 s52, s29, 10240
    s_mul_i32 s34, s40, 2560
    s_add_u32 s52, s52, s34
    s_add_u32 s52, s52, 2626560
    s_sub_u32 s35, s30, 10
    s_lshl_b32 s35, s35, 7
    s_lshl_b32 s34, s41, 6
    s_add_u32 s35, s35, s34
    s_lshl_b32 s34, s40, 5
    s_add_u32 s35, s35, s34
    v_add_u32 v1, s35, v3
    v_mul_u32_u24 v118, 320, v2
    v_xor_b32 v116, 0, v1
    v_mul_u32_u24 v117, 3277, v116
    v_lshrrev_b32 v117, 16, v117
    v_mul_u32_u24 v117, 163520, v117
    v_lshl_add_u32 v117, v116, 4, v117
    v_add_u32 v106, v117, v118
    v_xor_b32 v116, 32, v1
    v_mul_u32_u24 v117, 3277, v116
    v_lshrrev_b32 v117, 16, v117
    v_mul_u32_u24 v117, 163520, v117
    v_lshl_add_u32 v117, v116, 4, v117
    v_add_u32 v107, v117, v118
    v_lshl_add_u32 v114, v3, 2, s36
    v_lshl_add_u32 v114, v2, 9, v114
    v_lshl_add_u32 v119, v2, 4, s36
    s_setprio 1
L_ent_v:
    s_barrier
    ds_read_b128 v[10:13], v4
    ds_read_b64_tr_b16 v[18:19], v8 offset:0
    ds_read_b64_tr_b16 v[20:21], v8 offset:1024
    ds_read_b64_tr_b16 v[22:23], v9 offset:0
    ds_read_b64_tr_b16 v[24:25], v9 offset:1024
    ds_read_b128 v[14:17], v4 offset:2048
L_loop_v:
    s_waitcnt lgkmcnt(3)
    v_mfma_f32_32x32x16_bf16 v[42:57], v[10:13], v[18:21], v[42:57]
    ds_read_b128 v[26:29], v5
    ds_read_b64_tr_b16 v[34:35], v8 offset:4096
    ds_read_b64_tr_b16 v[36:37], v8 offset:5120
    s_waitcnt lgkmcnt(4)
    v_mfma_f32_32x32x16_bf16 v[58:73], v[10:13], v[22:25], v[58:73]
    ds_read_b64_tr_b16 v[38:39], v9 offset:4096
    ds_read_b64_tr_b16 v[40:41], v9 offset:5120
    ds_read_b128 v[30:33], v5 offset:2048
    s_waitcnt lgkmcnt(6)
    v_mfma_f32_32x32x16_bf16 v[90:105], v[14:17], v[22:25], v[90:105]
    s_add_u32 s44, s44, 1
    s_cmp_eq_u32 s44, 5
    s_mov_b32 s42, 16384
    s_cmov_b32 s42, -65536
    s_cselect_b32 s44, 0, s44
    v_mfma_f32_32x32x16_bf16 v[74:89], v[14:17], v[18:21], v[74:89]
    s_cmp_eq_u32 s55, s59
    s_cbranch_scc1 L_ld_v
L_ldx_v:
    s_waitcnt lgkmcnt(3)
    v_mfma_f32_32x32x16_bf16 v[42:57], v[26:29], v[34:37], v[42:57]
    ds_read_b128 v[10:13], v6
    ds_read_b64_tr_b16 v[18:19], v8 offset:8192
    ds_read_b64_tr_b16 v[20:21], v8 offset:9216
    s_waitcnt lgkmcnt(4)
    v_mfma_f32_32x32x16_bf16 v[58:73], v[26:29], v[38:41], v[58:73]
    ds_read_b64_tr_b16 v[22:23], v9 offset:8192
    ds_read_b64_tr_b16 v[24:25], v9 offset:9216
    ds_read_b128 v[14:17], v6 offset:2048
    s_waitcnt lgkmcnt(6)
    v_mfma_f32_32x32x16_bf16 v[90:105], v[30:33], v[38:41], v[90:105]
    s_add_u32 s45, s45, 1
    s_cmp_eq_u32 s45, 4
    s_mov_b32 s43, 16384
    s_cmov_b32 s43, -49152
    s_cselect_b32 s45, 0, s45
    v_mfma_f32_32x32x16_bf16 v[74:89], v[30:33], v[34:37], v[74:89]
    s_waitcnt lgkmcnt(3)
    v_mfma_f32_32x32x16_bf16 v[42:57], v[10:13], v[18:21], v[42:57]
    ds_read_b128 v[26:29], v7
    ds_read_b64_tr_b16 v[34:35], v8 offset:12288
    ds_read_b64_tr_b16 v[36:37], v8 offset:13312
    s_waitcnt lgkmcnt(4)
    v_mfma_f32_32x32x16_bf16 v[58:73], v[10:13], v[22:25], v[58:73]
    ds_read_b64_tr_b16 v[38:39], v9 offset:12288
    ds_read_b64_tr_b16 v[40:41], v9 offset:13312
    ds_read_b128 v[30:33], v7 offset:2048
    s_waitcnt lgkmcnt(6)
    v_mfma_f32_32x32x16_bf16 v[90:105], v[14:17], v[22:25], v[90:105]
    v_add_u32 v4, s42, v4
    v_add_u32 v8, s43, v8
    v_add_u32 v9, s43, v9
    v_mfma_f32_32x32x16_bf16 v[74:89], v[14:17], v[18:21], v[74:89]
    s_sub_u32 s55, s55, 1
    v_add_u32 v5, s42, v5
    v_add_u32 v6, s42, v6
    v_add_u32 v7, s42, v7
    s_cmp_eq_u32 s55, 0
    s_waitcnt lgkmcnt(0)
    s_cbranch_scc1 L_last_v
    s_barrier
L_nob_v:
    v_mfma_f32_32x32x16_bf16 v[42:57], v[26:29], v[34:37], v[42:57]
    ds_read_b128 v[10:13], v4
    ds_read_b64_tr_b16 v[18:19], v8 offset:0
    ds_read_b64_tr_b16 v[20:21], v8 offset:1024
    v_mfma_f32_32x32x16_bf16 v[58:73], v[26:29], v[38:41], v[58:73]
    ds_read_b64_tr_b16 v[22:23], v9 offset:0
    ds_read_b64_tr_b16 v[24:25], v9 offset:1024
    ds_read_b128 v[14:17], v4 offset:2048
    v_mfma_f32_32x32x16_bf16 v[90:105], v[30:33], v[38:41], v[90:105]
    v_mfma_f32_32x32x16_bf16 v[74:89], v[30:33], v[34:37], v[74:89]
    s_branch L_loop_v
L_ld_v:
    s_mov_b32 exec_hi, 0
    buffer_load_dwordx2 v[158:159], v120, s[24:27], s58 offen sc1
    buffer_load_dwordx2 v[160:161], v121, s[24:27], s58 offen sc1
    s_mov_b32 exec_hi, -1
    s_branch L_ldx_v
L_pause_v:
    s_barrier
    v_mfma_f32_32x32x16_bf16 v[42:57], v[26:29], v[34:37], v[42:57]
    s_mov_b32 s69, 0x80000000
    v_mfma_f32_32x32x16_bf16 v[58:73], v[26:29], v[38:41], v[58:73]
    s_mov_b32 s45, 0
    v_mfma_f32_32x32x16_bf16 v[90:105], v[30:33], v[38:41], v[90:105]
    s_mov_b32 s55, 5
    v_mfma_f32_32x32x16_bf16 v[74:89], v[30:33], v[34:37], v[74:89]
    s_mov_b32 s59, 2
    v_add_u32 v8, -16384, v8
    v_add_u32 v9, -16384, v9
    s_barrier
    s_barrier
    s_branch L_ent_v
L_last_v:
    s_bitcmp0_b32 s69, 31
    s_cbranch_scc1 L_pause_v
    s_barrier
    ds_read_b32 v162, v162
    ds_read2_b32 v[130:131], v114 offset0:0 offset1:32
    v_mfma_f32_32x32x16_bf16 v[42:57], v[26:29], v[34:37], v[42:57]
    ds_read_b128 v[138:141], v119 offset:1024
    ds_read_b128 v[142:145], v119 offset:1056
    ds_read_b128 v[146:149], v119 offset:1088
    ds_read_b128 v[150:153], v119 offset:1120
    v_mfma_f32_32x32x16_bf16 v[58:73], v[26:29], v[38:41], v[58:73]
    s_mov_b32 s59, 1048576
    s_waitcnt lgkmcnt(4)
    v_cvt_pk_bf16_f32 v122, v130, v130
    v_cvt_pk_bf16_f32 v124, v131, v131
    v_and_b32 v134, 0xffff0000, v122
    v_and_b32 v135, 0xffff0000, v124
    v_sub_f32 v134, v130, v134
    v_mfma_f32_32x32x16_bf16 v[90:105], v[30:33], v[38:41], v[90:105]
    v_sub_f32 v135, v131, v135
    v_cvt_pk_bf16_f32 v123, v134, v134
    v_cvt_pk_bf16_f32 v125, v135, v135
L_cs_v:
    s_waitcnt vmcnt(0)
    v_cmp_ne_u32 vcc, v162, v159
    v_cmp_ne_u32 s[46:47], v162, v161
    s_nop 1
    s_or_b32 vcc_lo, vcc_lo, s46
    s_cbranch_scc0 L_csx_v
    s_sub_u32 s59, s59, 1
    s_cbranch_scc1 L_csx_v
    s_mov_b32 exec_hi, 0
    buffer_load_dwordx2 v[158:159], v120, s[24:27], s58 offen sc1
    buffer_load_dwordx2 v[160:161], v121, s[24:27], s58 offen sc1
    s_mov_b32 exec_hi, -1
    s_branch L_cs_v
L_csx_v:
    v_mfma_f32_32x32x16_bf16 v[74:89], v[30:33], v[34:37], v[74:89]
    v_cvt_pk_bf16_f32 v126, v158, v158
    v_cvt_pk_bf16_f32 v128, v160, v160
    v_and_b32 v136, 0xffff0000, v126
    v_and_b32 v137, 0xffff0000, v128
    v_sub_f32 v136, v158, v136
    v_sub_f32 v137, v160, v137
    v_cvt_pk_bf16_f32 v126, v158, v136
    v_cvt_pk_bf16_f32 v127, v158, v136
    v_cvt_pk_bf16_f32 v128, v160, v137
    v_cvt_pk_bf16_f32 v129, v160, v137
    s_nop 1
    v_mfma_f32_32x32x8_bf16 v[42:57], v[122:123], v[126:127], v[42:57]
    v_mfma_f32_32x32x8_bf16 v[58:73], v[122:123], v[128:129], v[58:73]
    v_mfma_f32_32x32x8_bf16 v[90:105], v[124:125], v[128:129], v[90:105]
    v_mfma_f32_32x32x8_bf16 v[74:89], v[124:125], v[126:127], v[74:89]
    s_setprio 0
    ds_read_b128 v[10:13], v119 offset:1152
    ds_read_b128 v[14:17], v119 offset:1184
    ds_read_b128 v[18:21], v119 offset:1216
    ds_read_b128 v[22:25], v119 offset:1248
    s_waitcnt lgkmcnt(4)
    s_nop 2
    v_mul_f32 v42, v138, v42
    v_mul_f32 v43, v139, v43
    v_mul_f32 v44, v140, v44
    v_mul_f32 v45, v141, v45
    v_mul_f32 v46, v142, v46
    v_mul_f32 v47, v143, v47
    v_mul_f32 v48, v144, v48
    v_mul_f32 v49, v145, v49
    v_cvt_pk_bf16_f32 v42, v42, v43
    v_cvt_pk_bf16_f32 v43, v44, v45
    v_cvt_pk_bf16_f32 v44, v46, v47
    v_cvt_pk_bf16_f32 v45, v48, v49
    buffer_store_dwordx4 v[42:45], v106, s[24:27], s52 offen offset:0 sc1
    v_mul_f32 v50, v146, v50
    v_mul_f32 v51, v147, v51
    v_mul_f32 v52, v148, v52
    v_mul_f32 v53, v149, v53
    v_mul_f32 v54, v150, v54
    v_mul_f32 v55, v151, v55
    v_mul_f32 v56, v152, v56
    v_mul_f32 v57, v153, v57
    v_cvt_pk_bf16_f32 v50, v50, v51
    v_cvt_pk_bf16_f32 v51, v52, v53
    v_cvt_pk_bf16_f32 v52, v54, v55
    v_cvt_pk_bf16_f32 v53, v56, v57
    buffer_store_dwordx4 v[50:53], v106, s[24:27], s52 offen offset:640 sc1
    v_mul_f32 v58, v138, v58
    v_mul_f32 v59, v139, v59
    v_mul_f32 v60, v140, v60
    v_mul_f32 v61, v141, v61
    v_mul_f32 v62, v142, v62
    v_mul_f32 v63, v143, v63
    v_mul_f32 v64, v144, v64
    v_mul_f32 v65, v145, v65
    v_cvt_pk_bf16_f32 v58, v58, v59
    v_cvt_pk_bf16_f32 v59, v60, v61
    v_cvt_pk_bf16_f32 v60, v62, v63
    v_cvt_pk_bf16_f32 v61, v64, v65
    buffer_store_dwordx4 v[58:61], v107, s[24:27], s52 offen offset:0 sc1
    v_mul_f32 v66, v146, v66
    v_mul_f32 v67, v147, v67
    v_mul_f32 v68, v148, v68
    v_mul_f32 v69, v149, v69
    v_mul_f32 v70, v150, v70
    v_mul_f32 v71, v151, v71
    v_mul_f32 v72, v152, v72
    v_mul_f32 v73, v153, v73
    v_cvt_pk_bf16_f32 v66, v66, v67
    v_cvt_pk_bf16_f32 v67, v68, v69
    v_cvt_pk_bf16_f32 v68, v70, v71
    v_cvt_pk_bf16_f32 v69, v72, v73
    buffer_store_dwordx4 v[66:69], v107, s[24:27], s52 offen offset:640 sc1
    s_waitcnt lgkmcnt(0)
    v_mul_f32 v74, v10, v74
    v_mul_f32 v75, v11, v75
    v_mul_f32 v76, v12, v76
    v_mul_f32 v77, v13, v77
    v_mul_f32 v78, v14, v78
    v_mul_f32 v79, v15, v79
    v_mul_f32 v80, v16, v80
    v_mul_f32 v81, v17, v81
    v_cvt_pk_bf16_f32 v74, v74, v75
    v_cvt_pk_bf16_f32 v75, v76, v77
    v_cvt_pk_bf16_f32 v76, v78, v79
    v_cvt_pk_bf16_f32 v77, v80, v81
    buffer_store_dwordx4 v[74:77], v106, s[24:27], s52 offen offset:1280 sc1
    v_mul_f32 v82, v18, v82
    v_mul_f32 v83, v19, v83
    v_mul_f32 v84, v20, v84
    v_mul_f32 v85, v21, v85
    v_mul_f32 v86, v22, v86
    v_mul_f32 v87, v23, v87
    v_mul_f32 v88, v24, v88
    v_mul_f32 v89, v25, v89
    v_cvt_pk_bf16_f32 v82, v82, v83
    v_cvt_pk_bf16_f32 v83, v84, v85
    v_cvt_pk_bf16_f32 v84, v86, v87
    v_cvt_pk_bf16_f32 v85, v88, v89
    buffer_store_dwordx4 v[82:85], v106, s[24:27], s52 offen offset:1920 sc1
    v_mul_f32 v90, v10, v90
    v_mul_f32 v91, v11, v91
    v_mul_f32 v92, v12, v92
    v_mul_f32 v93, v13, v93
    v_mul_f32 v94, v14, v94
    v_mul_f32 v95, v15, v95
    v_mul_f32 v96, v16, v96
    v_mul_f32 v97, v17, v97
    v_cvt_pk_bf16_f32 v90, v90, v91
    v_cvt_pk_bf16_f32 v91, v92, v93
    v_cvt_pk_bf16_f32 v92, v94, v95
    v_cvt_pk_bf16_f32 v93, v96, v97
    buffer_store_dwordx4 v[90:93], v107, s[24:27], s52 offen offset:1280 sc1
    v_mul_f32 v98, v18, v98
    v_mul_f32 v99, v19, v99
    v_mul_f32 v100, v20, v100
    v_mul_f32 v101, v21, v101
    v_mul_f32 v102, v22, v102
    v_mul_f32 v103, v23, v103
    v_mul_f32 v104, v24, v104
    v_mul_f32 v105, v25, v105
    v_cvt_pk_bf16_f32 v98, v98, v99
    v_cvt_pk_bf16_f32 v99, v100, v101
    v_cvt_pk_bf16_f32 v100, v102, v103
    v_cvt_pk_bf16_f32 v101, v104, v105
    buffer_store_dwordx4 v[98:101], v107, s[24:27], s52 offen offset:1920 sc1
L_x_sig:
    v_mov_b32 v4, 160256
    ds_read_b32 v4, v4
    s_waitcnt lgkmcnt(0)
    v_readfirstlane_b32 s33, v4
    s_lshl_b32 s34, s30, 1
    s_add_u32 s34, s34, s41
    s_lshl_b32 s34, s34, 10
    s_lshr_b32 s35, s29, 1
    s_lshl_b32 s35, s35, 7
    s_add_u32 s34, s34, s35
    s_add_u32 s34, s34, 17629184
    s_and_b32 s35, s29, 1
    s_lshl_b32 s35, s35, 1
    s_add_u32 s35, s35, s40
    s_lshl_b32 s35, s35, 2
    s_add_u32 s34, s34, s35
    v_mov_b32 v1, 0
    s_mov_b64 vcc, 1
    s_barrier
    s_mov_b64 exec, vcc
    s_waitcnt vmcnt(0)
    buffer_store_dword v4, v1, s[24:27], s34 offen sc1
    s_mov_b64 exec, -1
    s_barrier
L_attn:
    v_lshrrev_b32 v2, 5, v0
    v_and_b32 v3, 31, v0
    s_mul_i32 s41, s31, 163840
    s_add_u32 s41, s41, 2621440
    v_lshlrev_b32 v5, 3, v3
    v_lshl_add_u32 v120, v2, 9, v5
    v_add_u32 v6, 143360, v120
    v_add_u32 v7, 143616, v120
    v_lshlrev_b32 v5, 3, v0
    v_add_u32 v5, 145408, v5
    v_lshlrev_b32 v4, 4, v3
    v_mul_u32_u24 v112, 320, v2
    v_add_u32 v4, v4, v112
    v_add_u32 v4, 122368, v4
    v_cmp_eq_u32 vcc, 20, v3
    v_mov_b32 v112, 123008
    v_mov_b32 v113, 196608
    v_cndmask_b32 v4, v4, v112, vcc
    v_cmp_lt_u32 vcc, 20, v3
    s_nop 1
    v_cndmask_b32 v4, v4, v113, vcc
    v_mov_b32 v56, 0
    v_mov_b32 v57, 0
    v_mov_b32 v58, 0
    v_mov_b32 v59, 0
    v_mov_b32 v60, 0
    v_mov_b32 v61, 0
    v_mov_b32 v62, 0
    v_mov_b32 v63, 0
    v_mov_b32 v64, 0
    v_mov_b32 v65, 0
    v_mov_b32 v66, 0
    v_mov_b32 v67, 0
    v_mov_b32 v68, 0
    v_mov_b32 v69, 0
    v_mov_b32 v70, 0
    v_mov_b32 v71, 0
    v_mov_b32 v52, 0
    v_mov_b32 v108, 0
    v_mov_b32 v53, 0
    v_mov_b32 v109, 0
    v_mov_b32 v54, 0
    v_mov_b32 v110, 0
    v_mov_b32 v55, 0
    v_mov_b32 v111, 0
    s_lshr_b32 s34, s28, 1
    s_cmp_lt_u32 s34, 3
    s_mov_b32 s35, 153344
    s_cmov_b32 s35, 114688
    s_mul_i32 s34, s34, 2560
    s_add_u32 s34, s34, s35
    s_and_b32 s35, s28, 1
    s_lshl_b32 s35, s35, 3
    s_add_u32 s34, s34, s35
    v_lshl_add_u32 v119, v3, 4, s34
    v_lshl_add_u32 v118, v2, 9, v119
    s_mul_i32 s34, s31, 20
    s_add_u32 s35, s34, 19
    s_lshr_b32 s34, s34, 6
    s_lshr_b32 s35, s35, 6
    s_sub_u32 s35, s35, s34
    s_lshl_b32 s35, s35, 10
    s_lshl_b32 s48, s34, 10
    s_add_u32 s48, s48, 17629184
    v_bfe_u32 v114, v0, 2, 2
    s_lshl_b32 s34, s28, 1
    s_sub_u32 s34, s34, 1
    v_add_u32 v1, s34, v114
    v_cmp_eq_u32 vcc, 0, v114
    v_bfe_u32 v115, v0, 1, 1
    v_add_u32 v115, 1, v115
    v_cndmask_b32 v1, v1, v114, vcc
    v_cmp_eq_u32 vcc, 3, v114
    v_mov_b32 v116, s32
    v_mov_b32 v117, 0
    v_cndmask_b32 v1, v1, v116, vcc
    v_cndmask_b32 v115, v115, v117, vcc
    v_lshlrev_b32 v1, 7, v1
    v_mul_u32_u24 v115, 10240, v115
    v_add_u32 v1, v1, v115
    v_and_b32 v114, 1, v0
    v_mad_u32_u24 v1, v114, s35, v1
    s_mov_b32 s50, 1048576
    s_mov_b32 s44, -1
    s_mov_b32 s45, 0xff
    s_lshl_b32 s34, s31, 5
    s_lshl_b32 s35, s32, 2
    s_add_u32 s34, s34, s35
    s_add_u32 s34, s34, s28
    s_mul_i32 s51, s34, 2560
    s_add_u32 s51, s51, 0
    s_cmp_lt_u32 s28, 3
    s_mov_b32 s35, 153344
    s_cmov_b32 s35, 114688
    s_mul_i32 s52, s28, 2560
    s_add_u32 s52, s52, s35
    s_mul_i32 s34, s28, 1280
    s_mul_i32 s35, s28, 1312
    s_add_u32 s36, s34, s41
    s_mov_b32 s49, 0
    s_cmp_ge_u32 s30, 15
    s_cbranch_scc1 L_poll1c
    s_barrier
    s_mov_b64 exec, 0xffff
    buffer_load_dwordx4 v[114:117], v1, s[24:27], s48 offen sc1
    s_mov_b64 exec, -1
    s_mov_b32 s49, 0
L_poll1a:
    s_barrier
    s_waitcnt vmcnt(0)
    v_xor_b32 v114, s33, v114
    v_xor_b32 v115, s33, v115
    v_xor_b32 v116, s33, v116
    v_xor_b32 v117, s33, v117
    v_or3_b32 v114, v114, v115, v116
    v_or_b32 v114, v114, v117
    v_cmp_ne_u32 vcc, 0, v114
    s_nop 1
    s_and_b32 vcc_lo, vcc_lo, 0xffff
    s_cbranch_scc0 L_poll1_ok
    s_mov_b64 exec, 0xffff
    buffer_load_dwordx4 v[114:117], v1, s[24:27], s48 offen sc1
    s_mov_b64 exec, -1
    s_sub_u32 s49, s49, 1
    s_cbranch_scc0 L_poll1a
    s_mov_b32 s49, 0
L_poll1b:
    s_waitcnt vmcnt(0)
    v_xor_b32 v114, s33, v114
    v_xor_b32 v115, s33, v115
    v_xor_b32 v116, s33, v116
    v_xor_b32 v117, s33, v117
    v_or3_b32 v114, v114, v115, v116
    v_or_b32 v114, v114, v117
    v_cmp_ne_u32 vcc, 0, v114
    s_nop 1
    s_and_b32 vcc_lo, vcc_lo, 0xffff
    s_cbranch_scc0 L_poll1_ok
    s_sub_u32 s50, s50, 1
    s_cbranch_scc1 L_poll1_ok
L_poll1c:
    s_mov_b64 exec, 0xffff
    buffer_load_dwordx4 v[114:117], v1, s[24:27], s48 offen sc1
    s_mov_b64 exec, -1
    s_branch L_poll1b
L_poll1_ok:
    v_lshlrev_b32 v1, 4, v0
    s_mov_b32 m0, s52
    s_mov_b64 exec, s[44:45]
    buffer_load_dwordx4 v1, s[24:27], s51 offen offset:0 sc1 lds
    buffer_load_dwordx4 v1, s[24:27], s51 offen offset:640 sc1 lds
    buffer_load_dwordx4 v1, s[24:27], s51 offen offset:1280 sc1 lds
    buffer_load_dwordx4 v1, s[24:27], s51 offen offset:1920 sc1 lds
    s_add_u32 m0, s34, 143360
    s_add_u32 s37, s36, 0
    buffer_load_dwordx4 v1, s[24:27], s37 offen sc1 lds
    buffer_load_dwordx4 v1, s[24:27], s37 offen offset:640 sc1 lds
    s_add_u32 m0, s35, 122368
    s_add_u32 s37, s37, 5120
    buffer_load_dwordx4 v1, s[24:27], s37 offen sc1 lds
    s_sub_u32 s37, s37, 16
    buffer_load_dwordx4 v1, s[24:27], s37 offen offset:656 sc1 lds
    s_add_u32 m0, s34, 148480
    s_add_u32 s37, s36, 10240
    buffer_load_dwordx4 v1, s[24:27], s37 offen sc1 lds
    buffer_load_dwordx4 v1, s[24:27], s37 offen offset:640 sc1 lds
    s_add_u32 m0, s35, 127616
    s_add_u32 s37, s37, 5120
    buffer_load_dwordx4 v1, s[24:27], s37 offen sc1 lds
    s_sub_u32 s37, s37, 16
    buffer_load_dwordx4 v1, s[24:27], s37 offen offset:656 sc1 lds
    s_mov_b64 exec, -1
L_rest:
    s_sub_u32 s49, s49, 1
    s_cbranch_scc1 L_rest_done
    s_barrier
    s_branch L_rest
L_rest_done:
    s_waitcnt vmcnt(4)
    s_branch L_attn_j
L_attn_z:
    v_mov_b32 v1, 160256
    ds_read_b32 v1, v1
    s_waitcnt lgkmcnt(0)
    v_readfirstlane_b32 s33, v1
    v_lshrrev_b32 v2, 5, v0
    v_and_b32 v3, 31, v0
    s_mul_i32 s41, s31, 163840
    s_add_u32 s41, s41, 2621440
    v_lshlrev_b32 v5, 3, v3
    v_lshl_add_u32 v120, v2, 9, v5
    v_add_u32 v6, 143360, v120
    v_add_u32 v7, 143616, v120
    v_lshlrev_b32 v5, 3, v0
    v_add_u32 v5, 145408, v5
    v_lshlrev_b32 v4, 4, v3
    v_mul_u32_u24 v112, 320, v2
    v_add_u32 v4, v4, v112
    v_add_u32 v4, 122368, v4
    v_cmp_eq_u32 vcc, 20, v3
    v_mov_b32 v112, 123008
    v_mov_b32 v113, 196608
    v_cndmask_b32 v4, v4, v112, vcc
    v_cmp_lt_u32 vcc, 20, v3
    s_nop 1
    v_cndmask_b32 v4, v4, v113, vcc
    v_mov_b32 v56, 0
    v_mov_b32 v57, 0
    v_mov_b32 v58, 0
    v_mov_b32 v59, 0
    v_mov_b32 v60, 0
    v_mov_b32 v61, 0
    v_mov_b32 v62, 0
    v_mov_b32 v63, 0
    v_mov_b32 v64, 0
    v_mov_b32 v65, 0
    v_mov_b32 v66, 0
    v_mov_b32 v67, 0
    v_mov_b32 v68, 0
    v_mov_b32 v69, 0
    v_mov_b32 v70, 0
    v_mov_b32 v71, 0
    v_mov_b32 v52, 0
    v_mov_b32 v108, 0
    v_mov_b32 v53, 0
    v_mov_b32 v109, 0
    v_mov_b32 v54, 0
    v_mov_b32 v110, 0
    v_mov_b32 v55, 0
    v_mov_b32 v111, 0
    s_lshr_b32 s34, s28, 1
    s_cmp_lt_u32 s34, 3
    s_mov_b32 s35, 153344
    s_cmov_b32 s35, 114688
    s_mul_i32 s34, s34, 2560
    s_add_u32 s34, s34, s35
    s_and_b32 s35, s28, 1
    s_lshl_b32 s35, s35, 3
    s_add_u32 s34, s34, s35
    v_lshl_add_u32 v119, v3, 4, s34
    v_lshl_add_u32 v118, v2, 9, v119
    v_mul_u32_u24 v1, 656, v3
    v_add_u32 v1, 123008, v1
    v_mov_b32 v88, 0x3f803f80
    v_mov_b32 v89, 0x3f803f80
    v_mov_b32 v90, 0x3f803f80
    v_mov_b32 v91, 0x3f803f80
    s_cmp_lg_u32 s28, 4
    s_cbranch_scc1 L_noones
    ds_write_b128 v1, v[88:91]
L_noones:
    s_waitcnt vmcnt(0)
    s_barrier
    s_waitcnt lgkmcnt(0)
L_attn_j:
    s_mov_b32 vcc_lo, -1
    s_mov_b32 vcc_hi, 0
    s_mov_b32 s46, -1
    s_mov_b32 s47, 0
    s_barrier
    ds_read2st64_b64 v[8:11], v118 offset0:0 offset1:2
    ds_read2st64_b64 v[88:91], v6 offset0:0 offset1:2
    ds_read2st64_b64 v[92:95], v7 offset0:0 offset1:2
    ds_read_b64 v[114:115], v119 offset:2048
    ds_read_b64 v[112:113], v5 offset:0
    ds_read_b128 v[96:99], v4 offset:0
    ds_read_b128 v[100:103], v4 offset:656
    s_waitcnt lgkmcnt(5)
    v_mfma_f32_32x32x16_bf16 v[16:31], v[88:91], v[8:11], 0
    s_waitcnt lgkmcnt(3)
    v_cndmask_b32 v12, 0, v114, vcc
    v_cndmask_b32 v13, 0, v115, vcc
    v_cndmask_b32 v14, v114, 0, s[46:47]
    v_cndmask_b32 v15, v115, 0, s[46:47]
    v_mfma_f32_32x32x16_bf16 v[32:47], v[92:95], v[8:11], 0
    s_waitcnt lgkmcnt(2)
    v_mfma_f32_32x32x8_bf16 v[16:31], v[112:113], v[12:13], v[16:31]
    v_mfma_f32_32x32x8_bf16 v[32:47], v[112:113], v[14:15], v[32:47]
    s_nop 10
    v_max3_f32 v114, v16, v17, v18
    v_max3_f32 v115, v19, v20, v21
    v_max3_f32 v114, v114, v22, v23
    v_max3_f32 v115, v115, v24, v25
    v_max3_f32 v114, v114, v26, v27
    v_max3_f32 v115, v115, v28, v29
    v_max3_f32 v114, v114, v30, v31
    v_max3_f32 v115, v115, v32, v33
    v_max3_f32 v114, v114, v34, v35
    v_max3_f32 v115, v115, v36, v37
    v_max3_f32 v114, v114, v38, v39
    v_max3_f32 v115, v115, v40, v41
    v_max3_f32 v114, v114, v42, v43
    v_max3_f32 v115, v115, v44, v45
    v_max3_f32 v114, v114, v46, v47
    v_max_f32 v114, v114, v115
    v_mov_b32 v115, v114
    s_nop 1
    v_permlane32_swap_b32 v114, v115
    s_nop 1
    v_max_f32 v114, v114, v115
    v_sub_f32 v72, 0xc2c00000, v114
    v_mov_b32 v73, v72
    v_mov_b64 v[74:75], v[72:73]
    v_mov_b64 v[76:77], v[72:73]
    v_mov_b64 v[78:79], v[72:73]
    v_mov_b64 v[80:81], v[72:73]
    v_mov_b64 v[82:83], v[72:73]
    v_mov_b64 v[84:85], v[72:73]
    v_mov_b64 v[86:87], v[72:73]
    s_nop 1
    v_mfma_f32_32x32x16_bf16 v[16:31], v[88:91], v[8:11], v[72:87]
    v_mfma_f32_32x32x8_bf16 v[16:31], v[112:113], v[12:13], v[16:31]
    s_mov_b32 s40, 4
    s_waitcnt vmcnt(0)
    s_nop 7
.p2align 3
L_at_loop:
    v_mfma_f32_32x32x16_bf16 v[32:47], v[92:95], v[8:11], v[72:87]
    s_setprio 1
    ds_read2st64_b64 v[88:91], v6 offset0:5 offset1:7
    v_exp_f32 v16, v16
    v_exp_f32 v17, v17
    v_exp_f32 v18, v18
    v_cvt_pk_bf16_f32 v48, v16, v17
    v_exp_f32 v19, v19
    v_exp_f32 v20, v20
    v_mfma_f32_32x32x16_bf16 v[56:71], v[108:111], v[52:55], v[56:71]
    s_waitcnt lgkmcnt(1)
    ds_read_b128 v[104:107], v4 offset:1312
    ds_read_b128 v[108:111], v4 offset:1968
    v_cvt_pk_bf16_f32 v49, v18, v19
    v_exp_f32 v21, v21
    v_exp_f32 v22, v22
    v_cvt_pk_bf16_f32 v50, v20, v21
    v_exp_f32 v23, v23
    v_exp_f32 v24, v24
    v_mfma_f32_32x32x8_bf16 v[32:47], v[112:113], v[14:15], v[32:47]
    v_cvt_pk_bf16_f32 v51, v22, v23
    v_exp_f32 v25, v25
    v_exp_f32 v26, v26
    v_cvt_pk_bf16_f32 v52, v24, v25
    v_exp_f32 v27, v27
    v_exp_f32 v28, v28
    v_mfma_f32_32x32x16_bf16 v[56:71], v[96:99], v[48:51], v[56:71]
    s_waitcnt lgkmcnt(2)
    ds_read_b64 v[112:113], v5 offset:2560
    v_cvt_pk_bf16_f32 v53, v26, v27
    v_exp_f32 v29, v29
    v_exp_f32 v30, v30
    v_exp_f32 v31, v31
    v_cvt_pk_bf16_f32 v54, v28, v29
    v_cvt_pk_bf16_f32 v55, v30, v31
    v_mfma_f32_32x32x16_bf16 v[16:31], v[88:91], v[8:11], v[72:87]
    s_setprio 0
    ds_read2st64_b64 v[92:95], v7 offset0:5 offset1:7
    v_exp_f32 v32, v32
    v_exp_f32 v33, v33
    v_exp_f32 v34, v34
    v_cvt_pk_bf16_f32 v48, v32, v33
    v_exp_f32 v35, v35
    v_exp_f32 v36, v36
    v_mfma_f32_32x32x16_bf16 v[56:71], v[100:103], v[52:55], v[56:71]
    s_waitcnt lgkmcnt(1)
    ds_read_b128 v[96:99], v4 offset:2624
    ds_read_b128 v[100:103], v4 offset:3280
    v_cvt_pk_bf16_f32 v49, v34, v35
    v_exp_f32 v37, v37
    v_exp_f32 v38, v38
    v_cvt_pk_bf16_f32 v50, v36, v37
    v_exp_f32 v39, v39
    v_exp_f32 v40, v40
    v_mfma_f32_32x32x8_bf16 v[16:31], v[112:113], v[12:13], v[16:31]
    v_cvt_pk_bf16_f32 v51, v38, v39
    v_exp_f32 v41, v41
    v_exp_f32 v42, v42
    v_cvt_pk_bf16_f32 v52, v40, v41
    v_exp_f32 v43, v43
    v_exp_f32 v44, v44
    v_mfma_f32_32x32x16_bf16 v[56:71], v[104:107], v[48:51], v[56:71]
    s_waitcnt lgkmcnt(2)
    v_cvt_pk_bf16_f32 v53, v42, v43
    v_exp_f32 v45, v45
    v_exp_f32 v46, v46
    v_exp_f32 v47, v47
    v_cvt_pk_bf16_f32 v54, v44, v45
    v_cvt_pk_bf16_f32 v55, v46, v47
    v_mfma_f32_32x32x16_bf16 v[32:47], v[92:95], v[8:11], v[72:87]
    s_barrier
    s_setprio 3
    ds_read2st64_b64 v[88:91], v6 offset0:10 offset1:12
    v_exp_f32 v16, v16
    v_exp_f32 v17, v17
    v_exp_f32 v18, v18
    v_cvt_pk_bf16_f32 v48, v16, v17
    v_exp_f32 v19, v19
    v_exp_f32 v20, v20
    v_mfma_f32_32x32x16_bf16 v[56:71], v[108:111], v[52:55], v[56:71]
    s_waitcnt lgkmcnt(1)
    ds_read_b128 v[104:107], v4 offset:3936
    ds_read_b128 v[108:111], v4 offset:4592
    v_cvt_pk_bf16_f32 v49, v18, v19
    v_exp_f32 v21, v21
    v_exp_f32 v22, v22
    v_cvt_pk_bf16_f32 v50, v20, v21
    v_exp_f32 v23, v23
    v_exp_f32 v24, v24
    v_mfma_f32_32x32x8_bf16 v[32:47], v[112:113], v[14:15], v[32:47]
    v_cvt_pk_bf16_f32 v51, v22, v23
    v_exp_f32 v25, v25
    v_exp_f32 v26, v26
    v_cvt_pk_bf16_f32 v52, v24, v25
    v_exp_f32 v27, v27
    v_exp_f32 v28, v28
    v_mfma_f32_32x32x16_bf16 v[56:71], v[96:99], v[48:51], v[56:71]
    s_waitcnt lgkmcnt(2)
    ds_read_b64 v[112:113], v5 offset:5120
    v_cvt_pk_bf16_f32 v53, v26, v27
    v_exp_f32 v29, v29
    v_exp_f32 v30, v30
    v_exp_f32 v31, v31
    v_cvt_pk_bf16_f32 v54, v28, v29
    v_cvt_pk_bf16_f32 v55, v30, v31
    v_mfma_f32_32x32x16_bf16 v[16:31], v[88:91], v[8:11], v[72:87]
    s_setprio 2
    ds_read2st64_b64 v[92:95], v7 offset0:10 offset1:12
    v_exp_f32 v32, v32
    v_exp_f32 v33, v33
    v_exp_f32 v34, v34
    v_cvt_pk_bf16_f32 v48, v32, v33
    v_exp_f32 v35, v35
    v_exp_f32 v36, v36
    v_mfma_f32_32x32x16_bf16 v[56:71], v[100:103], v[52:55], v[56:71]
    s_waitcnt lgkmcnt(1)
    ds_read_b128 v[96:99], v4 offset:5248
    ds_read_b128 v[100:103], v4 offset:5904
    v_cvt_pk_bf16_f32 v49, v34, v35
    v_exp_f32 v37, v37
    v_exp_f32 v38, v38
    v_cvt_pk_bf16_f32 v50, v36, v37
    v_exp_f32 v39, v39
    v_exp_f32 v40, v40
    v_mfma_f32_32x32x8_bf16 v[16:31], v[112:113], v[12:13], v[16:31]
    v_cvt_pk_bf16_f32 v51, v38, v39
    v_exp_f32 v41, v41
    v_exp_f32 v42, v42
    v_cvt_pk_bf16_f32 v52, v40, v41
    v_exp_f32 v43, v43
    v_exp_f32 v44, v44
    v_mfma_f32_32x32x16_bf16 v[56:71], v[104:107], v[48:51], v[56:71]
    s_waitcnt lgkmcnt(2)
    v_cvt_pk_bf16_f32 v53, v42, v43
    v_exp_f32 v45, v45
    v_exp_f32 v46, v46
    v_exp_f32 v47, v47
    v_cvt_pk_bf16_f32 v54, v44, v45
    v_cvt_pk_bf16_f32 v55, v46, v47
    v_mfma_f32_32x32x16_bf16 v[32:47], v[92:95], v[8:11], v[72:87]
    s_setprio 1
    ds_read2st64_b64 v[88:91], v6 offset0:15 offset1:17
    v_exp_f32 v16, v16
    v_exp_f32 v17, v17
    v_exp_f32 v18, v18
    v_cvt_pk_bf16_f32 v48, v16, v17
    v_exp_f32 v19, v19
    v_exp_f32 v20, v20
    v_mfma_f32_32x32x16_bf16 v[56:71], v[108:111], v[52:55], v[56:71]
    s_waitcnt lgkmcnt(1)
    ds_read_b128 v[104:107], v4 offset:6560
    ds_read_b128 v[108:111], v4 offset:7216
    v_cvt_pk_bf16_f32 v49, v18, v19
    v_exp_f32 v21, v21
    v_exp_f32 v22, v22
    v_cvt_pk_bf16_f32 v50, v20, v21
    v_exp_f32 v23, v23
    v_exp_f32 v24, v24
    v_mfma_f32_32x32x8_bf16 v[32:47], v[112:113], v[14:15], v[32:47]
    v_cvt_pk_bf16_f32 v51, v22, v23
    v_exp_f32 v25, v25
    v_exp_f32 v26, v26
    v_cvt_pk_bf16_f32 v52, v24, v25
    v_exp_f32 v27, v27
    v_exp_f32 v28, v28
    v_mfma_f32_32x32x16_bf16 v[56:71], v[96:99], v[48:51], v[56:71]
    s_waitcnt lgkmcnt(2)
    ds_read_b64 v[112:113], v5 offset:7680
    v_cvt_pk_bf16_f32 v53, v26, v27
    v_exp_f32 v29, v29
    v_exp_f32 v30, v30
    v_exp_f32 v31, v31
    v_cvt_pk_bf16_f32 v54, v28, v29
    v_cvt_pk_bf16_f32 v55, v30, v31
    v_mfma_f32_32x32x16_bf16 v[16:31], v[88:91], v[8:11], v[72:87]
    s_setprio 0
    ds_read2st64_b64 v[92:95], v7 offset0:15 offset1:17
    v_exp_f32 v32, v32
    v_exp_f32 v33, v33
    v_exp_f32 v34, v34
    v_cvt_pk_bf16_f32 v48, v32, v33
    v_exp_f32 v35, v35
    v_exp_f32 v36, v36
    v_mfma_f32_32x32x16_bf16 v[56:71], v[100:103], v[52:55], v[56:71]
    s_waitcnt lgkmcnt(1)
    ds_read_b128 v[96:99], v4 offset:7872
    ds_read_b128 v[100:103], v4 offset:8528
    v_cvt_pk_bf16_f32 v49, v34, v35
    v_exp_f32 v37, v37
    v_exp_f32 v38, v38
    v_cvt_pk_bf16_f32 v50, v36, v37
    v_exp_f32 v39, v39
    v_exp_f32 v40, v40
    v_mfma_f32_32x32x8_bf16 v[16:31], v[112:113], v[12:13], v[16:31]
    v_cvt_pk_bf16_f32 v51, v38, v39
    v_exp_f32 v41, v41
    v_exp_f32 v42, v42
    v_cvt_pk_bf16_f32 v52, v40, v41
    v_exp_f32 v43, v43
    v_exp_f32 v44, v44
    v_mfma_f32_32x32x16_bf16 v[56:71], v[104:107], v[48:51], v[56:71]
    s_waitcnt lgkmcnt(2)
    v_cvt_pk_bf16_f32 v53, v42, v43
    v_exp_f32 v45, v45
    v_exp_f32 v46, v46
    v_exp_f32 v47, v47
    v_cvt_pk_bf16_f32 v54, v44, v45
    v_cvt_pk_bf16_f32 v55, v46, v47
    v_mfma_f32_32x32x16_bf16 v[32:47], v[92:95], v[8:11], v[72:87]
    s_barrier
    s_setprio 3
    ds_read2st64_b64 v[88:91], v6 offset0:20 offset1:22
    v_exp_f32 v16, v16
    v_exp_f32 v17, v17
    v_exp_f32 v18, v18
    v_cvt_pk_bf16_f32 v48, v16, v17
    v_exp_f32 v19, v19
    v_exp_f32 v20, v20
    v_mfma_f32_32x32x16_bf16 v[56:71], v[108:111], v[52:55], v[56:71]
    s_waitcnt lgkmcnt(1)
    ds_read_b128 v[104:107], v4 offset:9184
    ds_read_b128 v[108:111], v4 offset:9840
    v_cvt_pk_bf16_f32 v49, v18, v19
    v_exp_f32 v21, v21
    v_exp_f32 v22, v22
    v_cvt_pk_bf16_f32 v50, v20, v21
    v_exp_f32 v23, v23
    v_exp_f32 v24, v24
    v_mfma_f32_32x32x8_bf16 v[32:47], v[112:113], v[14:15], v[32:47]
    v_cvt_pk_bf16_f32 v51, v22, v23
    v_exp_f32 v25, v25
    v_exp_f32 v26, v26
    v_cvt_pk_bf16_f32 v52, v24, v25
    v_exp_f32 v27, v27
    v_exp_f32 v28, v28
    v_mfma_f32_32x32x16_bf16 v[56:71], v[96:99], v[48:51], v[56:71]
    s_waitcnt lgkmcnt(2)
    ds_read_b64 v[112:113], v5 offset:10240
    v_cvt_pk_bf16_f32 v53, v26, v27
    v_exp_f32 v29, v29
    v_exp_f32 v30, v30
    v_exp_f32 v31, v31
    v_cvt_pk_bf16_f32 v54, v28, v29
    v_cvt_pk_bf16_f32 v55, v30, v31
    v_mfma_f32_32x32x16_bf16 v[16:31], v[88:91], v[8:11], v[72:87]
    s_setprio 2
    ds_read2st64_b64 v[92:95], v7 offset0:20 offset1:22
    v_exp_f32 v32, v32
    v_exp_f32 v33, v33
    v_exp_f32 v34, v34
    v_cvt_pk_bf16_f32 v48, v32, v33
    v_exp_f32 v35, v35
    v_exp_f32 v36, v36
    v_mfma_f32_32x32x16_bf16 v[56:71], v[100:103], v[52:55], v[56:71]
    s_waitcnt lgkmcnt(1)
    ds_read_b128 v[96:99], v4 offset:10496
    ds_read_b128 v[100:103], v4 offset:11152
    v_cvt_pk_bf16_f32 v49, v34, v35
    v_exp_f32 v37, v37
    v_exp_f32 v38, v38
    v_cvt_pk_bf16_f32 v50, v36, v37
    v_exp_f32 v39, v39
    v_exp_f32 v40, v40
    v_mfma_f32_32x32x8_bf16 v[16:31], v[112:113], v[12:13], v[16:31]
    v_cvt_pk_bf16_f32 v51, v38, v39
    v_exp_f32 v41, v41
    v_exp_f32 v42, v42
    v_cvt_pk_bf16_f32 v52, v40, v41
    v_exp_f32 v43, v43
    v_exp_f32 v44, v44
    v_mfma_f32_32x32x16_bf16 v[56:71], v[104:107], v[48:51], v[56:71]
    s_waitcnt lgkmcnt(2)
    v_cvt_pk_bf16_f32 v53, v42, v43
    v_exp_f32 v45, v45
    v_exp_f32 v46, v46
    v_exp_f32 v47, v47
    v_cvt_pk_bf16_f32 v54, v44, v45
    v_cvt_pk_bf16_f32 v55, v46, v47
    v_mfma_f32_32x32x16_bf16 v[32:47], v[92:95], v[8:11], v[72:87]
    s_setprio 1
    ds_read2st64_b64 v[88:91], v6 offset0:25 offset1:27
    v_exp_f32 v16, v16
    v_exp_f32 v17, v17
    v_exp_f32 v18, v18
    v_cvt_pk_bf16_f32 v48, v16, v17
    v_exp_f32 v19, v19
    v_exp_f32 v20, v20
    v_mfma_f32_32x32x16_bf16 v[56:71], v[108:111], v[52:55], v[56:71]
    s_waitcnt lgkmcnt(1)
    ds_read_b128 v[104:107], v4 offset:11808
    ds_read_b128 v[108:111], v4 offset:12464
    v_cvt_pk_bf16_f32 v49, v18, v19
    v_exp_f32 v21, v21
    v_exp_f32 v22, v22
    v_cvt_pk_bf16_f32 v50, v20, v21
    v_exp_f32 v23, v23
    v_exp_f32 v24, v24
    v_mfma_f32_32x32x8_bf16 v[32:47], v[112:113], v[14:15], v[32:47]
    v_cvt_pk_bf16_f32 v51, v22, v23
    v_exp_f32 v25, v25
    v_exp_f32 v26, v26
    v_cvt_pk_bf16_f32 v52, v24, v25
    v_exp_f32 v27, v27
    v_exp_f32 v28, v28
    v_mfma_f32_32x32x16_bf16 v[56:71], v[96:99], v[48:51], v[56:71]
    s_waitcnt lgkmcnt(2)
    ds_read_b64 v[112:113], v5 offset:12800
    v_cvt_pk_bf16_f32 v53, v26, v27
    v_exp_f32 v29, v29
    v_exp_f32 v30, v30
    v_exp_f32 v31, v31
    v_cvt_pk_bf16_f32 v54, v28, v29
    v_cvt_pk_bf16_f32 v55, v30, v31
    v_mfma_f32_32x32x16_bf16 v[16:31], v[88:91], v[8:11], v[72:87]
    s_setprio 0
    ds_read2st64_b64 v[92:95], v7 offset0:25 offset1:27
    v_exp_f32 v32, v32
    v_exp_f32 v33, v33
    v_exp_f32 v34, v34
    v_cvt_pk_bf16_f32 v48, v32, v33
    v_exp_f32 v35, v35
    v_exp_f32 v36, v36
    v_mfma_f32_32x32x16_bf16 v[56:71], v[100:103], v[52:55], v[56:71]
    s_waitcnt lgkmcnt(1)
    ds_read_b128 v[96:99], v4 offset:13120
    ds_read_b128 v[100:103], v4 offset:13776
    v_cvt_pk_bf16_f32 v49, v34, v35
    v_exp_f32 v37, v37
    v_exp_f32 v38, v38
    v_cvt_pk_bf16_f32 v50, v36, v37
    v_exp_f32 v39, v39
    v_exp_f32 v40, v40
    v_mfma_f32_32x32x8_bf16 v[16:31], v[112:113], v[12:13], v[16:31]
    v_cvt_pk_bf16_f32 v51, v38, v39
    v_exp_f32 v41, v41
    v_exp_f32 v42, v42
    v_cvt_pk_bf16_f32 v52, v40, v41
    v_exp_f32 v43, v43
    v_exp_f32 v44, v44
    v_mfma_f32_32x32x16_bf16 v[56:71], v[104:107], v[48:51], v[56:71]
    s_waitcnt lgkmcnt(2)
    v_cvt_pk_bf16_f32 v53, v42, v43
    v_exp_f32 v45, v45
    v_exp_f32 v46, v46
    v_exp_f32 v47, v47
    v_cvt_pk_bf16_f32 v54, v44, v45
    v_cvt_pk_bf16_f32 v55, v46, v47
    v_mfma_f32_32x32x16_bf16 v[32:47], v[92:95], v[8:11], v[72:87]
    s_barrier
    s_setprio 3
    ds_read2st64_b64 v[88:91], v6 offset0:30 offset1:32
    v_exp_f32 v16, v16
    v_exp_f32 v17, v17
    v_exp_f32 v18, v18
    v_cvt_pk_bf16_f32 v48, v16, v17
    v_exp_f32 v19, v19
    v_exp_f32 v20, v20
    v_mfma_f32_32x32x16_bf16 v[56:71], v[108:111], v[52:55], v[56:71]
    s_waitcnt lgkmcnt(1)
    ds_read_b128 v[104:107], v4 offset:14432
    ds_read_b128 v[108:111], v4 offset:15088
    v_cvt_pk_bf16_f32 v49, v18, v19
    v_exp_f32 v21, v21
    v_exp_f32 v22, v22
    v_cvt_pk_bf16_f32 v50, v20, v21
    v_exp_f32 v23, v23
    v_exp_f32 v24, v24
    v_mfma_f32_32x32x8_bf16 v[32:47], v[112:113], v[14:15], v[32:47]
    v_cvt_pk_bf16_f32 v51, v22, v23
    v_exp_f32 v25, v25
    v_exp_f32 v26, v26
    v_cvt_pk_bf16_f32 v52, v24, v25
    v_exp_f32 v27, v27
    v_exp_f32 v28, v28
    v_mfma_f32_32x32x16_bf16 v[56:71], v[96:99], v[48:51], v[56:71]
    s_waitcnt lgkmcnt(2)
    ds_read_b64 v[112:113], v5 offset:15360
    v_cvt_pk_bf16_f32 v53, v26, v27
    v_exp_f32 v29, v29
    v_exp_f32 v30, v30
    v_exp_f32 v31, v31
    v_cvt_pk_bf16_f32 v54, v28, v29
    v_cvt_pk_bf16_f32 v55, v30, v31
    v_mfma_f32_32x32x16_bf16 v[16:31], v[88:91], v[8:11], v[72:87]
    s_setprio 2
    ds_read2st64_b64 v[92:95], v7 offset0:30 offset1:32
    v_exp_f32 v32, v32
    v_exp_f32 v33, v33
    v_exp_f32 v34, v34
    v_cvt_pk_bf16_f32 v48, v32, v33
    v_exp_f32 v35, v35
    v_exp_f32 v36, v36
    v_mfma_f32_32x32x16_bf16 v[56:71], v[100:103], v[52:55], v[56:71]
    s_waitcnt lgkmcnt(1)
    ds_read_b128 v[96:99], v4 offset:15744
    ds_read_b128 v[100:103], v4 offset:16400
    v_cvt_pk_bf16_f32 v49, v34, v35
    v_exp_f32 v37, v37
    v_exp_f32 v38, v38
    v_cvt_pk_bf16_f32 v50, v36, v37
    v_exp_f32 v39, v39
    v_exp_f32 v40, v40
    v_mfma_f32_32x32x8_bf16 v[16:31], v[112:113], v[12:13], v[16:31]
    v_cvt_pk_bf16_f32 v51, v38, v39
    v_exp_f32 v41, v41
    v_exp_f32 v42, v42
    v_cvt_pk_bf16_f32 v52, v40, v41
    v_exp_f32 v43, v43
    v_exp_f32 v44, v44
    v_mfma_f32_32x32x16_bf16 v[56:71], v[104:107], v[48:51], v[56:71]
    s_waitcnt lgkmcnt(2)
    v_cvt_pk_bf16_f32 v53, v42, v43
    v_exp_f32 v45, v45
    v_exp_f32 v46, v46
    v_exp_f32 v47, v47
    v_cvt_pk_bf16_f32 v54, v44, v45
    v_cvt_pk_bf16_f32 v55, v46, v47
    v_mfma_f32_32x32x16_bf16 v[32:47], v[92:95], v[8:11], v[72:87]
    s_setprio 1
    ds_read2st64_b64 v[88:91], v6 offset0:35 offset1:37
    v_exp_f32 v16, v16
    v_exp_f32 v17, v17
    v_exp_f32 v18, v18
    v_cvt_pk_bf16_f32 v48, v16, v17
    v_exp_f32 v19, v19
    v_exp_f32 v20, v20
    v_mfma_f32_32x32x16_bf16 v[56:71], v[108:111], v[52:55], v[56:71]
    s_waitcnt lgkmcnt(1)
    ds_read_b128 v[104:107], v4 offset:17056
    ds_read_b128 v[108:111], v4 offset:17712
    v_cvt_pk_bf16_f32 v49, v18, v19
    v_exp_f32 v21, v21
    v_exp_f32 v22, v22
    v_cvt_pk_bf16_f32 v50, v20, v21
    v_exp_f32 v23, v23
    v_exp_f32 v24, v24
    v_mfma_f32_32x32x8_bf16 v[32:47], v[112:113], v[14:15], v[32:47]
    v_cvt_pk_bf16_f32 v51, v22, v23
    v_exp_f32 v25, v25
    v_exp_f32 v26, v26
    v_cvt_pk_bf16_f32 v52, v24, v25
    v_exp_f32 v27, v27
    v_exp_f32 v28, v28
    v_mfma_f32_32x32x16_bf16 v[56:71], v[96:99], v[48:51], v[56:71]
    s_waitcnt lgkmcnt(2)
    ds_read_b64 v[112:113], v5 offset:17920
    v_cvt_pk_bf16_f32 v53, v26, v27
    v_exp_f32 v29, v29
    v_exp_f32 v30, v30
    v_exp_f32 v31, v31
    v_cvt_pk_bf16_f32 v54, v28, v29
    v_cvt_pk_bf16_f32 v55, v30, v31
    v_mfma_f32_32x32x16_bf16 v[16:31], v[88:91], v[8:11], v[72:87]
    s_setprio 0
    ds_read2st64_b64 v[92:95], v7 offset0:35 offset1:37
    v_exp_f32 v32, v32
    v_exp_f32 v33, v33
    v_exp_f32 v34, v34
    v_cvt_pk_bf16_f32 v48, v32, v33
    v_exp_f32 v35, v35
    v_exp_f32 v36, v36
    v_mfma_f32_32x32x16_bf16 v[56:71], v[100:103], v[52:55], v[56:71]
    s_waitcnt lgkmcnt(1)
    ds_read_b128 v[96:99], v4 offset:18368
    ds_read_b128 v[100:103], v4 offset:19024
    v_cvt_pk_bf16_f32 v49, v34, v35
    v_exp_f32 v37, v37
    v_exp_f32 v38, v38
    v_cvt_pk_bf16_f32 v50, v36, v37
    v_exp_f32 v39, v39
    v_exp_f32 v40, v40
    v_mfma_f32_32x32x8_bf16 v[16:31], v[112:113], v[12:13], v[16:31]
    v_cvt_pk_bf16_f32 v51, v38, v39
    v_exp_f32 v41, v41
    v_exp_f32 v42, v42
    v_cvt_pk_bf16_f32 v52, v40, v41
    v_exp_f32 v43, v43
    v_exp_f32 v44, v44
    v_mfma_f32_32x32x16_bf16 v[56:71], v[104:107], v[48:51], v[56:71]
    s_waitcnt lgkmcnt(2)
    v_cvt_pk_bf16_f32 v53, v42, v43
    v_exp_f32 v45, v45
    v_exp_f32 v46, v46
    v_exp_f32 v47, v47
    v_cvt_pk_bf16_f32 v54, v44, v45
    v_cvt_pk_bf16_f32 v55, v46, v47
    v_mfma_f32_32x32x16_bf16 v[32:47], v[92:95], v[8:11], v[72:87]
    s_barrier
    s_setprio 3
    ds_read2st64_b64 v[88:91], v6 offset0:0 offset1:2
    v_exp_f32 v16, v16
    v_exp_f32 v17, v17
    v_exp_f32 v18, v18
    v_cvt_pk_bf16_f32 v48, v16, v17
    v_exp_f32 v19, v19
    v_exp_f32 v20, v20
    v_mfma_f32_32x32x16_bf16 v[56:71], v[108:111], v[52:55], v[56:71]
    s_waitcnt lgkmcnt(1)
    ds_read_b128 v[104:107], v4 offset:19680
    ds_read_b128 v[108:111], v4 offset:20336
    v_cvt_pk_bf16_f32 v49, v18, v19
    v_exp_f32 v21, v21
    v_exp_f32 v22, v22
    v_cvt_pk_bf16_f32 v50, v20, v21
    v_exp_f32 v23, v23
    v_exp_f32 v24, v24
    v_mfma_f32_32x32x8_bf16 v[32:47], v[112:113], v[14:15], v[32:47]
    v_cvt_pk_bf16_f32 v51, v22, v23
    v_exp_f32 v25, v25
    v_exp_f32 v26, v26
    v_cvt_pk_bf16_f32 v52, v24, v25
    v_exp_f32 v27, v27
    v_exp_f32 v28, v28
    v_mfma_f32_32x32x16_bf16 v[56:71], v[96:99], v[48:51], v[56:71]
    s_waitcnt lgkmcnt(2)
    ds_read_b64 v[112:113], v5 offset:0
    v_cvt_pk_bf16_f32 v53, v26, v27
    v_exp_f32 v29, v29
    v_exp_f32 v30, v30
    v_exp_f32 v31, v31
    v_cvt_pk_bf16_f32 v54, v28, v29
    v_cvt_pk_bf16_f32 v55, v30, v31
    v_mfma_f32_32x32x16_bf16 v[16:31], v[88:91], v[8:11], v[72:87]
    s_setprio 2
    ds_read2st64_b64 v[92:95], v7 offset0:0 offset1:2
    v_exp_f32 v32, v32
    v_exp_f32 v33, v33
    v_exp_f32 v34, v34
    v_cvt_pk_bf16_f32 v48, v32, v33
    v_exp_f32 v35, v35
    v_exp_f32 v36, v36
    v_mfma_f32_32x32x16_bf16 v[56:71], v[100:103], v[52:55], v[56:71]
    s_waitcnt lgkmcnt(1)
    ds_read_b128 v[96:99], v4 offset:0
    ds_read_b128 v[100:103], v4 offset:656
    v_cvt_pk_bf16_f32 v49, v34, v35
    v_exp_f32 v37, v37
    v_exp_f32 v38, v38
    v_cvt_pk_bf16_f32 v50, v36, v37
    v_exp_f32 v39, v39
    v_exp_f32 v40, v40
    v_mfma_f32_32x32x8_bf16 v[16:31], v[112:113], v[12:13], v[16:31]
    v_cvt_pk_bf16_f32 v51, v38, v39
    v_exp_f32 v41, v41
    v_exp_f32 v42, v42
    v_cvt_pk_bf16_f32 v52, v40, v41
    v_exp_f32 v43, v43
    v_exp_f32 v44, v44
    v_mfma_f32_32x32x16_bf16 v[56:71], v[104:107], v[48:51], v[56:71]
    s_waitcnt lgkmcnt(2)
    s_sub_u32 s40, s40, 1
    s_cmp_lg_u32 s40, 0
    v_cvt_pk_bf16_f32 v53, v42, v43
    v_exp_f32 v45, v45
    v_exp_f32 v46, v46
    v_exp_f32 v47, v47
    v_cvt_pk_bf16_f32 v54, v44, v45
    v_cvt_pk_bf16_f32 v55, v46, v47
    s_cbranch_scc1 L_at_loop
    s_nop 0
    v_mfma_f32_32x32x16_bf16 v[56:71], v[108:111], v[52:55], v[56:71]
    s_mov_b32 s42, 0
    s_waitcnt lgkmcnt(0)
L_at_fin:
    s_lshl_b32 s34, s32, 3
    s_add_u32 s34, s34, s28
    s_mul_i32 s34, s34, 40960
    s_add_u32 s34, s34, 14942208
    s_lshl_b32 s35, s31, 10
    s_add_u32 s35, s35, s34
    s_lshl_b32 s36, s31, 8
    s_add_u32 s36, s36, s34
    s_add_u32 s36, s36, 32768
    s_mov_b32 s37, 0xc800000
    s_nop 1
    v_mov_b32 v114, v64
    v_mov_b32 v116, v64
    v_lshlrev_b32 v1, 4, v0
    v_lshlrev_b32 v118, 3, v0
    v_permlane32_swap_b32 v116, v114
    v_add_f32 v115, |v56|, |v57|
    v_add_f32 v117, |v64|, |v65|
    v_rcp_f32 v114, v114
    v_add_f32 v115, v115, |v58|
    v_mul_f32 v16, v56, v114
    v_mul_f32 v17, v57, v114
    v_mul_f32 v18, v58, v114
    v_mul_f32 v19, v59, v114
    v_mul_f32 v20, v60, v114
    v_mul_f32 v21, v61, v114
    v_mul_f32 v22, v62, v114
    v_mul_f32 v23, v63, v114
    v_cvt_pk_bf16_f32 v16, v16, v17
    v_cvt_pk_bf16_f32 v17, v18, v19
    v_cvt_pk_bf16_f32 v18, v20, v21
    v_cvt_pk_bf16_f32 v19, v22, v23
    buffer_store_dwordx4 v[16:19], v1, s[24:27], s35 offen sc1
    v_mul_f32 v24, v64, v114
    v_mul_f32 v25, v65, v114
    v_mul_f32 v26, v66, v114
    v_mul_f32 v27, v67, v114
    v_cvt_pk_bf16_f32 v24, v24, v25
    v_cvt_pk_bf16_f32 v25, v26, v27
    s_mov_b32 exec_hi, 0
    buffer_store_dwordx2 v[24:25], v118, s[24:27], s36 offen sc1
    s_mov_b32 exec_hi, -1
    s_setprio 0
    v_add_f32 v115, v115, |v59|
    v_add_f32 v115, v115, |v60|
    v_add_f32 v115, v115, |v61|
    v_add_f32 v115, v115, |v62|
    v_add_f32 v115, v115, |v63|
    v_add_f32 v117, v117, |v66|
    v_add_f32 v117, v117, |v67|
    v_add_f32 v117, v117, v115
    v_cmp_ngt_f32 vcc, 0x7b800000, v117
    v_cmp_gt_f32 s[46:47], s37, v115
    s_nop 1
    s_or_b64 s[46:47], s[46:47], vcc
    s_cmp_eq_u32 s42, 0
    s_cselect_b64 s[46:47], s[46:47], 0
    s_cmp_lg_u64 s[46:47], 0
    s_cbranch_scc1 L_at_slow
    s_lshl_b32 s34, s32, 3
    s_add_u32 s34, s34, s28
    s_lshl_b32 s34, s34, 12
    s_lshr_b32 s35, s31, 2
    s_lshl_b32 s35, s35, 7
    s_add_u32 s34, s34, s35
    s_and_b32 s35, s31, 3
    s_lshl_b32 s35, s35, 2
    s_add_u32 s34, s34, s35
    s_add_u32 s34, s34, 17825792
    v_mov_b32 v1, s33
    v_mov_b32 v2, 0
    s_mov_b64 exec, 1
    s_waitcnt vmcnt(0)
    buffer_store_dword v1, v2, s[24:27], s34 offen sc1
    s_endpgm
L_at_slow:
    v_min_u32 v1, 19, v3
    v_lshlrev_b32 v1, 4, v1
    v_mul_u32_u24 v118, 320, v2
    v_add_u32 v118, v1, v118
    v_lshlrev_b32 v121, 3, v0
    v_mov_b32 v114, 0xff800000
    s_mov_b32 s40, 0
L_at_slow_max:
    s_lshr_b32 s34, s40, 1
    s_mul_i32 s34, s34, 10240
    s_and_b32 s35, s40, 1
    s_mul_i32 s35, s35, 2560
    s_add_u32 s34, s34, s35
    s_add_u32 s34, s34, s41
    s_add_u32 s35, s34, 5120
    buffer_load_dwordx2 v[88:89], v120, s[24:27], s34 offen offset:0 sc1
    buffer_load_dwordx2 v[90:91], v120, s[24:27], s34 offen offset:1024 sc1
    buffer_load_dwordx2 v[92:93], v120, s[24:27], s34 offen offset:256 sc1
    buffer_load_dwordx2 v[94:95], v120, s[24:27], s34 offen offset:1280 sc1
    buffer_load_dwordx2 v[112:113], v121, s[24:27], s34 offen offset:2048 sc1
    s_waitcnt vmcnt(0)
    v_mfma_f32_32x32x16_bf16 v[16:31], v[88:91], v[8:11], 0
    v_mfma_f32_32x32x16_bf16 v[32:47], v[92:95], v[8:11], 0
    v_mfma_f32_32x32x8_bf16 v[16:31], v[112:113], v[12:13], v[16:31]
    v_mfma_f32_32x32x8_bf16 v[32:47], v[112:113], v[14:15], v[32:47]
    s_nop 12
    v_max3_f32 v114, v114, v16, v32
    v_max3_f32 v114, v114, v17, v33
    v_max3_f32 v114, v114, v18, v34
    v_max3_f32 v114, v114, v19, v35
    v_max3_f32 v114, v114, v20, v36
    v_max3_f32 v114, v114, v21, v37
    v_max3_f32 v114, v114, v22, v38
    v_max3_f32 v114, v114, v23, v39
    v_max3_f32 v114, v114, v24, v40
    v_max3_f32 v114, v114, v25, v41
    v_max3_f32 v114, v114, v26, v42
    v_max3_f32 v114, v114, v27, v43
    v_max3_f32 v114, v114, v28, v44
    v_max3_f32 v114, v114, v29, v45
    v_max3_f32 v114, v114, v30, v46
    v_max3_f32 v114, v114, v31, v47
    s_add_u32 s40, s40, 1
    s_cmp_lt_u32 s40, 32
    s_cbranch_scc1 L_at_slow_max
    v_mov_b32 v115, v114
    s_nop 1
    v_permlane32_swap_b32 v114, v115
    s_nop 1
    v_max_f32 v114, v114, v115
    v_sub_f32 v72, 0, v114
    v_mov_b32 v56, 0
    v_sub_f32 v73, 0, v114
    v_mov_b32 v57, 0
    v_sub_f32 v74, 0, v114
    v_mov_b32 v58, 0
    v_sub_f32 v75, 0, v114
    v_mov_b32 v59, 0
    v_sub_f32 v76, 0, v114
    v_mov_b32 v60, 0
    v_sub_f32 v77, 0, v114
    v_mov_b32 v61, 0
    v_sub_f32 v78, 0, v114
    v_mov_b32 v62, 0
    v_sub_f32 v79, 0, v114
    v_mov_b32 v63, 0
    v_sub_f32 v80, 0, v114
    v_mov_b32 v64, 0
    v_sub_f32 v81, 0, v114
    v_mov_b32 v65, 0
    v_sub_f32 v82, 0, v114
    v_mov_b32 v66, 0
    v_sub_f32 v83, 0, v114
    v_mov_b32 v67, 0
    v_sub_f32 v84, 0, v114
    v_mov_b32 v68, 0
    v_sub_f32 v85, 0, v114
    v_mov_b32 v69, 0
    v_sub_f32 v86, 0, v114
    v_mov_b32 v70, 0
    v_sub_f32 v87, 0, v114
    v_mov_b32 v71, 0
    v_cmp_eq_u32 s[48:49], 20, v3
    v_mov_b32 v119, 0x3f803f80
    s_mov_b32 s40, 0
L_at_slow_pv:
    s_lshr_b32 s34, s40, 1
    s_mul_i32 s34, s34, 10240
    s_and_b32 s35, s40, 1
    s_mul_i32 s35, s35, 2560
    s_add_u32 s34, s34, s35
    s_add_u32 s34, s34, s41
    s_add_u32 s35, s34, 5120
    buffer_load_dwordx2 v[88:89], v120, s[24:27], s34 offen offset:0 sc1
    buffer_load_dwordx2 v[90:91], v120, s[24:27], s34 offen offset:1024 sc1
    buffer_load_dwordx2 v[92:93], v120, s[24:27], s34 offen offset:256 sc1
    buffer_load_dwordx2 v[94:95], v120, s[24:27], s34 offen offset:1280 sc1
    buffer_load_dwordx2 v[112:113], v121, s[24:27], s34 offen offset:2048 sc1
    buffer_load_dwordx4 v[96:99], v118, s[24:27], s35 offen offset:0 sc1
    buffer_load_dwordx4 v[100:103], v118, s[24:27], s35 offen offset:640 sc1
    buffer_load_dwordx4 v[104:107], v118, s[24:27], s35 offen offset:1280 sc1
    buffer_load_dwordx4 v[108:111], v118, s[24:27], s35 offen offset:1920 sc1
    s_waitcnt vmcnt(0)
    v_mfma_f32_32x32x16_bf16 v[16:31], v[88:91], v[8:11], v[72:87]
    v_mfma_f32_32x32x16_bf16 v[32:47], v[92:95], v[8:11], v[72:87]
    v_mfma_f32_32x32x8_bf16 v[16:31], v[112:113], v[12:13], v[16:31]
    v_mfma_f32_32x32x8_bf16 v[32:47], v[112:113], v[14:15], v[32:47]
    v_cndmask_b32 v96, v96, v119, s[48:49]
    v_cndmask_b32 v97, v97, v119, s[48:49]
    v_cndmask_b32 v98, v98, v119, s[48:49]
    v_cndmask_b32 v99, v99, v119, s[48:49]
    v_cndmask_b32 v100, v100, v119, s[48:49]
    v_cndmask_b32 v101, v101, v119, s[48:49]
    v_cndmask_b32 v102, v102, v119, s[48:49]
    v_cndmask_b32 v103, v103, v119, s[48:49]
    v_cndmask_b32 v104, v104, v119, s[48:49]
    v_cndmask_b32 v105, v105, v119, s[48:49]
    v_cndmask_b32 v106, v106, v119, s[48:49]
    v_cndmask_b32 v107, v107, v119, s[48:49]
    v_cndmask_b32 v108, v108, v119, s[48:49]
    v_cndmask_b32 v109, v109, v119, s[48:49]
    v_cndmask_b32 v110, v110, v119, s[48:49]
    v_cndmask_b32 v111, v111, v119, s[48:49]
    v_exp_f32 v16, v16
    v_exp_f32 v17, v17
    v_exp_f32 v18, v18
    v_exp_f32 v19, v19
    v_exp_f32 v20, v20
    v_exp_f32 v21, v21
    v_exp_f32 v22, v22
    v_exp_f32 v23, v23
    v_exp_f32 v24, v24
    v_exp_f32 v25, v25
    v_exp_f32 v26, v26
    v_exp_f32 v27, v27
    v_exp_f32 v28, v28
    v_exp_f32 v29, v29
    v_exp_f32 v30, v30
    v_exp_f32 v31, v31
    s_nop 0
    v_cvt_pk_bf16_f32 v48, v16, v17
    v_cvt_pk_bf16_f32 v49, v18, v19
    v_cvt_pk_bf16_f32 v50, v20, v21
    v_cvt_pk_bf16_f32 v51, v22, v23
    v_cvt_pk_bf16_f32 v52, v24, v25
    v_cvt_pk_bf16_f32 v53, v26, v27
    v_cvt_pk_bf16_f32 v54, v28, v29
    v_cvt_pk_bf16_f32 v55, v30, v31
    s_nop 1
    v_mfma_f32_32x32x16_bf16 v[56:71], v[96:99], v[48:51], v[56:71]
    v_mfma_f32_32x32x16_bf16 v[56:71], v[100:103], v[52:55], v[56:71]
    v_exp_f32 v32, v32
    v_exp_f32 v33, v33
    v_exp_f32 v34, v34
    v_exp_f32 v35, v35
    v_exp_f32 v36, v36
    v_exp_f32 v37, v37
    v_exp_f32 v38, v38
    v_exp_f32 v39, v39
    v_exp_f32 v40, v40
    v_exp_f32 v41, v41
    v_exp_f32 v42, v42
    v_exp_f32 v43, v43
    v_exp_f32 v44, v44
    v_exp_f32 v45, v45
    v_exp_f32 v46, v46
    v_exp_f32 v47, v47
    s_nop 0
    v_cvt_pk_bf16_f32 v48, v32, v33
    v_cvt_pk_bf16_f32 v49, v34, v35
    v_cvt_pk_bf16_f32 v50, v36, v37
    v_cvt_pk_bf16_f32 v51, v38, v39
    v_cvt_pk_bf16_f32 v52, v40, v41
    v_cvt_pk_bf16_f32 v53, v42, v43
    v_cvt_pk_bf16_f32 v54, v44, v45
    v_cvt_pk_bf16_f32 v55, v46, v47
    s_nop 1
    v_mfma_f32_32x32x16_bf16 v[56:71], v[104:107], v[48:51], v[56:71]
    v_mfma_f32_32x32x16_bf16 v[56:71], v[108:111], v[52:55], v[56:71]
    s_add_u32 s40, s40, 1
    s_cmp_lt_u32 s40, 32
    s_cbranch_scc1 L_at_slow_pv
    s_mov_b32 s42, 1
    s_branch L_at_fin
L_z_sum:
    s_waitcnt vmcnt(8)
    s_barrier
    s_add_u32 m0, s44, 32768
    s_cmp_ge_u32 s47, 8
    s_cselect_b32 s34, 2457600, 0
    s_sub_u32 s34, s42, s34
    s_add_u32 s34, s34, 491520
    buffer_load_dwordx4 v12, s[52:55], s34 offen offset:0 lds
    buffer_load_dwordx4 v13, s[52:55], s34 offen offset:1024 lds
    buffer_load_dwordx4 v14, s[52:55], s34 offen offset:2048 lds
    buffer_load_dwordx4 v15, s[52:55], s34 offen offset:3072 lds
    s_add_u32 m0, s44, 49152
    s_cmp_ge_u32 s47, 7
    s_cselect_b32 s34, 2457600, 0
    s_sub_u32 s34, s42, s34
    s_add_u32 s34, s34, 737280
    buffer_load_dwordx4 v12, s[52:55], s34 offen offset:0 lds
    buffer_load_dwordx4 v13, s[52:55], s34 offen offset:1024 lds
    buffer_load_dwordx4 v14, s[52:55], s34 offen offset:2048 lds
    buffer_load_dwordx4 v15, s[52:55], s34 offen offset:3072 lds
    s_waitcnt vmcnt(8)
    s_barrier
    s_add_u32 m0, s44, 0
    s_cmp_ge_u32 s47, 6
    s_cselect_b32 s34, 2457600, 0
    s_sub_u32 s34, s42, s34
    s_add_u32 s34, s34, 983040
    buffer_load_dwordx4 v12, s[52:55], s34 offen offset:0 lds
    buffer_load_dwordx4 v13, s[52:55], s34 offen offset:1024 lds
    buffer_load_dwordx4 v14, s[52:55], s34 offen offset:2048 lds
    buffer_load_dwordx4 v15, s[52:55], s34 offen offset:3072 lds
    s_waitcnt vmcnt(8)
    s_barrier
    s_add_u32 m0, s44, 16384
    s_cmp_ge_u32 s47, 5
    s_cselect_b32 s34, 2457600, 0
    s_sub_u32 s34, s42, s34
    s_add_u32 s34, s34, 1228800
    buffer_load_dwordx4 v12, s[52:55], s34 offen offset:0 lds
    buffer_load_dwordx4 v13, s[52:55], s34 offen offset:1024 lds
    buffer_load_dwordx4 v14, s[52:55], s34 offen offset:2048 lds
    buffer_load_dwordx4 v15, s[52:55], s34 offen offset:3072 lds
    s_waitcnt vmcnt(8)
    s_barrier
    s_add_u32 m0, s44, 32768
    s_cmp_ge_u32 s47, 4
    s_cselect_b32 s34, 2457600, 0
    s_sub_u32 s34, s42, s34
    s_add_u32 s34, s34, 1474560
    buffer_load_dwordx4 v12, s[52:55], s34 offen offset:0 lds
    buffer_load_dwordx4 v13, s[52:55], s34 offen offset:1024 lds
    buffer_load_dwordx4 v14, s[52:55], s34 offen offset:2048 lds
    buffer_load_dwordx4 v15, s[52:55], s34 offen offset:3072 lds
    s_waitcnt vmcnt(8)
    s_barrier
    s_add_u32 m0, s44, 49152
    s_cmp_ge_u32 s47, 3
    s_cselect_b32 s34, 2457600, 0
    s_sub_u32 s34, s42, s34
    s_add_u32 s34, s34, 1720320
    buffer_load_dwordx4 v12, s[52:55], s34 offen offset:0 lds
    buffer_load_dwordx4 v13, s[52:55], s34 offen offset:1024 lds
    buffer_load_dwordx4 v14, s[52:55], s34 offen offset:2048 lds
    buffer_load_dwordx4 v15, s[52:55], s34 offen offset:3072 lds
    s_waitcnt vmcnt(8)
    s_barrier
    s_add_u32 m0, s44, 0
    s_cmp_ge_u32 s47, 2
    s_cselect_b32 s34, 2457600, 0
    s_sub_u32 s34, s42, s34
    s_add_u32 s34, s34, 1966080
    buffer_load_dwordx4 v12, s[52:55], s34 offen offset:0 lds
    buffer_load_dwordx4 v13, s[52:55], s34 offen offset:1024 lds
    buffer_load_dwordx4 v14, s[52:55], s34 offen offset:2048 lds
    buffer_load_dwordx4 v15, s[52:55], s34 offen offset:3072 lds
    s_waitcnt vmcnt(8)
    s_barrier
    s_add_u32 m0, s44, 16384
    s_cmp_ge_u32 s47, 1
    s_cselect_b32 s34, 2457600, 0
    s_sub_u32 s34, s42, s34
    s_add_u32 s34, s34, 2211840
    buffer_load_dwordx4 v12, s[52:55], s34 offen offset:0 lds
    buffer_load_dwordx4 v13, s[52:55], s34 offen offset:1024 lds
    buffer_load_dwordx4 v14, s[52:55], s34 offen offset:2048 lds
    buffer_load_dwordx4 v15, s[52:55], s34 offen offset:3072 lds
    s_waitcnt vmcnt(8)
    s_barrier
    s_add_u32 m0, s44, 32768
    s_mov_b32 s34, s46
    buffer_load_dwordx4 v16, s[56:59], s34 offen offset:0 lds
    buffer_load_dwordx4 v17, s[56:59], s34 offen offset:1024 lds
    buffer_load_dwordx4 v18, s[56:59], s34 offen offset:2048 lds
    buffer_load_dwordx4 v19, s[56:59], s34 offen offset:3072 lds
    s_waitcnt vmcnt(8)
    s_barrier
    s_add_u32 m0, s44, 49152
    s_cmp_ge_u32 s47, 9
    s_cselect_b32 s34, 2211840, 0
    s_sub_u32 s34, s46, s34
    s_add_u32 s34, s34, 221184
    buffer_load_dwordx4 v16, s[56:59], s34 offen offset:0 lds
    buffer_load_dwordx4 v17, s[56:59], s34 offen offset:1024 lds
    buffer_load_dwordx4 v18, s[56:59], s34 offen offset:2048 lds
    buffer_load_dwordx4 v19, s[56:59], s34 offen offset:3072 lds
    s_waitcnt vmcnt(8)
    s_barrier
    s_add_u32 m0, s44, 0
    s_cmp_ge_u32 s47, 8
    s_cselect_b32 s34, 2211840, 0
    s_sub_u32 s34, s46, s34
    s_add_u32 s34, s34, 442368
    buffer_load_dwordx4 v16, s[56:59], s34 offen offset:0 lds
    buffer_load_dwordx4 v17, s[56:59], s34 offen offset:1024 lds
    buffer_load_dwordx4 v18, s[56:59], s34 offen offset:2048 lds
    buffer_load_dwordx4 v19, s[56:59], s34 offen offset:3072 lds
    s_waitcnt vmcnt(8)
    s_barrier
    s_add_u32 m0, s44, 16384
    s_cmp_ge_u32 s47, 7
    s_cselect_b32 s34, 2211840, 0
    s_sub_u32 s34, s46, s34
    s_add_u32 s34, s34, 663552
    buffer_load_dwordx4 v16, s[56:59], s34 offen offset:0 lds
    buffer_load_dwordx4 v17, s[56:59], s34 offen offset:1024 lds
    buffer_load_dwordx4 v18, s[56:59], s34 offen offset:2048 lds
    buffer_load_dwordx4 v19, s[56:59], s34 offen offset:3072 lds
    s_waitcnt vmcnt(8)
    s_barrier
    s_add_u32 m0, s44, 32768
    s_cmp_ge_u32 s47, 6
    s_cselect_b32 s34, 2211840, 0
    s_sub_u32 s34, s46, s34
    s_add_u32 s34, s34, 884736
    buffer_load_dwordx4 v16, s[56:59], s34 offen offset:0 lds
    buffer_load_dwordx4 v17, s[56:59], s34 offen offset:1024 lds
    buffer_load_dwordx4 v18, s[56:59], s34 offen offset:2048 lds
    buffer_load_dwordx4 v19, s[56:59], s34 offen offset:3072 lds
    s_waitcnt vmcnt(8)
    s_barrier
    s_add_u32 m0, s44, 49152
    s_cmp_ge_u32 s47, 5
    s_cselect_b32 s34, 2211840, 0
    s_sub_u32 s34, s46, s34
    s_add_u32 s34, s34, 1105920
    buffer_load_dwordx4 v16, s[56:59], s34 offen offset:0 lds
    buffer_load_dwordx4 v17, s[56:59], s34 offen offset:1024 lds
    buffer_load_dwordx4 v18, s[56:59], s34 offen offset:2048 lds
    buffer_load_dwordx4 v19, s[56:59], s34 offen offset:3072 lds
    s_waitcnt vmcnt(0)
    s_barrier
    s_add_u32 m0, s44, 0
    s_cmp_ge_u32 s47, 4
    s_cselect_b32 s34, 2211840, 0
    s_sub_u32 s34, s46, s34
    s_add_u32 s34, s34, 1327104
    buffer_load_dwordx4 v16, s[56:59], s34 offen offset:0 lds
    buffer_load_dwordx4 v17, s[56:59], s34 offen offset:1024 lds
    buffer_load_dwordx4 v18, s[56:59], s34 offen offset:2048 lds
    buffer_load_dwordx4 v19, s[56:59], s34 offen offset:3072 lds
    s_waitcnt vmcnt(0)
    s_barrier
    s_add_u32 m0, s44, 16384
    s_cmp_ge_u32 s47, 3
    s_cselect_b32 s34, 2211840, 0
    s_sub_u32 s34, s46, s34
    s_add_u32 s34, s34, 1548288
    buffer_load_dwordx4 v16, s[56:59], s34 offen offset:0 lds
    buffer_load_dwordx4 v17, s[56:59], s34 offen offset:1024 lds
    buffer_load_dwordx4 v18, s[56:59], s34 offen offset:2048 lds
    buffer_load_dwordx4 v19, s[56:59], s34 offen offset:3072 lds
    s_add_u32 m0, s44, 32768
    s_cmp_ge_u32 s47, 2
    s_cselect_b32 s34, 2211840, 0
    s_sub_u32 s34, s46, s34
    s_add_u32 s34, s34, 1769472
    buffer_load_dwordx4 v16, s[56:59], s34 offen offset:0 lds
    buffer_load_dwordx4 v17, s[56:59], s34 offen offset:1024 lds
    buffer_load_dwordx4 v18, s[56:59], s34 offen offset:2048 lds
    buffer_load_dwordx4 v19, s[56:59], s34 offen offset:3072 lds
    s_add_u32 m0, s44, 49152
    s_cmp_ge_u32 s47, 1
    s_cselect_b32 s34, 2211840, 0
    s_sub_u32 s34, s46, s34
    s_add_u32 s34, s34, 1990656
    buffer_load_dwordx4 v16, s[56:59], s34 offen offset:0 lds
    buffer_load_dwordx4 v17, s[56:59], s34 offen offset:1024 lds
    buffer_load_dwordx4 v18, s[56:59], s34 offen offset:2048 lds
    buffer_load_dwordx4 v19, s[56:59], s34 offen offset:3072 lds
    s_waitcnt vmcnt(8)
    s_barrier
    s_waitcnt vmcnt(4)
    s_barrier
    s_waitcnt vmcnt(0)
    s_branch L_attn_z
L_x_idle:
    v_cmp_eq_u32 vcc, 0, v3
    v_cmp_eq_u32 s[46:47], 20, v3
    v_mov_b32 v1, 0x3f803f80
    s_nop 0
    s_or_b64 vcc, vcc, s[46:47]
    s_nop 1
    v_cndmask_b32 v42, 0, v1, vcc
    v_cndmask_b32 v43, 0, v1, vcc
    v_cndmask_b32 v44, 0, v1, vcc
    v_cndmask_b32 v45, 0, v1, vcc
    s_barrier
    ds_read_b64_tr_b16 v[26:27], v8 offset:0
    ds_read_b64_tr_b16 v[28:29], v8 offset:1024
    ds_read_b64_tr_b16 v[30:31], v8 offset:4096
    ds_read_b64_tr_b16 v[32:33], v8 offset:5120
    ds_read_b64_tr_b16 v[34:35], v8 offset:8192
    ds_read_b64_tr_b16 v[36:37], v8 offset:9216
    ds_read_b64_tr_b16 v[38:39], v8 offset:12288
    ds_read_b64_tr_b16 v[40:41], v8 offset:13312
    s_waitcnt lgkmcnt(6)
    v_mfma_f32_16x16x32_bf16 v[46:49], v[42:45], v[26:29], v[46:49]
    s_waitcnt lgkmcnt(4)
    v_mfma_f32_16x16x32_bf16 v[46:49], v[42:45], v[30:33], v[46:49]
    s_waitcnt lgkmcnt(2)
    v_mfma_f32_16x16x32_bf16 v[46:49], v[42:45], v[34:37], v[46:49]
    s_waitcnt lgkmcnt(0)
    v_mfma_f32_16x16x32_bf16 v[46:49], v[42:45], v[38:41], v[46:49]
    s_barrier
    ds_read_b64_tr_b16 v[26:27], v8 offset:16384
    ds_read_b64_tr_b16 v[28:29], v8 offset:17408
    ds_read_b64_tr_b16 v[30:31], v8 offset:20480
    ds_read_b64_tr_b16 v[32:33], v8 offset:21504
    ds_read_b64_tr_b16 v[34:35], v8 offset:24576
    ds_read_b64_tr_b16 v[36:37], v8 offset:25600
    ds_read_b64_tr_b16 v[38:39], v8 offset:28672
    ds_read_b64_tr_b16 v[40:41], v8 offset:29696
    s_waitcnt lgkmcnt(6)
    v_mfma_f32_16x16x32_bf16 v[46:49], v[42:45], v[26:29], v[46:49]
    s_waitcnt lgkmcnt(4)
    v_mfma_f32_16x16x32_bf16 v[46:49], v[42:45], v[30:33], v[46:49]
    s_waitcnt lgkmcnt(2)
    v_mfma_f32_16x16x32_bf16 v[46:49], v[42:45], v[34:37], v[46:49]
    s_waitcnt lgkmcnt(0)
    v_mfma_f32_16x16x32_bf16 v[46:49], v[42:45], v[38:41], v[46:49]
    s_barrier
    ds_read_b64_tr_b16 v[26:27], v8 offset:32768
    ds_read_b64_tr_b16 v[28:29], v8 offset:33792
    ds_read_b64_tr_b16 v[30:31], v8 offset:36864
    ds_read_b64_tr_b16 v[32:33], v8 offset:37888
    ds_read_b64_tr_b16 v[34:35], v8 offset:40960
    ds_read_b64_tr_b16 v[36:37], v8 offset:41984
    ds_read_b64_tr_b16 v[38:39], v8 offset:45056
    ds_read_b64_tr_b16 v[40:41], v8 offset:46080
    s_waitcnt lgkmcnt(6)
    v_mfma_f32_16x16x32_bf16 v[46:49], v[42:45], v[26:29], v[46:49]
    s_waitcnt lgkmcnt(4)
    v_mfma_f32_16x16x32_bf16 v[46:49], v[42:45], v[30:33], v[46:49]
    s_waitcnt lgkmcnt(2)
    v_mfma_f32_16x16x32_bf16 v[46:49], v[42:45], v[34:37], v[46:49]
    s_waitcnt lgkmcnt(0)
    v_mfma_f32_16x16x32_bf16 v[46:49], v[42:45], v[38:41], v[46:49]
    s_barrier
    ds_read_b64_tr_b16 v[26:27], v8 offset:49152
    ds_read_b64_tr_b16 v[28:29], v8 offset:50176
    ds_read_b64_tr_b16 v[30:31], v8 offset:53248
    ds_read_b64_tr_b16 v[32:33], v8 offset:54272
    ds_read_b64_tr_b16 v[34:35], v8 offset:57344
    ds_read_b64_tr_b16 v[36:37], v8 offset:58368
    ds_read_b64_tr_b16 v[38:39], v8 offset:61440
    ds_read_b64_tr_b16 v[40:41], v8 offset:62464
    s_waitcnt lgkmcnt(6)
    v_mfma_f32_16x16x32_bf16 v[46:49], v[42:45], v[26:29], v[46:49]
    s_waitcnt lgkmcnt(4)
    v_mfma_f32_16x16x32_bf16 v[46:49], v[42:45], v[30:33], v[46:49]
    s_waitcnt lgkmcnt(2)
    v_mfma_f32_16x16x32_bf16 v[46:49], v[42:45], v[34:37], v[46:49]
    s_waitcnt lgkmcnt(0)
    v_mfma_f32_16x16x32_bf16 v[46:49], v[42:45], v[38:41], v[46:49]
    s_barrier
    ds_read_b64_tr_b16 v[26:27], v8 offset:0
    ds_read_b64_tr_b16 v[28:29], v8 offset:1024
    ds_read_b64_tr_b16 v[30:31], v8 offset:4096
    ds_read_b64_tr_b16 v[32:33], v8 offset:5120
    ds_read_b64_tr_b16 v[34:35], v8 offset:8192
    ds_read_b64_tr_b16 v[36:37], v8 offset:9216
    ds_read_b64_tr_b16 v[38:39], v8 offset:12288
    ds_read_b64_tr_b16 v[40:41], v8 offset:13312
    s_waitcnt lgkmcnt(6)
    v_mfma_f32_16x16x32_bf16 v[46:49], v[42:45], v[26:29], v[46:49]
    s_waitcnt lgkmcnt(4)
    v_mfma_f32_16x16x32_bf16 v[46:49], v[42:45], v[30:33], v[46:49]
    s_waitcnt lgkmcnt(2)
    v_mfma_f32_16x16x32_bf16 v[46:49], v[42:45], v[34:37], v[46:49]
    s_waitcnt lgkmcnt(0)
    v_mfma_f32_16x16x32_bf16 v[46:49], v[42:45], v[38:41], v[46:49]
    s_barrier
    ds_read_b64_tr_b16 v[26:27], v8 offset:16384
    ds_read_b64_tr_b16 v[28:29], v8 offset:17408
    ds_read_b64_tr_b16 v[30:31], v8 offset:20480
    ds_read_b64_tr_b16 v[32:33], v8 offset:21504
    ds_read_b64_tr_b16 v[34:35], v8 offset:24576
    ds_read_b64_tr_b16 v[36:37], v8 offset:25600
    ds_read_b64_tr_b16 v[38:39], v8 offset:28672
    ds_read_b64_tr_b16 v[40:41], v8 offset:29696
    s_waitcnt lgkmcnt(6)
    v_mfma_f32_16x16x32_bf16 v[46:49], v[42:45], v[26:29], v[46:49]
    s_waitcnt lgkmcnt(4)
    v_mfma_f32_16x16x32_bf16 v[46:49], v[42:45], v[30:33], v[46:49]
    s_waitcnt lgkmcnt(2)
    v_mfma_f32_16x16x32_bf16 v[46:49], v[42:45], v[34:37], v[46:49]
    s_waitcnt lgkmcnt(0)
    v_mfma_f32_16x16x32_bf16 v[46:49], v[42:45], v[38:41], v[46:49]
    s_barrier
    ds_read_b64_tr_b16 v[26:27], v8 offset:32768
    ds_read_b64_tr_b16 v[28:29], v8 offset:33792
    ds_read_b64_tr_b16 v[30:31], v8 offset:36864
    ds_read_b64_tr_b16 v[32:33], v8 offset:37888
    ds_read_b64_tr_b16 v[34:35], v8 offset:40960
    ds_read_b64_tr_b16 v[36:37], v8 offset:41984
    ds_read_b64_tr_b16 v[38:39], v8 offset:45056
    ds_read_b64_tr_b16 v[40:41], v8 offset:46080
    s_waitcnt lgkmcnt(6)
    v_mfma_f32_16x16x32_bf16 v[46:49], v[42:45], v[26:29], v[46:49]
    s_waitcnt lgkmcnt(4)
    v_mfma_f32_16x16x32_bf16 v[46:49], v[42:45], v[30:33], v[46:49]
    s_waitcnt lgkmcnt(2)
    v_mfma_f32_16x16x32_bf16 v[46:49], v[42:45], v[34:37], v[46:49]
    s_waitcnt lgkmcnt(0)
    v_mfma_f32_16x16x32_bf16 v[46:49], v[42:45], v[38:41], v[46:49]
    s_barrier
    ds_read_b64_tr_b16 v[26:27], v8 offset:49152
    ds_read_b64_tr_b16 v[28:29], v8 offset:50176
    ds_read_b64_tr_b16 v[30:31], v8 offset:53248
    ds_read_b64_tr_b16 v[32:33], v8 offset:54272
    ds_read_b64_tr_b16 v[34:35], v8 offset:57344
    ds_read_b64_tr_b16 v[36:37], v8 offset:58368
    ds_read_b64_tr_b16 v[38:39], v8 offset:61440
    ds_read_b64_tr_b16 v[40:41], v8 offset:62464
    s_waitcnt lgkmcnt(6)
    v_mfma_f32_16x16x32_bf16 v[46:49], v[42:45], v[26:29], v[46:49]
    s_waitcnt lgkmcnt(4)
    v_mfma_f32_16x16x32_bf16 v[46:49], v[42:45], v[30:33], v[46:49]
    s_waitcnt lgkmcnt(2)
    v_mfma_f32_16x16x32_bf16 v[46:49], v[42:45], v[34:37], v[46:49]
    s_waitcnt lgkmcnt(0)
    v_mfma_f32_16x16x32_bf16 v[46:49], v[42:45], v[38:41], v[46:49]
    s_barrier
    ds_read_b64_tr_b16 v[26:27], v8 offset:0
    ds_read_b64_tr_b16 v[28:29], v8 offset:1024
    ds_read_b64_tr_b16 v[30:31], v8 offset:4096
    ds_read_b64_tr_b16 v[32:33], v8 offset:5120
    ds_read_b64_tr_b16 v[34:35], v8 offset:8192
    ds_read_b64_tr_b16 v[36:37], v8 offset:9216
    ds_read_b64_tr_b16 v[38:39], v8 offset:12288
    ds_read_b64_tr_b16 v[40:41], v8 offset:13312
    s_waitcnt lgkmcnt(6)
    v_mfma_f32_16x16x32_bf16 v[46:49], v[42:45], v[26:29], v[46:49]
    s_waitcnt lgkmcnt(4)
    v_mfma_f32_16x16x32_bf16 v[46:49], v[42:45], v[30:33], v[46:49]
    s_waitcnt lgkmcnt(2)
    v_mfma_f32_16x16x32_bf16 v[46:49], v[42:45], v[34:37], v[46:49]
    s_waitcnt lgkmcnt(0)
    v_mfma_f32_16x16x32_bf16 v[46:49], v[42:45], v[38:41], v[46:49]
    s_barrier
    ds_read_b64_tr_b16 v[26:27], v8 offset:16384
    ds_read_b64_tr_b16 v[28:29], v8 offset:17408
    ds_read_b64_tr_b16 v[30:31], v8 offset:20480
    ds_read_b64_tr_b16 v[32:33], v8 offset:21504
    ds_read_b64_tr_b16 v[34:35], v8 offset:24576
    ds_read_b64_tr_b16 v[36:37], v8 offset:25600
    ds_read_b64_tr_b16 v[38:39], v8 offset:28672
    ds_read_b64_tr_b16 v[40:41], v8 offset:29696
    s_waitcnt lgkmcnt(6)
    v_mfma_f32_16x16x32_bf16 v[46:49], v[42:45], v[26:29], v[46:49]
    s_waitcnt lgkmcnt(4)
    v_mfma_f32_16x16x32_bf16 v[46:49], v[42:45], v[30:33], v[46:49]
    s_waitcnt lgkmcnt(2)
    v_mfma_f32_16x16x32_bf16 v[46:49], v[42:45], v[34:37], v[46:49]
    s_waitcnt lgkmcnt(0)
    v_mfma_f32_16x16x32_bf16 v[46:49], v[42:45], v[38:41], v[46:49]
    s_barrier
    v_mov_b32 v1, 160256
    ds_read_b32 v1, v1
    s_waitcnt lgkmcnt(0)
    v_readfirstlane_b32 s33, v1
    s_lshl_b32 s58, s29, 10
    s_add_u32 s58, s58, 17596416
    s_nop 5
    v_mov_b32 v47, s33
    s_mov_b32 exec_hi, 0
    buffer_store_dwordx2 v[46:47], v120, s[24:27], s58 offen sc1
    s_mov_b32 exec_hi, -1
    ds_read_b64_tr_b16 v[26:27], v8 offset:32768
    ds_read_b64_tr_b16 v[28:29], v8 offset:33792
    ds_read_b64_tr_b16 v[30:31], v8 offset:36864
    ds_read_b64_tr_b16 v[32:33], v8 offset:37888
    ds_read_b64_tr_b16 v[34:35], v8 offset:40960
    ds_read_b64_tr_b16 v[36:37], v8 offset:41984
    ds_read_b64_tr_b16 v[38:39], v8 offset:45056
    ds_read_b64_tr_b16 v[40:41], v8 offset:46080
    s_waitcnt lgkmcnt(6)
    v_mfma_f32_16x16x32_bf16 v[50:53], v[42:45], v[26:29], v[50:53]
    s_waitcnt lgkmcnt(4)
    v_mfma_f32_16x16x32_bf16 v[50:53], v[42:45], v[30:33], v[50:53]
    s_waitcnt lgkmcnt(2)
    v_mfma_f32_16x16x32_bf16 v[50:53], v[42:45], v[34:37], v[50:53]
    s_waitcnt lgkmcnt(0)
    v_mfma_f32_16x16x32_bf16 v[50:53], v[42:45], v[38:41], v[50:53]
    s_barrier
    ds_read_b64_tr_b16 v[26:27], v8 offset:49152
    ds_read_b64_tr_b16 v[28:29], v8 offset:50176
    ds_read_b64_tr_b16 v[30:31], v8 offset:53248
    ds_read_b64_tr_b16 v[32:33], v8 offset:54272
    ds_read_b64_tr_b16 v[34:35], v8 offset:57344
    ds_read_b64_tr_b16 v[36:37], v8 offset:58368
    ds_read_b64_tr_b16 v[38:39], v8 offset:61440
    ds_read_b64_tr_b16 v[40:41], v8 offset:62464
    s_waitcnt lgkmcnt(6)
    v_mfma_f32_16x16x32_bf16 v[50:53], v[42:45], v[26:29], v[50:53]
    s_waitcnt lgkmcnt(4)
    v_mfma_f32_16x16x32_bf16 v[50:53], v[42:45], v[30:33], v[50:53]
    s_waitcnt lgkmcnt(2)
    v_mfma_f32_16x16x32_bf16 v[50:53], v[42:45], v[34:37], v[50:53]
    s_waitcnt lgkmcnt(0)
    v_mfma_f32_16x16x32_bf16 v[50:53], v[42:45], v[38:41], v[50:53]
    s_barrier
    ds_read_b64_tr_b16 v[26:27], v8 offset:0
    ds_read_b64_tr_b16 v[28:29], v8 offset:1024
    ds_read_b64_tr_b16 v[30:31], v8 offset:4096
    ds_read_b64_tr_b16 v[32:33], v8 offset:5120
    ds_read_b64_tr_b16 v[34:35], v8 offset:8192
    ds_read_b64_tr_b16 v[36:37], v8 offset:9216
    ds_read_b64_tr_b16 v[38:39], v8 offset:12288
    ds_read_b64_tr_b16 v[40:41], v8 offset:13312
    s_waitcnt lgkmcnt(6)
    v_mfma_f32_16x16x32_bf16 v[50:53], v[42:45], v[26:29], v[50:53]
    s_waitcnt lgkmcnt(4)
    v_mfma_f32_16x16x32_bf16 v[50:53], v[42:45], v[30:33], v[50:53]
    s_waitcnt lgkmcnt(2)
    v_mfma_f32_16x16x32_bf16 v[50:53], v[42:45], v[34:37], v[50:53]
    s_waitcnt lgkmcnt(0)
    v_mfma_f32_16x16x32_bf16 v[50:53], v[42:45], v[38:41], v[50:53]
    s_barrier
    ds_read_b64_tr_b16 v[26:27], v8 offset:16384
    ds_read_b64_tr_b16 v[28:29], v8 offset:17408
    ds_read_b64_tr_b16 v[30:31], v8 offset:20480
    ds_read_b64_tr_b16 v[32:33], v8 offset:21504
    ds_read_b64_tr_b16 v[34:35], v8 offset:24576
    ds_read_b64_tr_b16 v[36:37], v8 offset:25600
    ds_read_b64_tr_b16 v[38:39], v8 offset:28672
    ds_read_b64_tr_b16 v[40:41], v8 offset:29696
    s_waitcnt lgkmcnt(6)
    v_mfma_f32_16x16x32_bf16 v[50:53], v[42:45], v[26:29], v[50:53]
    s_waitcnt lgkmcnt(4)
    v_mfma_f32_16x16x32_bf16 v[50:53], v[42:45], v[30:33], v[50:53]
    s_waitcnt lgkmcnt(2)
    v_mfma_f32_16x16x32_bf16 v[50:53], v[42:45], v[34:37], v[50:53]
    s_waitcnt lgkmcnt(0)
    v_mfma_f32_16x16x32_bf16 v[50:53], v[42:45], v[38:41], v[50:53]
    ds_read_b64_tr_b16 v[26:27], v8 offset:32768
    ds_read_b64_tr_b16 v[28:29], v8 offset:33792
    ds_read_b64_tr_b16 v[30:31], v8 offset:36864
    ds_read_b64_tr_b16 v[32:33], v8 offset:37888
    ds_read_b64_tr_b16 v[34:35], v8 offset:40960
    ds_read_b64_tr_b16 v[36:37], v8 offset:41984
    ds_read_b64_tr_b16 v[38:39], v8 offset:45056
    ds_read_b64_tr_b16 v[40:41], v8 offset:46080
    s_waitcnt lgkmcnt(6)
    v_mfma_f32_16x16x32_bf16 v[50:53], v[42:45], v[26:29], v[50:53]
    s_waitcnt lgkmcnt(4)
    v_mfma_f32_16x16x32_bf16 v[50:53], v[42:45], v[30:33], v[50:53]
    s_waitcnt lgkmcnt(2)
    v_mfma_f32_16x16x32_bf16 v[50:53], v[42:45], v[34:37], v[50:53]
    s_waitcnt lgkmcnt(0)
    v_mfma_f32_16x16x32_bf16 v[50:53], v[42:45], v[38:41], v[50:53]
    ds_read_b64_tr_b16 v[26:27], v8 offset:49152
    ds_read_b64_tr_b16 v[28:29], v8 offset:50176
    ds_read_b64_tr_b16 v[30:31], v8 offset:53248
    ds_read_b64_tr_b16 v[32:33], v8 offset:54272
    ds_read_b64_tr_b16 v[34:35], v8 offset:57344
    ds_read_b64_tr_b16 v[36:37], v8 offset:58368
    ds_read_b64_tr_b16 v[38:39], v8 offset:61440
    ds_read_b64_tr_b16 v[40:41], v8 offset:62464
    s_waitcnt lgkmcnt(6)
    v_mfma_f32_16x16x32_bf16 v[50:53], v[42:45], v[26:29], v[50:53]
    s_waitcnt lgkmcnt(4)
    v_mfma_f32_16x16x32_bf16 v[50:53], v[42:45], v[30:33], v[50:53]
    s_waitcnt lgkmcnt(2)
    v_mfma_f32_16x16x32_bf16 v[50:53], v[42:45], v[34:37], v[50:53]
    s_waitcnt lgkmcnt(0)
    v_mfma_f32_16x16x32_bf16 v[50:53], v[42:45], v[38:41], v[50:53]
    s_barrier
    ds_read_b64_tr_b16 v[26:27], v8 offset:0
    ds_read_b64_tr_b16 v[28:29], v8 offset:1024
    ds_read_b64_tr_b16 v[30:31], v8 offset:4096
    ds_read_b64_tr_b16 v[32:33], v8 offset:5120
    ds_read_b64_tr_b16 v[34:35], v8 offset:8192
    ds_read_b64_tr_b16 v[36:37], v8 offset:9216
    ds_read_b64_tr_b16 v[38:39], v8 offset:12288
    ds_read_b64_tr_b16 v[40:41], v8 offset:13312
    s_waitcnt lgkmcnt(6)
    v_mfma_f32_16x16x32_bf16 v[50:53], v[42:45], v[26:29], v[50:53]
    s_waitcnt lgkmcnt(4)
    v_mfma_f32_16x16x32_bf16 v[50:53], v[42:45], v[30:33], v[50:53]
    s_waitcnt lgkmcnt(2)
    v_mfma_f32_16x16x32_bf16 v[50:53], v[42:45], v[34:37], v[50:53]
    s_waitcnt lgkmcnt(0)
    v_mfma_f32_16x16x32_bf16 v[50:53], v[42:45], v[38:41], v[50:53]
    s_barrier
    ds_read_b64_tr_b16 v[26:27], v8 offset:16384
    ds_read_b64_tr_b16 v[28:29], v8 offset:17408
    ds_read_b64_tr_b16 v[30:31], v8 offset:20480
    ds_read_b64_tr_b16 v[32:33], v8 offset:21504
    ds_read_b64_tr_b16 v[34:35], v8 offset:24576
    ds_read_b64_tr_b16 v[36:37], v8 offset:25600
    ds_read_b64_tr_b16 v[38:39], v8 offset:28672
    ds_read_b64_tr_b16 v[40:41], v8 offset:29696
    s_waitcnt lgkmcnt(6)
    v_mfma_f32_16x16x32_bf16 v[50:53], v[42:45], v[26:29], v[50:53]
    s_waitcnt lgkmcnt(4)
    v_mfma_f32_16x16x32_bf16 v[50:53], v[42:45], v[30:33], v[50:53]
    s_waitcnt lgkmcnt(2)
    v_mfma_f32_16x16x32_bf16 v[50:53], v[42:45], v[34:37], v[50:53]
    s_waitcnt lgkmcnt(0)
    v_mfma_f32_16x16x32_bf16 v[50:53], v[42:45], v[38:41], v[50:53]
    s_barrier
    ds_read_b64_tr_b16 v[26:27], v8 offset:32768
    ds_read_b64_tr_b16 v[28:29], v8 offset:33792
    ds_read_b64_tr_b16 v[30:31], v8 offset:36864
    ds_read_b64_tr_b16 v[32:33], v8 offset:37888
    ds_read_b64_tr_b16 v[34:35], v8 offset:40960
    ds_read_b64_tr_b16 v[36:37], v8 offset:41984
    ds_read_b64_tr_b16 v[38:39], v8 offset:45056
    ds_read_b64_tr_b16 v[40:41], v8 offset:46080
    s_waitcnt lgkmcnt(6)
    v_mfma_f32_16x16x32_bf16 v[50:53], v[42:45], v[26:29], v[50:53]
    s_waitcnt lgkmcnt(4)
    v_mfma_f32_16x16x32_bf16 v[50:53], v[42:45], v[30:33], v[50:53]
    s_waitcnt lgkmcnt(2)
    v_mfma_f32_16x16x32_bf16 v[50:53], v[42:45], v[34:37], v[50:53]
    s_waitcnt lgkmcnt(0)
    v_mfma_f32_16x16x32_bf16 v[50:53], v[42:45], v[38:41], v[50:53]
    s_barrier
    ds_read_b64_tr_b16 v[26:27], v8 offset:49152
    ds_read_b64_tr_b16 v[28:29], v8 offset:50176
    ds_read_b64_tr_b16 v[30:31], v8 offset:53248
    ds_read_b64_tr_b16 v[32:33], v8 offset:54272
    ds_read_b64_tr_b16 v[34:35], v8 offset:57344
    ds_read_b64_tr_b16 v[36:37], v8 offset:58368
    ds_read_b64_tr_b16 v[38:39], v8 offset:61440
    ds_read_b64_tr_b16 v[40:41], v8 offset:62464
    s_waitcnt lgkmcnt(6)
    v_mfma_f32_16x16x32_bf16 v[50:53], v[42:45], v[26:29], v[50:53]
    s_waitcnt lgkmcnt(4)
    v_mfma_f32_16x16x32_bf16 v[50:53], v[42:45], v[30:33], v[50:53]
    s_waitcnt lgkmcnt(2)
    v_mfma_f32_16x16x32_bf16 v[50:53], v[42:45], v[34:37], v[50:53]
    s_waitcnt lgkmcnt(0)
    v_mfma_f32_16x16x32_bf16 v[50:53], v[42:45], v[38:41], v[50:53]
    s_lshl_b32 s58, s29, 10
    s_add_u32 s58, s58, 17612800
    s_nop 5
    v_mov_b32 v51, s33
    s_mov_b32 exec_hi, 0
    buffer_store_dwordx2 v[50:51], v120, s[24:27], s58 offen sc1
    s_mov_b32 exec_hi, -1
    s_branch L_attn
L_helper:
    s_sub_u32 s38, s28, 8
    s_and_b32 s31, s2, 7
    s_bfe_u32 s32, s2, 0x20003
    s_lshl2_add_u32 s31, s31, s32
    s_lshr_b32 s32, s2, 5
    s_sub_u32 s41, s28, 8
    s_and_b32 s40, s41, 1
    s_lshr_b32 s41, s41, 1
    v_lshrrev_b32 v2, 5, v0
    v_and_b32 v3, 31, v0
    v_mov_b32 v106, v3
    v_bfe_u32 v1, v106, 1, 3
    v_xor_b32 v1, v1, v2
    v_lshrrev_b32 v107, 5, v106
    v_lshlrev_b32 v107, 2, v107
    v_xor_b32 v1, v1, v107
    s_lshl_b32 s34, s40, 13
    s_add_u32 s34, s34, 114688
    v_lshlrev_b32 v106, 7, v106
    v_add_u32 v106, s34, v106
    v_xor_b32 v107, 0, v1
    v_lshl_add_u32 v4, v107, 4, v106
    v_xor_b32 v107, 2, v1
    v_lshl_add_u32 v5, v107, 4, v106
    v_xor_b32 v107, 4, v1
    v_lshl_add_u32 v6, v107, 4, v106
    v_xor_b32 v107, 6, v1
    v_lshl_add_u32 v7, v107, 4, v106
    v_lshrrev_b32 v1, 2, v0
    v_and_b32 v1, 3, v1
    v_lshl_add_u32 v106, v2, 3, v1
    v_lshlrev_b32 v106, 8, v106
    v_and_b32 v107, 3, v0
    v_lshl_add_u32 v106, v107, 3, v106
    v_and_b32 v107, 16, v0
    v_lshl_add_u32 v106, v107, 1, v106
    v_add_u32 v106, 16384, v106
    s_lshl_b32 s34, s41, 1
    s_add_u32 s34, s34, s40
    v_xor_b32 v1, s34, v1
    s_lshl_b32 s34, s34, 8
    v_lshl_add_u32 v120, v3, 3, s34
    v_xor_b32 v121, 256, v120
    s_lshl_b32 s58, s30, 10
    s_add_u32 s58, s58, 17612800
    s_mov_b32 s59, -1
    v_lshl_add_u32 v8, v1, 6, v106
    v_xor_b32 v1, 1, v1
    v_lshl_add_u32 v9, v1, 6, v106
    s_mov_b32 s44, 3
    s_mov_b32 s45, 1
    s_mov_b32 s55, 3
    s_mov_b32 s69, 0
    s_lshl_b32 s34, s29, 7
    s_lshl_b32 s35, s30, 3
    s_add_u32 s34, s34, s35
    s_lshl_b32 s35, s38, 1
    s_add_u32 s36, s34, s35
    s_mul_i32 s37, s36, 1280
    s_lshl_b32 s36, s36, 4
    s_add_u32 s36, s36, 17563648
    v_mul_u32_u24 v1, 1280, v2
    v_lshl_add_u32 v110, v3, 4, v1
    v_lshl_add_u32 v111, v3, 3, v1
    v_lshlrev_b32 v112, 1, v3
    s_lshl_b32 s39, s30, 1
    s_add_u32 s39, s39, s41
    s_lshl_b32 s34, s39, 7
    s_waitcnt lgkmcnt(0)
    s_mov_b32 s24, s22
    s_mov_b32 s25, s23
    s_mov_b32 s26, 18092032
    s_mov_b32 s27, 0x00020000
    s_add_u32 s10, s22, 18087936
    s_addc_u32 s11, s23, 0
    s_load_dword s33, s[10:11], 0
    s_and_b32 s10, s36, 0xffffff80
    s_add_u32 s10, s22, s10
    s_addc_u32 s11, s23, 0
    s_load_dword s61, s[10:11], 0
    s_load_dword s61, s[10:11], 64
    s_lshl_b32 s56, s30, 1
    s_add_u32 s56, s56, s41
    s_lshl_b32 s56, s56, 10
    s_lshr_b32 s57, s29, 1
    s_lshl_b32 s57, s57, 7
    s_add_u32 s56, s56, s57
    s_add_u32 s56, s56, 17629184
    s_and_b32 s10, s56, 0xffffff80
    s_add_u32 s10, s22, s10
    s_addc_u32 s11, s23, 0
    s_load_dword s61, s[10:11], 0
    s_load_dword s61, s[10:11], 64
    s_lshl_b32 s56, s29, 1
    s_add_u32 s56, s56, s40
    s_lshl_b32 s56, s56, 4
    s_add_u32 s56, s56, s30
    s_lshl_b32 s56, s56, 7
    s_add_u32 s56, s56, 17694720
    s_and_b32 s10, s56, 0xffffff80
    s_add_u32 s10, s22, s10
    s_addc_u32 s11, s23, 0
    s_load_dword s61, s[10:11], 0
    s_load_dword s61, s[10:11], 64
    s_lshl_b32 s56, s32, 2
    s_add_u32 s56, s56, s38
    s_lshl_b32 s56, s56, 13
    s_lshr_b32 s57, s31, 2
    s_lshl_b32 s57, s57, 7
    s_add_u32 s56, s56, s57
    s_add_u32 s56, s56, 17825792
    s_and_b32 s10, s56, 0xffffff80
    s_add_u32 s10, s22, s10
    s_addc_u32 s11, s23, 0
    s_load_dword s61, s[10:11], 0
    s_load_dword s61, s[10:11], 64
    s_load_dword s61, s[10:11], 4096
    s_load_dword s61, s[10:11], 4160
    s_mov_b32 s60, s34
    s_bfe_u32 s3, s2, 0x20001
    s_bfe_u32 s34, s2, 0x30003
    s_lshl3_add_u32 s3, s3, s34
    s_and_b32 s62, s38, 1
    s_lshr_b32 s63, s38, 1
    s_lshl1_add_u32 s64, s3, s62
    s_lshr_b32 s65, s2, 6
    v_lshlrev_b32 v138, 4, v0
    v_lshlrev_b32 v139, 3, v0
    v_lshlrev_b32 v167, 5, v3
    s_lshl_b32 s34, s3, 6
    s_add_u32 s34, s34, s62
    v_and_b32 v1, 15, v0
    v_lshl_add_u32 v1, v1, 1, s34
    v_mul_u32_u24 v142, 1280, v1
    v_and_b32 v116, 16, v0
    v_lshl_add_u32 v142, v116, 1, v142
    v_lshl_add_u32 v142, v2, 4, v142
    v_lshlrev_b32 v140, 1, v116
    v_and_b32 v116, 1, v0
    v_lshl_add_u32 v140, v116, 4, v140
    v_and_b32 v116, 2, v0
    v_lshl_add_u32 v140, v116, 2, v140
    v_bfe_u32 v116, v0, 2, 2
    v_lshl_add_u32 v116, v2, 2, v116
    s_bitcmp1_b32 s2, 0
    s_cbranch_scc1 L_su2
    s_mul_i32 s65, s65, 192
    s_mul_i32 s66, s38, 30720
    v_mul_u32_u24 v116, 192, v116
    v_add3_u32 v140, v140, v116, s66
    v_mov_b32 v141, v140
    s_cmp_eq_u32 s63, 0
    s_cselect_b32 s67, 1280, 0
    v_lshl_add_u32 v1, v3, 1, s34
    v_mul_u32_u24 v143, s67, v1
    v_lshl_add_u32 v1, v2, 4, s65
    v_add_u32 v143, v143, v1
    v_add_u32 v116, 0, v0
    v_mul_u32_u24 v1, 171, v116
    v_lshrrev_b32 v1, 11, v1
    v_mul_u32_u24 v117, 12, v1
    v_sub_u32 v116, v116, v117
    v_lshl_add_u32 v116, v116, 4, s65
    v_mul_u32_u24 v144, 1280, v1
    v_add_u32 v144, v144, v116
    v_lshrrev_b32 v1, 2, v1
    v_add_u32 v1, 1, v1
    v_mul_u32_u24 v1, 20480, v1
    v_add_u32 v148, v144, v1
    v_add_u32 v116, 64, v0
    v_mul_u32_u24 v1, 171, v116
    v_lshrrev_b32 v1, 11, v1
    v_mul_u32_u24 v117, 12, v1
    v_sub_u32 v116, v116, v117
    v_lshl_add_u32 v116, v116, 4, s65
    v_mul_u32_u24 v145, 1280, v1
    v_add_u32 v145, v145, v116
    v_lshrrev_b32 v1, 2, v1
    v_add_u32 v1, 1, v1
    v_mul_u32_u24 v1, 20480, v1
    v_subrev_u32 v145, 1024, v145
    v_add_u32 v149, v145, v1
    v_add_u32 v116, 128, v0
    v_mul_u32_u24 v1, 171, v116
    v_lshrrev_b32 v1, 11, v1
    v_mul_u32_u24 v117, 12, v1
    v_sub_u32 v116, v116, v117
    v_lshl_add_u32 v116, v116, 4, s65
    v_mul_u32_u24 v146, 1280, v1
    v_add_u32 v146, v146, v116
    v_lshrrev_b32 v1, 2, v1
    v_add_u32 v1, 1, v1
    v_mul_u32_u24 v1, 20480, v1
    v_subrev_u32 v146, 2048, v146
    v_add_u32 v150, v146, v1
    s_branch L_su3
L_su2:
    s_lshl_b32 s65, s65, 7
    s_add_u32 s65, s65, 768
    s_mul_i32 s66, s38, 20480
    v_lshlrev_b32 v1, 7, v116
    v_add3_u32 v140, v140, v1, s66
    v_and_b32 v1, 2, v116
    v_lshl_add_u32 v140, v1, 5, v140
    v_xor_b32 v141, 64, v140
    s_cmp_eq_u32 s63, 0
    s_cselect_b32 s67, -1, 0
    s_mov_b32 s68, 90112
    s_cmov_b32 s68, 81920
    s_lshl_b32 s35, s62, 7
    v_lshl_add_u32 v1, v3, 8, s35
    v_and_b32 v116, 1, v0
    v_lshl_add_u32 v1, v116, 6, v1
    v_and_b32 v1, s67, v1
    v_lshl_add_u32 v1, v2, 4, v1
    v_add_u32 v143, s68, v1
    v_lshrrev_b32 v1, 3, v0
    v_and_b32 v116, 7, v0
    v_and_b32 v117, 16, v0
    v_lshrrev_b32 v117, 2, v117
    v_xor_b32 v116, v116, v117
    v_add_u32 v1, 0, v1
    v_lshl_add_u32 v116, v116, 4, s65
    v_mul_u32_u24 v144, 1280, v1
    v_add_u32 v144, v144, v116
    v_lshrrev_b32 v1, 2, v1
    v_add_u32 v1, 1, v1
    v_mul_u32_u24 v1, 20480, v1
    v_add_u32 v148, v144, v1
    v_lshrrev_b32 v1, 3, v0
    v_and_b32 v116, 7, v0
    v_and_b32 v117, 16, v0
    v_lshrrev_b32 v117, 2, v117
    v_xor_b32 v116, v116, v117
    v_add_u32 v1, 8, v1
    v_lshl_add_u32 v116, v116, 4, s65
    v_mul_u32_u24 v145, 1280, v1
    v_add_u32 v145, v145, v116
    v_lshrrev_b32 v1, 2, v1
    v_add_u32 v1, 1, v1
    v_mul_u32_u24 v1, 20480, v1
    v_subrev_u32 v145, 1024, v145
    v_add_u32 v149, v145, v1
    v_mov_b32 v146, 0
    v_mov_b32 v150, 0
L_su3:
    v_mov_b64 v[158:159], 0
    v_mov_b64 v[160:161], 0
    v_mov_b32 v162, 160256
    v_mov_b64 v[42:43], 0
    v_mov_b64 v[44:45], 0
    v_mov_b64 v[46:47], 0
    v_mov_b64 v[48:49], 0
    v_mov_b64 v[50:51], 0
    v_mov_b64 v[52:53], 0
    v_mov_b64 v[54:55], 0
    v_mov_b64 v[56:57], 0
    v_mov_b64 v[58:59], 0
    v_mov_b64 v[60:61], 0
    v_mov_b64 v[62:63], 0
    v_mov_b64 v[64:65], 0
    v_mov_b64 v[66:67], 0
    v_mov_b64 v[68:69], 0
    v_mov_b64 v[70:71], 0
    v_mov_b64 v[72:73], 0
    v_mov_b64 v[74:75], 0
    v_mov_b64 v[76:77], 0
    v_mov_b64 v[78:79], 0
    v_mov_b64 v[80:81], 0
    v_mov_b64 v[82:83], 0
    v_mov_b64 v[84:85], 0
    v_mov_b64 v[86:87], 0
    v_mov_b64 v[88:89], 0
    v_mov_b64 v[90:91], 0
    v_mov_b64 v[92:93], 0
    v_mov_b64 v[94:95], 0
    v_mov_b64 v[96:97], 0
    v_mov_b64 v[98:99], 0
    v_mov_b64 v[100:101], 0
    v_mov_b64 v[102:103], 0
    v_mov_b64 v[104:105], 0
    s_lshl_b32 s34, s29, 2
    s_lshl_b32 s35, s40, 1
    s_add_u32 s34, s34, s35
    s_mul_i32 s34, s34, 108
    s_lshl_b32 s35, s39, 2
    s_add_u32 s34, s34, s35
    s_lshl_b32 s34, s34, 10
    s_add_u32 s52, s34, 7864320
    s_add_u32 s53, s52, 110592
    s_lshl_b32 s34, s40, 11
    v_lshl_add_u32 v106, v0, 4, s34
    v_xor_b32 v107, 2048, v106
    s_lshl_b32 s34, s40, 8
    s_add_u32 s34, s34, 158720
    v_lshl_add_u32 v109, v3, 3, s34
    v_lshl_add_u32 v109, v2, 9, v109
    s_lshl_b32 s34, s38, 7
    s_add_u32 s34, s34, 158720
    v_lshl_add_u32 v115, v3, 2, s34
    v_mov_b32 v116, 160256
    v_lshlrev_b32 v108, 4, v3
    s_mov_b32 s34, s60
    s_mov_b32 s48, s4
    s_mov_b32 s49, s5
    s_mov_b32 s50, 2621440
    s_mov_b32 s51, 0x00020000
    s_barrier
    buffer_load_dwordx4 v[122:125], v110, s[48:51], s37 offen
    buffer_load_dwordx4 v[126:129], v110, s[48:51], s37 offen offset:512
    buffer_load_dwordx2 v[130:131], v111, s[48:51], s37 offen offset:1024
    s_barrier
    s_barrier
    s_waitcnt vmcnt(0) lgkmcnt(0)
    s_add_u32 s33, s33, 0x9e3779b1
    s_mov_b64 exec, 1
    v_mov_b32 v1, s33
    ds_write_b32 v116, v1
    s_mov_b64 exec, -1
    s_mov_b32 s48, s14
    s_mov_b32 s49, s15
    s_mov_b32 s50, 3456
    s_mov_b32 s51, 0x00020000
    s_lshl_b32 s35, s40, 6
    s_add_u32 s34, s34, s35
    s_xor_b32 s35, s34, 64
    buffer_load_ushort v113, v112, s[48:51], s34 offen
    buffer_load_ushort v114, v112, s[48:51], s35 offen
    s_lshl_b32 s35, s29, 11
    s_lshl_b32 s34, s38, 9
    s_add_u32 s35, s35, s34
    s_add_u32 s35, s35, 17563648
    s_mov_b32 s37, 1048576
    v_lshlrev_b32 v18, 16, v122
    v_and_b32 v122, 0xffff0000, v122
    v_add_f32 v10, v18, v122
    v_lshlrev_b32 v19, 16, v123
    v_and_b32 v123, 0xffff0000, v123
    v_add_f32 v11, v19, v123
    v_lshlrev_b32 v20, 16, v124
    v_and_b32 v124, 0xffff0000, v124
    v_add_f32 v10, v10, v20
    v_add_f32 v11, v11, v124
    v_lshlrev_b32 v21, 16, v125
    v_and_b32 v125, 0xffff0000, v125
    v_add_f32 v10, v10, v21
    v_add_f32 v11, v11, v125
    v_lshlrev_b32 v22, 16, v126
    v_and_b32 v126, 0xffff0000, v126
    v_add_f32 v10, v10, v22
    v_add_f32 v11, v11, v126
    v_lshlrev_b32 v23, 16, v127
    v_and_b32 v127, 0xffff0000, v127
    v_add_f32 v10, v10, v23
    v_add_f32 v11, v11, v127
    v_lshlrev_b32 v24, 16, v128
    v_and_b32 v128, 0xffff0000, v128
    v_add_f32 v10, v10, v24
    v_add_f32 v11, v11, v128
    v_lshlrev_b32 v25, 16, v129
    v_and_b32 v129, 0xffff0000, v129
    v_add_f32 v10, v10, v25
    v_add_f32 v11, v11, v129
    v_lshlrev_b32 v26, 16, v130
    v_and_b32 v130, 0xffff0000, v130
    v_add_f32 v10, v10, v26
    v_add_f32 v11, v11, v130
    v_lshlrev_b32 v27, 16, v131
    v_and_b32 v131, 0xffff0000, v131
    v_add_f32 v10, v10, v27
    v_add_f32 v11, v11, v131
    v_add_f32 v10, v10, v11
    s_nop 1
    v_add_f32_dpp v10, v10, v10 quad_perm:[1,0,3,2] row_mask:0xf bank_mask:0xf
    s_nop 1
    v_add_f32_dpp v10, v10, v10 quad_perm:[2,3,0,1] row_mask:0xf bank_mask:0xf
    s_nop 1
    v_add_f32_dpp v10, v10, v10 row_half_mirror row_mask:0xf bank_mask:0xf
    s_nop 1
    v_add_f32_dpp v10, v10, v10 row_mirror row_mask:0xf bank_mask:0xf
    v_mov_b32 v13, v10
    s_nop 1
    v_permlane16_swap_b32 v10, v13
    s_nop 1
    v_add_f32 v10, v10, v13
    v_mul_f32 v10, 0x3acccccd, v10
    v_mov_b32 v11, 0
    v_mov_b32 v12, 0
    s_barrier
    v_sub_f32 v18, v18, v10
    v_sub_f32 v19, v19, v10
    v_fmac_f32 v11, v18, v18
    v_fmac_f32 v12, v19, v19
    v_sub_f32 v20, v20, v10
    v_sub_f32 v21, v21, v10
    v_fmac_f32 v11, v20, v20
    v_fmac_f32 v12, v21, v21
    v_sub_f32 v22, v22, v10
    v_sub_f32 v23, v23, v10
    v_fmac_f32 v11, v22, v22
    v_fmac_f32 v12, v23, v23
    v_sub_f32 v24, v24, v10
    v_sub_f32 v25, v25, v10
    v_fmac_f32 v11, v24, v24
    v_fmac_f32 v12, v25, v25
    v_sub_f32 v26, v26, v10
    v_sub_f32 v27, v27, v10
    v_fmac_f32 v11, v26, v26
    v_fmac_f32 v12, v27, v27
    v_sub_f32 v122, v122, v10
    v_sub_f32 v123, v123, v10
    v_fmac_f32 v11, v122, v122
    v_fmac_f32 v12, v123, v123
    v_sub_f32 v124, v124, v10
    v_sub_f32 v125, v125, v10
    v_fmac_f32 v11, v124, v124
    v_fmac_f32 v12, v125, v125
    v_sub_f32 v126, v126, v10
    v_sub_f32 v127, v127, v10
    v_fmac_f32 v11, v126, v126
    v_fmac_f32 v12, v127, v127
    v_sub_f32 v128, v128, v10
    v_sub_f32 v129, v129, v10
    v_fmac_f32 v11, v128, v128
    v_fmac_f32 v12, v129, v129
    v_sub_f32 v130, v130, v10
    v_sub_f32 v131, v131, v10
    v_fmac_f32 v11, v130, v130
    v_fmac_f32 v12, v131, v131
    v_add_f32 v12, v11, v12
    s_nop 1
    v_add_f32_dpp v12, v12, v12 quad_perm:[1,0,3,2] row_mask:0xf bank_mask:0xf
    s_nop 1
    v_add_f32_dpp v12, v12, v12 quad_perm:[2,3,0,1] row_mask:0xf bank_mask:0xf
    s_nop 1
    v_add_f32_dpp v12, v12, v12 row_half_mirror row_mask:0xf bank_mask:0xf
    s_nop 1
    v_add_f32_dpp v12, v12, v12 row_mirror row_mask:0xf bank_mask:0xf
    v_mov_b32 v13, v12
    s_nop 1
    v_permlane16_swap_b32 v12, v13
    s_nop 1
    v_add_f32 v12, v12, v13
    v_mov_b32 v13, 0x3727c5ac
    v_fmac_f32 v13, 0x3acccccd, v12
    v_rsq_f32 v12, v13
    v_mov_b32 v11, s33
    v_mov_b32 v13, s33
    v_lshrrev_b32 v1, 1, v0
    s_mov_b32 exec_lo, 1
    s_mov_b32 exec_hi, 1
    buffer_store_dwordx4 v[10:13], v1, s[24:27], s36 offen sc1
    s_mov_b64 exec, -1
    s_barrier
    s_waitcnt lgkmcnt(0)
    s_cmp_lt_u32 s39, 27
    s_cbranch_scc1 L_h_act
    s_barrier
    s_barrier
    s_barrier
    s_barrier
    s_branch L_h_mid
L_h_act:
    s_setprio 1
L_ent_ffn:
    s_barrier
    ds_read_b128 v[10:13], v4
    ds_read_b64_tr_b16 v[18:19], v8 offset:0
    ds_read_b64_tr_b16 v[20:21], v8 offset:1024
    ds_read_b64_tr_b16 v[22:23], v9 offset:0
    ds_read_b64_tr_b16 v[24:25], v9 offset:1024
    ds_read_b128 v[14:17], v6 offset:4096
L_loop_ffn:
    s_waitcnt lgkmcnt(3)
    v_mfma_f32_32x32x16_bf16 v[42:57], v[18:21], v[10:13], v[42:57]
    ds_read_b128 v[26:29], v5
    ds_read_b64_tr_b16 v[34:35], v8 offset:4096
    ds_read_b64_tr_b16 v[36:37], v8 offset:5120
    s_waitcnt lgkmcnt(4)
    v_mfma_f32_32x32x16_bf16 v[58:73], v[22:25], v[10:13], v[58:73]
    ds_read_b64_tr_b16 v[38:39], v9 offset:4096
    ds_read_b64_tr_b16 v[40:41], v9 offset:5120
    ds_read_b128 v[30:33], v7 offset:4096
    s_waitcnt lgkmcnt(6)
    v_mfma_f32_32x32x16_bf16 v[90:105], v[22:25], v[14:17], v[90:105]
    s_add_u32 s44, s44, 1
    s_cmp_eq_u32 s44, 5
    s_mov_b32 s42, 16384
    s_cmov_b32 s42, -65536
    s_cselect_b32 s44, 0, s44
    v_mfma_f32_32x32x16_bf16 v[74:89], v[18:21], v[14:17], v[74:89]
    s_cmp_eq_u32 s55, s59
    s_cbranch_scc1 L_ld_ffn
L_ldx_ffn:
    s_waitcnt lgkmcnt(3)
    v_mfma_f32_32x32x16_bf16 v[42:57], v[34:37], v[26:29], v[42:57]
    ds_read_b128 v[10:13], v6
    ds_read_b64_tr_b16 v[18:19], v8 offset:8192
    ds_read_b64_tr_b16 v[20:21], v8 offset:9216
    s_waitcnt lgkmcnt(4)
    v_mfma_f32_32x32x16_bf16 v[58:73], v[38:41], v[26:29], v[58:73]
    ds_read_b64_tr_b16 v[22:23], v9 offset:8192
    ds_read_b64_tr_b16 v[24:25], v9 offset:9216
    ds_read_b128 v[14:17], v4 offset:4096
    s_waitcnt lgkmcnt(6)
    v_mfma_f32_32x32x16_bf16 v[90:105], v[38:41], v[30:33], v[90:105]
    s_add_u32 s45, s45, 1
    s_cmp_eq_u32 s45, 4
    s_mov_b32 s43, 16384
    s_cmov_b32 s43, -49152
    s_cselect_b32 s45, 0, s45
    v_mfma_f32_32x32x16_bf16 v[74:89], v[34:37], v[30:33], v[74:89]
    s_waitcnt lgkmcnt(3)
    v_mfma_f32_32x32x16_bf16 v[42:57], v[18:21], v[10:13], v[42:57]
    ds_read_b128 v[26:29], v7
    ds_read_b64_tr_b16 v[34:35], v8 offset:12288
    ds_read_b64_tr_b16 v[36:37], v8 offset:13312
    s_waitcnt lgkmcnt(4)
    v_mfma_f32_32x32x16_bf16 v[58:73], v[22:25], v[10:13], v[58:73]
    ds_read_b64_tr_b16 v[38:39], v9 offset:12288
    ds_read_b64_tr_b16 v[40:41], v9 offset:13312
    ds_read_b128 v[30:33], v5 offset:4096
    s_waitcnt lgkmcnt(6)
    v_mfma_f32_32x32x16_bf16 v[90:105], v[22:25], v[14:17], v[90:105]
    v_add_u32 v4, s42, v4
    v_add_u32 v8, s43, v8
    v_add_u32 v9, s43, v9
    v_mfma_f32_32x32x16_bf16 v[74:89], v[18:21], v[14:17], v[74:89]
    s_sub_u32 s55, s55, 1
    v_add_u32 v5, s42, v5
    v_add_u32 v6, s42, v6
    v_add_u32 v7, s42, v7
    s_cmp_eq_u32 s55, 0
    s_waitcnt lgkmcnt(0)
    s_cbranch_scc1 L_last_ffn
    s_bitcmp1_b32 s69, s55
    s_cbranch_scc1 L_nob_ffn
    s_barrier
L_nob_ffn:
    v_mfma_f32_32x32x16_bf16 v[42:57], v[34:37], v[26:29], v[42:57]
    ds_read_b128 v[10:13], v4
    ds_read_b64_tr_b16 v[18:19], v8 offset:0
    ds_read_b64_tr_b16 v[20:21], v8 offset:1024
    v_mfma_f32_32x32x16_bf16 v[58:73], v[38:41], v[26:29], v[58:73]
    ds_read_b64_tr_b16 v[22:23], v9 offset:0
    ds_read_b64_tr_b16 v[24:25], v9 offset:1024
    ds_read_b128 v[14:17], v6 offset:4096
    v_mfma_f32_32x32x16_bf16 v[90:105], v[38:41], v[30:33], v[90:105]
    v_mfma_f32_32x32x16_bf16 v[74:89], v[34:37], v[30:33], v[74:89]
    s_branch L_loop_ffn
L_ld_ffn:
    s_mov_b32 exec_hi, 0
    buffer_load_dwordx2 v[158:159], v120, s[24:27], s58 offen sc1
    buffer_load_dwordx2 v[160:161], v121, s[24:27], s58 offen sc1
    s_mov_b32 exec_hi, -1
    s_branch L_ldx_ffn
L_pause_ffn:
    s_barrier
    v_mfma_f32_32x32x16_bf16 v[42:57], v[34:37], v[26:29], v[42:57]
    s_mov_b32 s69, 0x80000060
    v_mfma_f32_32x32x16_bf16 v[58:73], v[38:41], v[26:29], v[58:73]
    s_mov_b32 s45, 1
    v_mfma_f32_32x32x16_bf16 v[90:105], v[38:41], v[30:33], v[90:105]
    s_mov_b32 s55, 7
    v_mfma_f32_32x32x16_bf16 v[74:89], v[34:37], v[30:33], v[74:89]
    s_mov_b32 s59, 2
    v_add_u32 v8, 16384, v8
    v_add_u32 v9, 16384, v9
L_h_mid:
    s_setprio 0
    buffer_load_dwordx4 v[10:13], v108, s[24:27], s35 offen sc1
    s_barrier
    s_barrier
    s_cmp_eq_u32 s30, 15
    s_cselect_b32 s37, 0, s37
L_h_chk:
    s_waitcnt vmcnt(0)
    v_cmp_ne_u32 vcc, s33, v11
    v_cmp_ne_u32 s[46:47], s33, v13
    s_nop 1
    s_or_b64 vcc, vcc, s[46:47]
    s_cbranch_scc0 L_h_got
    s_sub_u32 s37, s37, 1
    s_cbranch_scc1 L_h_got
    buffer_load_dwordx4 v[10:13], v108, s[24:27], s35 offen sc1
    s_branch L_h_chk
L_h_got:
    v_rcp_f32 v11, v12
    v_sub_f32 v10, 0, v10
    s_mov_b32 exec_lo, 0
    v_lshlrev_b32 v158, 16, v113
    v_lshlrev_b32 v160, 16, v114
    s_mov_b32 exec_lo, -1
    s_barrier
    s_barrier
    s_mov_b32 exec_hi, 0
    ds_write_b32 v115, v10
    ds_write_b32 v115, v11 offset:512
    ds_write_b32 v115, v12 offset:1024
    s_mov_b64 exec, -1
    s_waitcnt lgkmcnt(0)
    s_cmp_lt_u32 s39, 27
    s_cbranch_scc1 L_h_act
    s_barrier
    s_barrier
    s_barrier
    s_barrier
    s_barrier
    s_barrier
    s_branch L_h_p2
L_last_ffn:
    s_bitcmp0_b32 s69, 31
    s_cbranch_scc1 L_pause_ffn
    ds_read_b32 v162, v162
    ds_read_b64 v[130:131], v109
    v_mfma_f32_32x32x16_bf16 v[42:57], v[34:37], v[26:29], v[42:57]
    v_mfma_f32_32x32x16_bf16 v[58:73], v[38:41], v[26:29], v[58:73]
    s_mov_b32 s59, 1048576
    s_waitcnt lgkmcnt(0)
    v_cvt_pk_bf16_f32 v122, v130, v130
    v_cvt_pk_bf16_f32 v124, v131, v131
    v_and_b32 v134, 0xffff0000, v122
    v_and_b32 v135, 0xffff0000, v124
    v_sub_f32 v134, v130, v134
    v_mfma_f32_32x32x16_bf16 v[90:105], v[38:41], v[30:33], v[90:105]
    v_sub_f32 v135, v131, v135
    v_cvt_pk_bf16_f32 v123, v134, v134
    v_cvt_pk_bf16_f32 v125, v135, v135
L_cs_ffn:
    s_waitcnt vmcnt(0)
    v_cmp_ne_u32 vcc, v162, v159
    v_cmp_ne_u32 s[46:47], v162, v161
    s_nop 1
    s_or_b32 vcc_lo, vcc_lo, s46
    s_cbranch_scc0 L_csx_ffn
    s_sub_u32 s59, s59, 1
    s_cbranch_scc1 L_csx_ffn
    s_mov_b32 exec_hi, 0
    buffer_load_dwordx2 v[158:159], v120, s[24:27], s58 offen sc1
    buffer_load_dwordx2 v[160:161], v121, s[24:27], s58 offen sc1
    s_mov_b32 exec_hi, -1
    s_branch L_cs_ffn
L_csx_ffn:
    v_mfma_f32_32x32x16_bf16 v[74:89], v[34:37], v[30:33], v[74:89]
    v_cvt_pk_bf16_f32 v126, v158, v158
    v_cvt_pk_bf16_f32 v128, v160, v160
    v_and_b32 v136, 0xffff0000, v126
    v_and_b32 v137, 0xffff0000, v128
    v_sub_f32 v136, v158, v136
    v_sub_f32 v137, v160, v137
    v_cvt_pk_bf16_f32 v126, v158, v136
    v_cvt_pk_bf16_f32 v127, v158, v136
    v_cvt_pk_bf16_f32 v128, v160, v137
    v_cvt_pk_bf16_f32 v129, v160, v137
    s_nop 1
    v_mfma_f32_32x32x8_bf16 v[42:57], v[126:127], v[122:123], v[42:57]
    v_mfma_f32_32x32x8_bf16 v[58:73], v[128:129], v[122:123], v[58:73]
    v_mfma_f32_32x32x8_bf16 v[90:105], v[128:129], v[124:125], v[90:105]
    v_mfma_f32_32x32x8_bf16 v[74:89], v[126:127], v[124:125], v[74:89]
    s_nop 8
    v_mul_f32 v42, v42, |v42|
    v_mul_f32 v43, v43, |v43|
    v_mul_f32 v44, v44, |v44|
    v_mul_f32 v45, v45, |v45|
    v_mul_f32 v46, v46, |v46|
    v_mul_f32 v47, v47, |v47|
    v_mul_f32 v48, v48, |v48|
    v_mul_f32 v49, v49, |v49|
    v_cvt_pk_bf16_f32 v42, v42, v43
    v_cvt_pk_bf16_f32 v43, v44, v45
    v_cvt_pk_bf16_f32 v44, v46, v47
    v_cvt_pk_bf16_f32 v45, v48, v49
    v_pk_max_i16 v42, v42, 0
    v_pk_max_i16 v43, v43, 0
    v_pk_max_i16 v44, v44, 0
    v_pk_max_i16 v45, v45, 0
    v_mul_f32 v50, v50, |v50|
    v_mul_f32 v51, v51, |v51|
    v_mul_f32 v52, v52, |v52|
    v_mul_f32 v53, v53, |v53|
    v_mul_f32 v54, v54, |v54|
    v_mul_f32 v55, v55, |v55|
    v_mul_f32 v56, v56, |v56|
    v_mul_f32 v57, v57, |v57|
    v_cvt_pk_bf16_f32 v50, v50, v51
    v_cvt_pk_bf16_f32 v51, v52, v53
    v_cvt_pk_bf16_f32 v52, v54, v55
    v_cvt_pk_bf16_f32 v53, v56, v57
    v_pk_max_i16 v50, v50, 0
    v_pk_max_i16 v51, v51, 0
    v_pk_max_i16 v52, v52, 0
    v_pk_max_i16 v53, v53, 0
    v_mul_f32 v58, v58, |v58|
    v_mul_f32 v59, v59, |v59|
    v_mul_f32 v60, v60, |v60|
    v_mul_f32 v61, v61, |v61|
    v_mul_f32 v62, v62, |v62|
    v_mul_f32 v63, v63, |v63|
    v_mul_f32 v64, v64, |v64|
    v_mul_f32 v65, v65, |v65|
    v_cvt_pk_bf16_f32 v58, v58, v59
    v_cvt_pk_bf16_f32 v59, v60, v61
    v_cvt_pk_bf16_f32 v60, v62, v63
    v_cvt_pk_bf16_f32 v61, v64, v65
    v_pk_max_i16 v58, v58, 0
    v_pk_max_i16 v59, v59, 0
    v_pk_max_i16 v60, v60, 0
    v_pk_max_i16 v61, v61, 0
    v_mul_f32 v66, v66, |v66|
    v_mul_f32 v67, v67, |v67|
    v_mul_f32 v68, v68, |v68|
    v_mul_f32 v69, v69, |v69|
    v_mul_f32 v70, v70, |v70|
    v_mul_f32 v71, v71, |v71|
    v_mul_f32 v72, v72, |v72|
    v_mul_f32 v73, v73, |v73|
    v_cvt_pk_bf16_f32 v66, v66, v67
    v_cvt_pk_bf16_f32 v67, v68, v69
    v_cvt_pk_bf16_f32 v68, v70, v71
    v_cvt_pk_bf16_f32 v69, v72, v73
    v_pk_max_i16 v66, v66, 0
    v_pk_max_i16 v67, v67, 0
    v_pk_max_i16 v68, v68, 0
    v_pk_max_i16 v69, v69, 0
    v_mul_f32 v90, v90, |v90|
    v_mul_f32 v91, v91, |v91|
    v_mul_f32 v92, v92, |v92|
    v_mul_f32 v93, v93, |v93|
    v_mul_f32 v94, v94, |v94|
    v_mul_f32 v95, v95, |v95|
    v_mul_f32 v96, v96, |v96|
    v_mul_f32 v97, v97, |v97|
    v_cvt_pk_bf16_f32 v90, v90, v91
    v_cvt_pk_bf16_f32 v91, v92, v93
    v_cvt_pk_bf16_f32 v92, v94, v95
    v_cvt_pk_bf16_f32 v93, v96, v97
    v_pk_max_i16 v90, v90, 0
    v_pk_max_i16 v91, v91, 0
    v_pk_max_i16 v92, v92, 0
    v_pk_max_i16 v93, v93, 0
    v_mul_f32 v98, v98, |v98|
    v_mul_f32 v99, v99, |v99|
    v_mul_f32 v100, v100, |v100|
    v_mul_f32 v101, v101, |v101|
    v_mul_f32 v102, v102, |v102|
    v_mul_f32 v103, v103, |v103|
    v_mul_f32 v104, v104, |v104|
    v_mul_f32 v105, v105, |v105|
    v_cvt_pk_bf16_f32 v98, v98, v99
    v_cvt_pk_bf16_f32 v99, v100, v101
    v_cvt_pk_bf16_f32 v100, v102, v103
    v_cvt_pk_bf16_f32 v101, v104, v105
    v_pk_max_i16 v98, v98, 0
    v_pk_max_i16 v99, v99, 0
    v_pk_max_i16 v100, v100, 0
    v_pk_max_i16 v101, v101, 0
    v_mul_f32 v74, v74, |v74|
    v_mul_f32 v75, v75, |v75|
    v_mul_f32 v76, v76, |v76|
    v_mul_f32 v77, v77, |v77|
    v_mul_f32 v78, v78, |v78|
    v_mul_f32 v79, v79, |v79|
    v_mul_f32 v80, v80, |v80|
    v_mul_f32 v81, v81, |v81|
    v_cvt_pk_bf16_f32 v74, v74, v75
    v_cvt_pk_bf16_f32 v75, v76, v77
    v_cvt_pk_bf16_f32 v76, v78, v79
    v_cvt_pk_bf16_f32 v77, v80, v81
    v_pk_max_i16 v74, v74, 0
    v_pk_max_i16 v75, v75, 0
    v_pk_max_i16 v76, v76, 0
    v_pk_max_i16 v77, v77, 0
    v_mul_f32 v82, v82, |v82|
    v_mul_f32 v83, v83, |v83|
    v_mul_f32 v84, v84, |v84|
    v_mul_f32 v85, v85, |v85|
    v_mul_f32 v86, v86, |v86|
    v_mul_f32 v87, v87, |v87|
    v_mul_f32 v88, v88, |v88|
    v_mul_f32 v89, v89, |v89|
    v_cvt_pk_bf16_f32 v82, v82, v83
    v_cvt_pk_bf16_f32 v83, v84, v85
    v_cvt_pk_bf16_f32 v84, v86, v87
    v_cvt_pk_bf16_f32 v85, v88, v89
    v_pk_max_i16 v82, v82, 0
    v_pk_max_i16 v83, v83, 0
    v_pk_max_i16 v84, v84, 0
    v_pk_max_i16 v85, v85, 0
    s_barrier
    buffer_store_dwordx4 v[42:45], v106, s[24:27], s52 offen offset:0 sc1
    buffer_store_dwordx4 v[50:53], v106, s[24:27], s52 offen offset:1024 sc1
    buffer_store_dwordx4 v[58:61], v107, s[24:27], s52 offen offset:0 sc1
    buffer_store_dwordx4 v[66:69], v107, s[24:27], s52 offen offset:1024 sc1
    buffer_store_dwordx4 v[90:93], v107, s[24:27], s53 offen offset:0 sc1
    buffer_store_dwordx4 v[98:101], v107, s[24:27], s53 offen offset:1024 sc1
    buffer_store_dwordx4 v[74:77], v106, s[24:27], s53 offen offset:0 sc1
    buffer_store_dwordx4 v[82:85], v106, s[24:27], s53 offen offset:1024 sc1
L_h_p2:
    s_mov_b32 s60, -1
    s_mov_b32 s61, 0xff
    s_mul_i32 s40, s31, 163840
    s_mul_i32 s34, s38, 1280
    s_add_u32 s40, s40, s34
    s_add_u32 s40, s40, 2621440
    s_add_u32 s45, s34, 143360
    s_mul_i32 s46, s38, 1312
    s_add_u32 s46, s46, 122368
    s_add_u32 m0, s45, 10240
    s_add_u32 s34, s40, 20480
    s_mov_b64 exec, s[60:61]
    buffer_load_dwordx4 v138, s[24:27], s34 offen offset:0 sc1 lds
    buffer_load_dwordx4 v138, s[24:27], s34 offen offset:640 sc1 lds
    s_add_u32 m0, s46, 10496
    s_add_u32 s34, s34, 5120
    buffer_load_dwordx4 v138, s[24:27], s34 offen offset:0 sc1 lds
    s_sub_u32 s34, s34, 16
    buffer_load_dwordx4 v138, s[24:27], s34 offen offset:656 sc1 lds
    s_mov_b64 exec, -1
    s_mov_b32 s48, s16
    s_mov_b32 s49, s17
    s_mov_b32 s50, 2211840
    s_mov_b32 s51, 0x00020000
    s_mov_b32 s52, s8
    s_mov_b32 s53, s9
    s_mov_b32 s54, 819200
    s_mov_b32 s55, 0x00020000
    s_mul_i32 s47, s3, 27
    s_lshr_b32 s47, s47, 5
    s_mul_i32 s34, s38, 27
    s_add_u32 s34, s34, s47
    s_mul_i32 s43, s34, 20480
    s_and_b32 s69, s3, 1
    s_lshl1_add_u32 s44, s38, s69
    s_xor_b32 s68, s44, 1
    s_mul_i32 s44, s44, 102400
    s_mul_i32 s68, s68, 102400
    s_mul_i32 s41, s64, 110592
    s_lshl_b32 s34, s34, 10
    s_add_u32 s41, s41, s34
    s_add_u32 s41, s41, 7864320
    s_cmp_eq_u32 s62, 0
    s_mov_b32 s42, -110592
    s_cmov_b32 s42, 110592
    s_lshl_b32 s37, s29, 1
    s_add_u32 s37, s37, s62
    s_lshl_b32 s37, s37, 4
    s_add_u32 s37, s37, s30
    s_lshl_b32 s37, s37, 7
    s_lshl_b32 s35, s63, 2
    s_add_u32 s37, s37, s35
    s_add_u32 s37, s37, 17694720
    v_mov_b32 v131, s33
    v_min_u32 v130, 27, v0
    v_and_b32 v1, 1, v130
    v_lshlrev_b32 v1, 2, v1
    v_lshrrev_b32 v130, 1, v130
    v_lshl_add_u32 v1, v130, 7, v1
    v_add_u32 v132, s66, v138
    s_bitcmp1_b32 s2, 0
    s_mov_b32 s34, 30720
    s_cmov_b32 s34, 20480
    s_xor_b32 s35, s38, 1
    s_mul_i32 s35, s35, s34
    v_add_u32 v133, s35, v138
    v_xor_b32 v134, 64, v143
    s_setprio 0
    s_bitcmp1_b32 s2, 0
    s_cbranch_scc1 L_p2_2
L_p2_3:
    s_barrier
    s_add_u32 m0, s45, 15360
    s_add_u32 s34, s40, 30720
    s_mov_b64 exec, s[60:61]
    buffer_load_dwordx4 v138, s[24:27], s34 offen offset:0 sc1 lds
    buffer_load_dwordx4 v138, s[24:27], s34 offen offset:640 sc1 lds
    s_add_u32 m0, s46, 15744
    s_add_u32 s34, s34, 5120
    buffer_load_dwordx4 v138, s[24:27], s34 offen offset:0 sc1 lds
    s_sub_u32 s34, s34, 16
    buffer_load_dwordx4 v138, s[24:27], s34 offen offset:656 sc1 lds
    s_add_u32 m0, s66, 0
    s_cmp_ge_u32 s47, 27
    s_cselect_b32 s34, 552960, 0
    s_sub_u32 s34, s43, s34
    s_add_u32 s34, s34, 0
    s_mov_b64 exec, -1
    buffer_load_dwordx4 v144, s[48:51], s34 offen offset:0 lds
    buffer_load_dwordx4 v145, s[48:51], s34 offen offset:1024 lds
    buffer_load_dwordx4 v146, s[48:51], s34 offen offset:2048 lds
    s_waitcnt vmcnt(11)
    s_mov_b64 exec, 1
    buffer_store_dword v131, v1, s[24:27], s37 offen sc1
    s_mov_b64 exec, -1
    s_lshl_b32 s37, s3, 11
    s_add_u32 s37, s37, 17694720
    s_mov_b32 s36, 1048576
    s_waitcnt vmcnt(8)
    s_barrier
    s_add_u32 m0, s45, 0
    s_add_u32 s34, s40, 40960
    s_mov_b64 exec, s[60:61]
    buffer_load_dwordx4 v138, s[24:27], s34 offen offset:0 sc1 lds
    buffer_load_dwordx4 v138, s[24:27], s34 offen offset:640 sc1 lds
    s_add_u32 m0, s46, 0
    s_add_u32 s34, s34, 5120
    buffer_load_dwordx4 v138, s[24:27], s34 offen offset:0 sc1 lds
    s_sub_u32 s34, s34, 16
    buffer_load_dwordx4 v138, s[24:27], s34 offen offset:656 sc1 lds
    s_add_u32 m0, s66, 3072
    s_cmp_ge_u32 s47, 26
    s_cselect_b32 s34, 552960, 0
    s_sub_u32 s34, s43, s34
    s_add_u32 s34, s34, 20480
    s_mov_b64 exec, -1
    buffer_load_dwordx4 v144, s[48:51], s34 offen offset:0 lds
    buffer_load_dwordx4 v145, s[48:51], s34 offen offset:1024 lds
    buffer_load_dwordx4 v146, s[48:51], s34 offen offset:2048 lds
    s_add_u32 m0, s66, 6144
    s_cmp_ge_u32 s47, 25
    s_cselect_b32 s34, 552960, 0
    s_sub_u32 s34, s43, s34
    s_add_u32 s34, s34, 40960
    buffer_load_dwordx4 v144, s[48:51], s34 offen offset:0 lds
    buffer_load_dwordx4 v145, s[48:51], s34 offen offset:1024 lds
    buffer_load_dwordx4 v146, s[48:51], s34 offen offset:2048 lds
    s_add_u32 m0, s66, 12288
    s_add_u32 s34, s44, 0
    buffer_load_dwordx4 v148, s[52:55], s34 offen offset:0 lds
    buffer_load_dwordx4 v149, s[52:55], s34 offen offset:1024 lds
    buffer_load_dwordx4 v150, s[52:55], s34 offen offset:2048 lds
    s_cmp_eq_u32 s63, 0
    s_cselect_b32 s56, s4, s18
    s_cselect_b32 s57, s5, s19
    s_mov_b32 s58, 1280
    s_cmov_b32 s58, 2621440
    s_mov_b32 s59, 0x00020000
    buffer_load_dword v130, v1, s[24:27], s37 offen sc1
    s_waitcnt vmcnt(18)
    s_barrier
    s_setprio 3
L_poll2_3:
    s_waitcnt vmcnt(0)
    v_cmp_ne_u32 vcc, s33, v130
    s_nop 1
    s_cmp_eq_u64 vcc, 0
    s_cbranch_scc1 L_poll2x_3
    s_sub_u32 s36, s36, 1
    s_cbranch_scc1 L_poll2x_3
    buffer_load_dword v130, v1, s[24:27], s37 offen sc1
    s_branch L_poll2_3
L_poll2x_3:
    s_setprio 0
    s_cmp_ge_u32 s47, 27
    s_cselect_b32 s35, 27648, 0
    s_sub_u32 s35, s41, s35
    s_add_u32 s35, s35, 0
    buffer_load_dwordx4 v[98:101], v138, s[24:27], s35 offen sc1
    s_add_u32 s35, s35, s42
    buffer_load_dwordx4 v[102:105], v138, s[24:27], s35 offen sc1
    s_add_u32 m0, s45, 5120
    s_add_u32 s34, s40, 51200
    s_mov_b64 exec, s[60:61]
    buffer_load_dwordx4 v138, s[24:27], s34 offen offset:0 sc1 lds
    buffer_load_dwordx4 v138, s[24:27], s34 offen offset:640 sc1 lds
    s_add_u32 m0, s46, 5248
    s_add_u32 s34, s34, 5120
    buffer_load_dwordx4 v138, s[24:27], s34 offen offset:0 sc1 lds
    s_sub_u32 s34, s34, 16
    buffer_load_dwordx4 v138, s[24:27], s34 offen offset:656 sc1 lds
    s_cmp_ge_u32 s47, 26
    s_cselect_b32 s35, 27648, 0
    s_sub_u32 s35, s41, s35
    s_add_u32 s35, s35, 1024
    s_mov_b64 exec, -1
    buffer_load_dwordx4 v[106:109], v138, s[24:27], s35 offen sc1
    s_add_u32 s35, s35, s42
    buffer_load_dwordx4 v[110:113], v138, s[24:27], s35 offen sc1
    s_cmp_ge_u32 s47, 25
    s_cselect_b32 s35, 27648, 0
    s_sub_u32 s35, s41, s35
    s_add_u32 s35, s35, 2048
    buffer_load_dwordx4 v[114:117], v138, s[24:27], s35 offen sc1
    s_add_u32 s35, s35, s42
    buffer_load_dwordx4 v[118:121], v138, s[24:27], s35 offen sc1
    s_add_u32 m0, s66, 15360
    s_add_u32 s34, s68, 0
    buffer_load_dwordx4 v144, s[52:55], s34 offen offset:0 lds
    buffer_load_dwordx4 v145, s[52:55], s34 offen offset:1024 lds
    buffer_load_dwordx4 v146, s[52:55], s34 offen offset:2048 lds
    s_lshl_b32 s34, s3, 10
    s_lshl4_add_u32 s34, s62, s34
    s_add_u32 s34, s34, 17563648
    buffer_load_dwordx2 v[164:165], v167, s[24:27], s34 offen offset:8 sc1
    ds_read_b64_tr_b16 v[152:153], v140 offset:0
    ds_read_b64_tr_b16 v[154:155], v140 offset:1536
    ds_read_b64_tr_b16 v[156:157], v140 offset:64
    ds_read_b64_tr_b16 v[158:159], v140 offset:1600
    s_barrier
    s_waitcnt vmcnt(12)
    s_waitcnt lgkmcnt(2)
    v_mfma_f32_32x32x16_bf16 v[2:17], v[152:155], v[98:101], 0
    ds_read_b64_tr_b16 v[160:161], v140 offset:128
    ds_read_b64_tr_b16 v[162:163], v140 offset:1664
    s_add_u32 m0, s45, 10240
    s_add_u32 s34, s40, 61440
    s_mov_b64 exec, s[60:61]
    buffer_load_dwordx4 v138, s[24:27], s34 offen offset:0 sc1 lds
    buffer_load_dwordx4 v138, s[24:27], s34 offen offset:640 sc1 lds
    s_mov_b64 exec, -1
    v_mfma_f32_32x32x16_bf16 v[50:65], v[152:155], v[102:105], 0
    s_add_u32 m0, s46, 10496
    s_add_u32 s34, s34, 5120
    s_mov_b64 exec, s[60:61]
    buffer_load_dwordx4 v138, s[24:27], s34 offen offset:0 sc1 lds
    s_sub_u32 s34, s34, 16
    buffer_load_dwordx4 v138, s[24:27], s34 offen offset:656 sc1 lds
    s_mov_b64 exec, -1
    s_waitcnt lgkmcnt(2)
    v_mfma_f32_32x32x16_bf16 v[18:33], v[156:159], v[98:101], 0
    ds_read_b64_tr_b16 v[152:153], v140 offset:3072
    ds_read_b64_tr_b16 v[154:155], v140 offset:4608
    s_add_u32 m0, s66, 9216
    s_cmp_ge_u32 s47, 24
    s_cselect_b32 s34, 552960, 0
    s_sub_u32 s34, s43, s34
    s_add_u32 s34, s34, 61440
    buffer_load_dwordx4 v144, s[48:51], s34 offen offset:0 lds
    v_mfma_f32_32x32x16_bf16 v[66:81], v[156:159], v[102:105], 0
    buffer_load_dwordx4 v145, s[48:51], s34 offen offset:1024 lds
    s_waitcnt lgkmcnt(2)
    v_mfma_f32_32x32x16_bf16 v[34:49], v[160:163], v[98:101], 0
    ds_read_b64_tr_b16 v[156:157], v140 offset:3136
    ds_read_b64_tr_b16 v[158:159], v140 offset:4672
    buffer_load_dwordx4 v146, s[48:51], s34 offen offset:2048 lds
    v_mfma_f32_32x32x16_bf16 v[82:97], v[160:163], v[102:105], 0
    s_cmp_ge_u32 s47, 24
    s_cselect_b32 s35, 27648, 0
    s_sub_u32 s35, s41, s35
    s_add_u32 s35, s35, 3072
    buffer_load_dwordx4 v[122:125], v138, s[24:27], s35 offen sc1
    s_waitcnt vmcnt(14)
    s_waitcnt lgkmcnt(2)
    v_mfma_f32_32x32x16_bf16 v[2:17], v[152:155], v[106:109], v[2:17]
    ds_read_b64_tr_b16 v[160:161], v140 offset:3200
    ds_read_b64_tr_b16 v[162:163], v140 offset:4736
    s_add_u32 s35, s35, s42
    buffer_load_dwordx4 v[126:129], v138, s[24:27], s35 offen sc1
    s_add_u32 m0, s66, 0
    s_cmp_ge_u32 s47, 23
    s_cselect_b32 s34, 552960, 0
    s_sub_u32 s34, s43, s34
    s_add_u32 s34, s34, 81920
    buffer_load_dwordx4 v144, s[48:51], s34 offen offset:0 lds
    v_mfma_f32_32x32x16_bf16 v[50:65], v[152:155], v[110:113], v[50:65]
    buffer_load_dwordx4 v145, s[48:51], s34 offen offset:1024 lds
    s_waitcnt lgkmcnt(2)
    v_mfma_f32_32x32x16_bf16 v[18:33], v[156:159], v[106:109], v[18:33]
    ds_read_b64_tr_b16 v[152:153], v140 offset:6144
    ds_read_b64_tr_b16 v[154:155], v140 offset:7680
    buffer_load_dwordx4 v146, s[48:51], s34 offen offset:2048 lds
    v_mfma_f32_32x32x16_bf16 v[66:81], v[156:159], v[110:113], v[66:81]
    s_cmp_ge_u32 s47, 23
    s_cselect_b32 s35, 27648, 0
    s_sub_u32 s35, s41, s35
    s_add_u32 s35, s35, 4096
    buffer_load_dwordx4 v[98:101], v138, s[24:27], s35 offen sc1
    s_waitcnt lgkmcnt(2)
    v_mfma_f32_32x32x16_bf16 v[34:49], v[160:163], v[106:109], v[34:49]
    ds_read_b64_tr_b16 v[156:157], v140 offset:6208
    ds_read_b64_tr_b16 v[158:159], v140 offset:7744
    s_add_u32 s35, s35, s42
    buffer_load_dwordx4 v[102:105], v138, s[24:27], s35 offen sc1
    v_mfma_f32_32x32x16_bf16 v[82:97], v[160:163], v[110:113], v[82:97]
    s_waitcnt vmcnt(18)
    s_waitcnt lgkmcnt(2)
    v_mfma_f32_32x32x16_bf16 v[2:17], v[152:155], v[114:117], v[2:17]
    ds_read_b64_tr_b16 v[160:161], v140 offset:6272
    ds_read_b64_tr_b16 v[162:163], v140 offset:7808
    s_add_u32 m0, s66, 3072
    s_cmp_ge_u32 s47, 22
    s_cselect_b32 s34, 552960, 0
    s_sub_u32 s34, s43, s34
    s_add_u32 s34, s34, 102400
    buffer_load_dwordx4 v144, s[48:51], s34 offen offset:0 lds
    v_mfma_f32_32x32x16_bf16 v[50:65], v[152:155], v[118:121], v[50:65]
    buffer_load_dwordx4 v145, s[48:51], s34 offen offset:1024 lds
    s_waitcnt lgkmcnt(2)
    v_mfma_f32_32x32x16_bf16 v[18:33], v[156:159], v[114:117], v[18:33]
    s_waitcnt vmcnt(9)
    ds_read_b64_tr_b16 v[152:153], v140 offset:9216
    ds_read_b64_tr_b16 v[154:155], v140 offset:10752
    buffer_load_dwordx4 v146, s[48:51], s34 offen offset:2048 lds
    v_mfma_f32_32x32x16_bf16 v[66:81], v[156:159], v[118:121], v[66:81]
    s_cmp_ge_u32 s47, 22
    s_cselect_b32 s35, 27648, 0
    s_sub_u32 s35, s41, s35
    s_add_u32 s35, s35, 5120
    buffer_load_dwordx4 v[106:109], v138, s[24:27], s35 offen sc1
    s_barrier
    s_waitcnt lgkmcnt(2)
    v_mfma_f32_32x32x16_bf16 v[34:49], v[160:163], v[114:117], v[34:49]
    ds_read_b64_tr_b16 v[156:157], v140 offset:9280
    ds_read_b64_tr_b16 v[158:159], v140 offset:10816
    s_add_u32 s35, s35, s42
    buffer_load_dwordx4 v[110:113], v138, s[24:27], s35 offen sc1
    v_mfma_f32_32x32x16_bf16 v[82:97], v[160:163], v[118:121], v[82:97]
    s_add_u32 m0, s45, 15360
    s_add_u32 s34, s40, 71680
    s_mov_b64 exec, s[60:61]
    buffer_load_dwordx4 v138, s[24:27], s34 offen offset:0 sc1 lds
    s_mov_b64 exec, -1
    s_waitcnt vmcnt(11)
    s_waitcnt lgkmcnt(2)
    v_mfma_f32_32x32x16_bf16 v[2:17], v[152:155], v[122:125], v[2:17]
    ds_read_b64_tr_b16 v[160:161], v140 offset:9344
    ds_read_b64_tr_b16 v[162:163], v140 offset:10880
    s_mov_b64 exec, s[60:61]
    buffer_load_dwordx4 v138, s[24:27], s34 offen offset:640 sc1 lds
    s_add_u32 m0, s46, 15744
    s_add_u32 s34, s34, 5120
    buffer_load_dwordx4 v138, s[24:27], s34 offen offset:0 sc1 lds
    s_mov_b64 exec, -1
    v_mfma_f32_32x32x16_bf16 v[50:65], v[152:155], v[126:129], v[50:65]
    s_sub_u32 s34, s34, 16
    s_mov_b64 exec, s[60:61]
    buffer_load_dwordx4 v138, s[24:27], s34 offen offset:656 sc1 lds
    s_add_u32 m0, s66, 6144
    s_cmp_ge_u32 s47, 21
    s_cselect_b32 s34, 552960, 0
    s_sub_u32 s34, s43, s34
    s_add_u32 s34, s34, 122880
    s_mov_b64 exec, -1
    buffer_load_dwordx4 v144, s[48:51], s34 offen offset:0 lds
    s_waitcnt lgkmcnt(2)
    v_mfma_f32_32x32x16_bf16 v[18:33], v[156:159], v[122:125], v[18:33]
    s_waitcnt vmcnt(12)
    ds_read_b64_tr_b16 v[152:153], v140 offset:0
    ds_read_b64_tr_b16 v[154:155], v140 offset:1536
    buffer_load_dwordx4 v145, s[48:51], s34 offen offset:1024 lds
    v_mfma_f32_32x32x16_bf16 v[66:81], v[156:159], v[126:129], v[66:81]
    buffer_load_dwordx4 v146, s[48:51], s34 offen offset:2048 lds
    s_waitcnt lgkmcnt(2)
    v_mfma_f32_32x32x16_bf16 v[34:49], v[160:163], v[122:125], v[34:49]
    ds_read_b64_tr_b16 v[156:157], v140 offset:64
    ds_read_b64_tr_b16 v[158:159], v140 offset:1600
    s_cmp_ge_u32 s47, 21
    s_cselect_b32 s35, 27648, 0
    s_sub_u32 s35, s41, s35
    s_add_u32 s35, s35, 6144
    buffer_load_dwordx4 v[114:117], v138, s[24:27], s35 offen sc1
    v_mfma_f32_32x32x16_bf16 v[82:97], v[160:163], v[126:129], v[82:97]
    s_add_u32 s35, s35, s42
    buffer_load_dwordx4 v[118:121], v138, s[24:27], s35 offen sc1
    s_waitcnt vmcnt(14)
    s_waitcnt lgkmcnt(2)
    v_mfma_f32_32x32x16_bf16 v[2:17], v[152:155], v[98:101], v[2:17]
    ds_read_b64_tr_b16 v[160:161], v140 offset:128
    ds_read_b64_tr_b16 v[162:163], v140 offset:1664
    s_add_u32 m0, s66, 9216
    s_cmp_ge_u32 s47, 20
    s_cselect_b32 s34, 552960, 0
    s_sub_u32 s34, s43, s34
    s_add_u32 s34, s34, 143360
    buffer_load_dwordx4 v144, s[48:51], s34 offen offset:0 lds
    v_mfma_f32_32x32x16_bf16 v[50:65], v[152:155], v[102:105], v[50:65]
    buffer_load_dwordx4 v145, s[48:51], s34 offen offset:1024 lds
    s_waitcnt lgkmcnt(2)
    v_mfma_f32_32x32x16_bf16 v[18:33], v[156:159], v[98:101], v[18:33]
    s_waitcnt vmcnt(13)
    ds_read_b64_tr_b16 v[152:153], v140 offset:3072
    ds_read_b64_tr_b16 v[154:155], v140 offset:4608
    buffer_load_dwordx4 v146, s[48:51], s34 offen offset:2048 lds
    v_mfma_f32_32x32x16_bf16 v[66:81], v[156:159], v[102:105], v[66:81]
    s_cmp_ge_u32 s47, 20
    s_cselect_b32 s35, 27648, 0
    s_sub_u32 s35, s41, s35
    s_add_u32 s35, s35, 7168
    buffer_load_dwordx4 v[122:125], v138, s[24:27], s35 offen sc1
    s_waitcnt lgkmcnt(2)
    v_mfma_f32_32x32x16_bf16 v[34:49], v[160:163], v[98:101], v[34:49]
    ds_read_b64_tr_b16 v[156:157], v140 offset:3136
    ds_read_b64_tr_b16 v[158:159], v140 offset:4672
    s_add_u32 s35, s35, s42
    buffer_load_dwordx4 v[126:129], v138, s[24:27], s35 offen sc1
    v_mfma_f32_32x32x16_bf16 v[82:97], v[160:163], v[102:105], v[82:97]
    s_waitcnt vmcnt(14)
    s_waitcnt lgkmcnt(2)
    v_mfma_f32_32x32x16_bf16 v[2:17], v[152:155], v[106:109], v[2:17]
    ds_read_b64_tr_b16 v[160:161], v140 offset:3200
    ds_read_b64_tr_b16 v[162:163], v140 offset:4736
    s_add_u32 m0, s66, 0
    s_cmp_ge_u32 s47, 19
    s_cselect_b32 s34, 552960, 0
    s_sub_u32 s34, s43, s34
    s_add_u32 s34, s34, 163840
    buffer_load_dwordx4 v144, s[48:51], s34 offen offset:0 lds
    v_mfma_f32_32x32x16_bf16 v[50:65], v[152:155], v[110:113], v[50:65]
    buffer_load_dwordx4 v145, s[48:51], s34 offen offset:1024 lds
    s_barrier
    s_waitcnt lgkmcnt(2)
    v_mfma_f32_32x32x16_bf16 v[18:33], v[156:159], v[106:109], v[18:33]
    s_waitcnt vmcnt(9)
    ds_read_b64_tr_b16 v[152:153], v140 offset:6144
    ds_read_b64_tr_b16 v[154:155], v140 offset:7680
    buffer_load_dwordx4 v146, s[48:51], s34 offen offset:2048 lds
    s_cmp_ge_u32 s47, 19
    s_cselect_b32 s35, 27648, 0
    s_sub_u32 s35, s41, s35
    s_add_u32 s35, s35, 8192
    buffer_load_dwordx4 v[98:101], v138, s[24:27], s35 offen sc1
    v_mfma_f32_32x32x16_bf16 v[66:81], v[156:159], v[110:113], v[66:81]
    s_add_u32 s35, s35, s42
    buffer_load_dwordx4 v[102:105], v138, s[24:27], s35 offen sc1
    s_add_u32 m0, s45, 0
    s_add_u32 s34, s40, 81920
    s_mov_b64 exec, s[60:61]
    buffer_load_dwordx4 v138, s[24:27], s34 offen offset:0 sc1 lds
    s_mov_b64 exec, -1
    s_waitcnt lgkmcnt(2)
    v_mfma_f32_32x32x16_bf16 v[34:49], v[160:163], v[106:109], v[34:49]
    ds_read_b64_tr_b16 v[156:157], v140 offset:6208
    ds_read_b64_tr_b16 v[158:159], v140 offset:7744
    s_mov_b64 exec, s[60:61]
    buffer_load_dwordx4 v138, s[24:27], s34 offen offset:640 sc1 lds
    s_add_u32 m0, s46, 0
    s_add_u32 s34, s34, 5120
    buffer_load_dwordx4 v138, s[24:27], s34 offen offset:0 sc1 lds
    s_mov_b64 exec, -1
    v_mfma_f32_32x32x16_bf16 v[82:97], v[160:163], v[110:113], v[82:97]
    s_sub_u32 s34, s34, 16
    s_mov_b64 exec, s[60:61]
    buffer_load_dwordx4 v138, s[24:27], s34 offen offset:656 sc1 lds
    s_mov_b64 exec, -1
    s_waitcnt vmcnt(14)
    s_waitcnt lgkmcnt(2)
    v_mfma_f32_32x32x16_bf16 v[2:17], v[152:155], v[114:117], v[2:17]
    ds_read_b64_tr_b16 v[160:161], v140 offset:6272
    ds_read_b64_tr_b16 v[162:163], v140 offset:7808
    s_add_u32 m0, s66, 18432
    s_add_u32 s34, s68, 25600
    buffer_load_dwordx4 v144, s[52:55], s34 offen offset:0 lds
    buffer_load_dwordx4 v145, s[52:55], s34 offen offset:1024 lds
    v_mfma_f32_32x32x16_bf16 v[50:65], v[152:155], v[118:121], v[50:65]
    buffer_load_dwordx4 v146, s[52:55], s34 offen offset:2048 lds
    s_add_u32 m0, s66, 3072
    s_cmp_ge_u32 s47, 18
    s_cselect_b32 s34, 552960, 0
    s_sub_u32 s34, s43, s34
    s_add_u32 s34, s34, 184320
    buffer_load_dwordx4 v144, s[48:51], s34 offen offset:0 lds
    s_waitcnt lgkmcnt(2)
    v_mfma_f32_32x32x16_bf16 v[18:33], v[156:159], v[114:117], v[18:33]
    s_waitcnt vmcnt(15)
    ds_read_b64_tr_b16 v[152:153], v140 offset:9216
    ds_read_b64_tr_b16 v[154:155], v140 offset:10752
    buffer_load_dwordx4 v145, s[48:51], s34 offen offset:1024 lds
    v_mfma_f32_32x32x16_bf16 v[66:81], v[156:159], v[118:121], v[66:81]
    buffer_load_dwordx4 v146, s[48:51], s34 offen offset:2048 lds
    s_waitcnt lgkmcnt(2)
    v_mfma_f32_32x32x16_bf16 v[34:49], v[160:163], v[114:117], v[34:49]
    ds_read_b64_tr_b16 v[156:157], v140 offset:9280
    ds_read_b64_tr_b16 v[158:159], v140 offset:10816
    s_cmp_ge_u32 s47, 18
    s_cselect_b32 s35, 27648, 0
    s_sub_u32 s35, s41, s35
    s_add_u32 s35, s35, 9216
    buffer_load_dwordx4 v[106:109], v138, s[24:27], s35 offen sc1
    v_mfma_f32_32x32x16_bf16 v[82:97], v[160:163], v[118:121], v[82:97]
    s_add_u32 s35, s35, s42
    buffer_load_dwordx4 v[110:113], v138, s[24:27], s35 offen sc1
    s_waitcnt vmcnt(17)
    s_waitcnt lgkmcnt(2)
    v_mfma_f32_32x32x16_bf16 v[2:17], v[152:155], v[122:125], v[2:17]
    ds_read_b64_tr_b16 v[160:161], v140 offset:9344
    ds_read_b64_tr_b16 v[162:163], v140 offset:10880
    s_add_u32 m0, s66, 6144
    s_cmp_ge_u32 s47, 17
    s_cselect_b32 s34, 552960, 0
    s_sub_u32 s34, s43, s34
    s_add_u32 s34, s34, 204800
    buffer_load_dwordx4 v144, s[48:51], s34 offen offset:0 lds
    v_mfma_f32_32x32x16_bf16 v[50:65], v[152:155], v[126:129], v[50:65]
    buffer_load_dwordx4 v145, s[48:51], s34 offen offset:1024 lds
    s_waitcnt lgkmcnt(2)
    v_mfma_f32_32x32x16_bf16 v[18:33], v[156:159], v[122:125], v[18:33]
    s_waitcnt vmcnt(16)
    ds_read_b64_tr_b16 v[152:153], v140 offset:0
    ds_read_b64_tr_b16 v[154:155], v140 offset:1536
    buffer_load_dwordx4 v146, s[48:51], s34 offen offset:2048 lds
    v_mfma_f32_32x32x16_bf16 v[66:81], v[156:159], v[126:129], v[66:81]
    s_cmp_ge_u32 s47, 17
    s_cselect_b32 s35, 27648, 0
    s_sub_u32 s35, s41, s35
    s_add_u32 s35, s35, 10240
    buffer_load_dwordx4 v[114:117], v138, s[24:27], s35 offen sc1
    s_barrier
    s_waitcnt lgkmcnt(2)
    v_mfma_f32_32x32x16_bf16 v[34:49], v[160:163], v[122:125], v[34:49]
    ds_read_b64_tr_b16 v[156:157], v140 offset:64
    ds_read_b64_tr_b16 v[158:159], v140 offset:1600
    s_add_u32 s35, s35, s42
    buffer_load_dwordx4 v[118:121], v138, s[24:27], s35 offen sc1
    v_mfma_f32_32x32x16_bf16 v[82:97], v[160:163], v[126:129], v[82:97]
    s_add_u32 m0, s45, 5120
    s_add_u32 s34, s40, 92160
    s_mov_b64 exec, s[60:61]
    buffer_load_dwordx4 v138, s[24:27], s34 offen offset:0 sc1 lds
    s_mov_b64 exec, -1
    s_waitcnt vmcnt(18)
    s_waitcnt lgkmcnt(2)
    v_mfma_f32_32x32x16_bf16 v[2:17], v[152:155], v[98:101], v[2:17]
    ds_read_b64_tr_b16 v[160:161], v140 offset:128
    ds_read_b64_tr_b16 v[162:163], v140 offset:1664
    s_mov_b64 exec, s[60:61]
    buffer_load_dwordx4 v138, s[24:27], s34 offen offset:640 sc1 lds
    s_add_u32 m0, s46, 5248
    s_add_u32 s34, s34, 5120
    buffer_load_dwordx4 v138, s[24:27], s34 offen offset:0 sc1 lds
    s_mov_b64 exec, -1
    v_mfma_f32_32x32x16_bf16 v[50:65], v[152:155], v[102:105], v[50:65]
    s_sub_u32 s34, s34, 16
    s_mov_b64 exec, s[60:61]
    buffer_load_dwordx4 v138, s[24:27], s34 offen offset:656 sc1 lds
    s_add_u32 m0, s66, 9216
    s_cmp_ge_u32 s47, 16
    s_cselect_b32 s34, 552960, 0
    s_sub_u32 s34, s43, s34
    s_add_u32 s34, s34, 225280
    s_mov_b64 exec, -1
    buffer_load_dwordx4 v144, s[48:51], s34 offen offset:0 lds
    s_waitcnt lgkmcnt(2)
    v_mfma_f32_32x32x16_bf16 v[18:33], v[156:159], v[98:101], v[18:33]
    s_waitcnt vmcnt(12)
    ds_read_b64_tr_b16 v[152:153], v140 offset:3072
    ds_read_b64_tr_b16 v[154:155], v140 offset:4608
    buffer_load_dwordx4 v145, s[48:51], s34 offen offset:1024 lds
    v_mfma_f32_32x32x16_bf16 v[66:81], v[156:159], v[102:105], v[66:81]
    buffer_load_dwordx4 v146, s[48:51], s34 offen offset:2048 lds
    s_waitcnt lgkmcnt(2)
    v_mfma_f32_32x32x16_bf16 v[34:49], v[160:163], v[98:101], v[34:49]
    ds_read_b64_tr_b16 v[156:157], v140 offset:3136
    ds_read_b64_tr_b16 v[158:159], v140 offset:4672
    s_cmp_ge_u32 s47, 16
    s_cselect_b32 s35, 27648, 0
    s_sub_u32 s35, s41, s35
    s_add_u32 s35, s35, 11264
    buffer_load_dwordx4 v[122:125], v138, s[24:27], s35 offen sc1
    v_mfma_f32_32x32x16_bf16 v[82:97], v[160:163], v[102:105], v[82:97]
    s_add_u32 s35, s35, s42
    buffer_load_dwordx4 v[126:129], v138, s[24:27], s35 offen sc1
    s_waitcnt vmcnt(14)
    s_waitcnt lgkmcnt(2)
    v_mfma_f32_32x32x16_bf16 v[2:17], v[152:155], v[106:109], v[2:17]
    ds_read_b64_tr_b16 v[160:161], v140 offset:3200
    ds_read_b64_tr_b16 v[162:163], v140 offset:4736
    s_add_u32 m0, s66, 0
    s_cmp_ge_u32 s47, 15
    s_cselect_b32 s34, 552960, 0
    s_sub_u32 s34, s43, s34
    s_add_u32 s34, s34, 245760
    buffer_load_dwordx4 v144, s[48:51], s34 offen offset:0 lds
    v_mfma_f32_32x32x16_bf16 v[50:65], v[152:155], v[110:113], v[50:65]
    buffer_load_dwordx4 v145, s[48:51], s34 offen offset:1024 lds
    s_waitcnt lgkmcnt(2)
    v_mfma_f32_32x32x16_bf16 v[18:33], v[156:159], v[106:109], v[18:33]
    s_waitcnt vmcnt(13)
    ds_read_b64_tr_b16 v[152:153], v140 offset:6144
    ds_read_b64_tr_b16 v[154:155], v140 offset:7680
    buffer_load_dwordx4 v146, s[48:51], s34 offen offset:2048 lds
    v_mfma_f32_32x32x16_bf16 v[66:81], v[156:159], v[110:113], v[66:81]
    s_cmp_ge_u32 s47, 15
    s_cselect_b32 s35, 27648, 0
    s_sub_u32 s35, s41, s35
    s_add_u32 s35, s35, 12288
    buffer_load_dwordx4 v[98:101], v138, s[24:27], s35 offen sc1
    s_waitcnt lgkmcnt(2)
    v_mfma_f32_32x32x16_bf16 v[34:49], v[160:163], v[106:109], v[34:49]
    ds_read_b64_tr_b16 v[156:157], v140 offset:6208
    ds_read_b64_tr_b16 v[158:159], v140 offset:7744
    s_add_u32 s35, s35, s42
    buffer_load_dwordx4 v[102:105], v138, s[24:27], s35 offen sc1
    v_mfma_f32_32x32x16_bf16 v[82:97], v[160:163], v[110:113], v[82:97]
    s_waitcnt vmcnt(14)
    s_waitcnt lgkmcnt(2)
    v_mfma_f32_32x32x16_bf16 v[2:17], v[152:155], v[114:117], v[2:17]
    ds_read_b64_tr_b16 v[160:161], v140 offset:6272
    ds_read_b64_tr_b16 v[162:163], v140 offset:7808
    s_add_u32 m0, s66, 3072
    s_cmp_ge_u32 s47, 14
    s_cselect_b32 s34, 552960, 0
    s_sub_u32 s34, s43, s34
    s_add_u32 s34, s34, 266240
    buffer_load_dwordx4 v144, s[48:51], s34 offen offset:0 lds
    v_mfma_f32_32x32x16_bf16 v[50:65], v[152:155], v[118:121], v[50:65]
    buffer_load_dwordx4 v145, s[48:51], s34 offen offset:1024 lds
    s_barrier
    s_waitcnt lgkmcnt(2)
    v_mfma_f32_32x32x16_bf16 v[18:33], v[156:159], v[114:117], v[18:33]
    s_waitcnt vmcnt(9)
    ds_read_b64_tr_b16 v[152:153], v140 offset:9216
    ds_read_b64_tr_b16 v[154:155], v140 offset:10752
    buffer_load_dwordx4 v146, s[48:51], s34 offen offset:2048 lds
    s_cmp_ge_u32 s47, 14
    s_cselect_b32 s35, 27648, 0
    s_sub_u32 s35, s41, s35
    s_add_u32 s35, s35, 13312
    buffer_load_dwordx4 v[106:109], v138, s[24:27], s35 offen sc1
    v_mfma_f32_32x32x16_bf16 v[66:81], v[156:159], v[118:121], v[66:81]
    s_add_u32 s35, s35, s42
    buffer_load_dwordx4 v[110:113], v138, s[24:27], s35 offen sc1
    s_waitcnt lgkmcnt(2)
    v_mfma_f32_32x32x16_bf16 v[34:49], v[160:163], v[114:117], v[34:49]
    ds_read_b64_tr_b16 v[156:157], v140 offset:9280
    ds_read_b64_tr_b16 v[158:159], v140 offset:10816
    s_add_u32 m0, s45, 10240
    s_add_u32 s34, s40, 102400
    s_mov_b64 exec, s[60:61]
    buffer_load_dwordx4 v138, s[24:27], s34 offen offset:0 sc1 lds
    s_mov_b64 exec, -1
    v_mfma_f32_32x32x16_bf16 v[82:97], v[160:163], v[118:121], v[82:97]
    s_mov_b64 exec, s[60:61]
    buffer_load_dwordx4 v138, s[24:27], s34 offen offset:640 sc1 lds
    s_mov_b64 exec, -1
    s_waitcnt vmcnt(12)
    s_waitcnt lgkmcnt(2)
    v_mfma_f32_32x32x16_bf16 v[2:17], v[152:155], v[122:125], v[2:17]
    ds_read_b64_tr_b16 v[160:161], v140 offset:9344
    ds_read_b64_tr_b16 v[162:163], v140 offset:10880
    s_add_u32 m0, s46, 10496
    s_add_u32 s34, s34, 5120
    s_mov_b64 exec, s[60:61]
    buffer_load_dwordx4 v138, s[24:27], s34 offen offset:0 sc1 lds
    s_sub_u32 s34, s34, 16
    buffer_load_dwordx4 v138, s[24:27], s34 offen offset:656 sc1 lds
    s_mov_b64 exec, -1
    v_mfma_f32_32x32x16_bf16 v[50:65], v[152:155], v[126:129], v[50:65]
    s_add_u32 m0, s66, 6144
    s_cmp_ge_u32 s47, 13
    s_cselect_b32 s34, 552960, 0
    s_sub_u32 s34, s43, s34
    s_add_u32 s34, s34, 286720
    buffer_load_dwordx4 v144, s[48:51], s34 offen offset:0 lds
    s_waitcnt lgkmcnt(2)
    v_mfma_f32_32x32x16_bf16 v[18:33], v[156:159], v[122:125], v[18:33]
    s_waitcnt vmcnt(12)
    ds_read_b64_tr_b16 v[152:153], v140 offset:0
    ds_read_b64_tr_b16 v[154:155], v140 offset:1536
    buffer_load_dwordx4 v145, s[48:51], s34 offen offset:1024 lds
    v_mfma_f32_32x32x16_bf16 v[66:81], v[156:159], v[126:129], v[66:81]
    buffer_load_dwordx4 v146, s[48:51], s34 offen offset:2048 lds
    s_waitcnt lgkmcnt(2)
    v_mfma_f32_32x32x16_bf16 v[34:49], v[160:163], v[122:125], v[34:49]
    ds_read_b64_tr_b16 v[156:157], v140 offset:64
    ds_read_b64_tr_b16 v[158:159], v140 offset:1600
    s_cmp_ge_u32 s47, 13
    s_cselect_b32 s35, 27648, 0
    s_sub_u32 s35, s41, s35
    s_add_u32 s35, s35, 14336
    buffer_load_dwordx4 v[114:117], v138, s[24:27], s35 offen sc1
    v_mfma_f32_32x32x16_bf16 v[82:97], v[160:163], v[126:129], v[82:97]
    s_add_u32 s35, s35, s42
    buffer_load_dwordx4 v[118:121], v138, s[24:27], s35 offen sc1
    s_waitcnt vmcnt(14)
    s_waitcnt lgkmcnt(2)
    v_mfma_f32_32x32x16_bf16 v[2:17], v[152:155], v[98:101], v[2:17]
    ds_read_b64_tr_b16 v[160:161], v140 offset:128
    ds_read_b64_tr_b16 v[162:163], v140 offset:1664
    s_add_u32 m0, s66, 9216
    s_cmp_ge_u32 s47, 12
    s_cselect_b32 s34, 552960, 0
    s_sub_u32 s34, s43, s34
    s_add_u32 s34, s34, 307200
    buffer_load_dwordx4 v144, s[48:51], s34 offen offset:0 lds
    v_mfma_f32_32x32x16_bf16 v[50:65], v[152:155], v[102:105], v[50:65]
    buffer_load_dwordx4 v145, s[48:51], s34 offen offset:1024 lds
    s_waitcnt lgkmcnt(2)
    v_mfma_f32_32x32x16_bf16 v[18:33], v[156:159], v[98:101], v[18:33]
    s_waitcnt vmcnt(13)
    ds_read_b64_tr_b16 v[152:153], v140 offset:3072
    ds_read_b64_tr_b16 v[154:155], v140 offset:4608
    buffer_load_dwordx4 v146, s[48:51], s34 offen offset:2048 lds
    v_mfma_f32_32x32x16_bf16 v[66:81], v[156:159], v[102:105], v[66:81]
    s_cmp_ge_u32 s47, 12
    s_cselect_b32 s35, 27648, 0
    s_sub_u32 s35, s41, s35
    s_add_u32 s35, s35, 15360
    buffer_load_dwordx4 v[122:125], v138, s[24:27], s35 offen sc1
    s_barrier
    s_waitcnt lgkmcnt(2)
    v_mfma_f32_32x32x16_bf16 v[34:49], v[160:163], v[98:101], v[34:49]
    ds_read_b64_tr_b16 v[156:157], v140 offset:3136
    ds_read_b64_tr_b16 v[158:159], v140 offset:4672
    s_add_u32 s35, s35, s42
    buffer_load_dwordx4 v[126:129], v138, s[24:27], s35 offen sc1
    s_add_u32 m0, s45, 15360
    s_add_u32 s34, s40, 112640
    s_mov_b64 exec, s[60:61]
    buffer_load_dwordx4 v138, s[24:27], s34 offen offset:0 sc1 lds
    s_mov_b64 exec, -1
    v_mfma_f32_32x32x16_bf16 v[82:97], v[160:163], v[102:105], v[82:97]
    s_mov_b64 exec, s[60:61]
    buffer_load_dwordx4 v138, s[24:27], s34 offen offset:640 sc1 lds
    s_add_u32 m0, s46, 15744
    s_add_u32 s34, s34, 5120
    buffer_load_dwordx4 v138, s[24:27], s34 offen offset:0 sc1 lds
    s_mov_b64 exec, -1
    s_waitcnt vmcnt(17)
    s_waitcnt lgkmcnt(2)
    v_mfma_f32_32x32x16_bf16 v[2:17], v[152:155], v[106:109], v[2:17]
    ds_read_b64_tr_b16 v[160:161], v140 offset:3200
    ds_read_b64_tr_b16 v[162:163], v140 offset:4736
    s_sub_u32 s34, s34, 16
    s_mov_b64 exec, s[60:61]
    buffer_load_dwordx4 v138, s[24:27], s34 offen offset:656 sc1 lds
    s_add_u32 m0, s66, 21504
    s_add_u32 s34, s68, 51200
    s_mov_b64 exec, -1
    buffer_load_dwordx4 v144, s[52:55], s34 offen offset:0 lds
    v_mfma_f32_32x32x16_bf16 v[50:65], v[152:155], v[110:113], v[50:65]
    buffer_load_dwordx4 v145, s[52:55], s34 offen offset:1024 lds
    buffer_load_dwordx4 v146, s[52:55], s34 offen offset:2048 lds
    s_waitcnt lgkmcnt(2)
    v_mfma_f32_32x32x16_bf16 v[18:33], v[156:159], v[106:109], v[18:33]
    s_waitcnt vmcnt(14)
    ds_read_b64_tr_b16 v[152:153], v140 offset:6144
    ds_read_b64_tr_b16 v[154:155], v140 offset:7680
    s_add_u32 m0, s66, 0
    s_cmp_ge_u32 s47, 11
    s_cselect_b32 s34, 552960, 0
    s_sub_u32 s34, s43, s34
    s_add_u32 s34, s34, 327680
    buffer_load_dwordx4 v144, s[48:51], s34 offen offset:0 lds
    v_mfma_f32_32x32x16_bf16 v[66:81], v[156:159], v[110:113], v[66:81]
    buffer_load_dwordx4 v145, s[48:51], s34 offen offset:1024 lds
    s_waitcnt lgkmcnt(2)
    v_mfma_f32_32x32x16_bf16 v[34:49], v[160:163], v[106:109], v[34:49]
    ds_read_b64_tr_b16 v[156:157], v140 offset:6208
    ds_read_b64_tr_b16 v[158:159], v140 offset:7744
    buffer_load_dwordx4 v146, s[48:51], s34 offen offset:2048 lds
    v_mfma_f32_32x32x16_bf16 v[82:97], v[160:163], v[110:113], v[82:97]
    s_cmp_ge_u32 s47, 11
    s_cselect_b32 s35, 27648, 0
    s_sub_u32 s35, s41, s35
    s_add_u32 s35, s35, 16384
    buffer_load_dwordx4 v[98:101], v138, s[24:27], s35 offen sc1
    s_waitcnt vmcnt(16)
    s_waitcnt lgkmcnt(2)
    v_mfma_f32_32x32x16_bf16 v[2:17], v[152:155], v[114:117], v[2:17]
    ds_read_b64_tr_b16 v[160:161], v140 offset:6272
    ds_read_b64_tr_b16 v[162:163], v140 offset:7808
    s_add_u32 s35, s35, s42
    buffer_load_dwordx4 v[102:105], v138, s[24:27], s35 offen sc1
    s_add_u32 m0, s66, 3072
    s_cmp_ge_u32 s47, 10
    s_cselect_b32 s34, 552960, 0
    s_sub_u32 s34, s43, s34
    s_add_u32 s34, s34, 348160
    buffer_load_dwordx4 v144, s[48:51], s34 offen offset:0 lds
    v_mfma_f32_32x32x16_bf16 v[50:65], v[152:155], v[118:121], v[50:65]
    buffer_load_dwordx4 v145, s[48:51], s34 offen offset:1024 lds
    s_waitcnt lgkmcnt(2)
    v_mfma_f32_32x32x16_bf16 v[18:33], v[156:159], v[114:117], v[18:33]
    s_waitcnt vmcnt(16)
    ds_read_b64_tr_b16 v[152:153], v140 offset:9216
    ds_read_b64_tr_b16 v[154:155], v140 offset:10752
    buffer_load_dwordx4 v146, s[48:51], s34 offen offset:2048 lds
    v_mfma_f32_32x32x16_bf16 v[66:81], v[156:159], v[118:121], v[66:81]
    s_cmp_ge_u32 s47, 10
    s_cselect_b32 s35, 27648, 0
    s_sub_u32 s35, s41, s35
    s_add_u32 s35, s35, 17408
    buffer_load_dwordx4 v[106:109], v138, s[24:27], s35 offen sc1
    s_waitcnt lgkmcnt(2)
    v_mfma_f32_32x32x16_bf16 v[34:49], v[160:163], v[114:117], v[34:49]
    ds_read_b64_tr_b16 v[156:157], v140 offset:9280
    ds_read_b64_tr_b16 v[158:159], v140 offset:10816
    s_add_u32 s35, s35, s42
    buffer_load_dwordx4 v[110:113], v138, s[24:27], s35 offen sc1
    v_mfma_f32_32x32x16_bf16 v[82:97], v[160:163], v[118:121], v[82:97]
    s_waitcnt vmcnt(17)
    s_waitcnt lgkmcnt(2)
    v_mfma_f32_32x32x16_bf16 v[2:17], v[152:155], v[122:125], v[2:17]
    ds_read_b64_tr_b16 v[160:161], v140 offset:9344
    ds_read_b64_tr_b16 v[162:163], v140 offset:10880
    s_add_u32 m0, s66, 6144
    s_cmp_ge_u32 s47, 9
    s_cselect_b32 s34, 552960, 0
    s_sub_u32 s34, s43, s34
    s_add_u32 s34, s34, 368640
    buffer_load_dwordx4 v144, s[48:51], s34 offen offset:0 lds
    v_mfma_f32_32x32x16_bf16 v[50:65], v[152:155], v[126:129], v[50:65]
    buffer_load_dwordx4 v145, s[48:51], s34 offen offset:1024 lds
    s_barrier
    s_waitcnt lgkmcnt(2)
    v_mfma_f32_32x32x16_bf16 v[18:33], v[156:159], v[122:125], v[18:33]
    s_waitcnt vmcnt(9)
    ds_read_b64_tr_b16 v[152:153], v140 offset:0
    ds_read_b64_tr_b16 v[154:155], v140 offset:1536
    buffer_load_dwordx4 v146, s[48:51], s34 offen offset:2048 lds
    s_cmp_ge_u32 s47, 9
    s_cselect_b32 s35, 27648, 0
    s_sub_u32 s35, s41, s35
    s_add_u32 s35, s35, 18432
    buffer_load_dwordx4 v[114:117], v138, s[24:27], s35 offen sc1
    v_mfma_f32_32x32x16_bf16 v[66:81], v[156:159], v[126:129], v[66:81]
    s_add_u32 s35, s35, s42
    buffer_load_dwordx4 v[118:121], v138, s[24:27], s35 offen sc1
    s_waitcnt lgkmcnt(2)
    v_mfma_f32_32x32x16_bf16 v[34:49], v[160:163], v[122:125], v[34:49]
    ds_read_b64_tr_b16 v[156:157], v140 offset:64
    ds_read_b64_tr_b16 v[158:159], v140 offset:1600
    s_add_u32 m0, s45, 0
    s_add_u32 s34, s40, 122880
    s_mov_b64 exec, s[60:61]
    buffer_load_dwordx4 v138, s[24:27], s34 offen offset:0 sc1 lds
    s_mov_b64 exec, -1
    v_mfma_f32_32x32x16_bf16 v[82:97], v[160:163], v[126:129], v[82:97]
    s_mov_b64 exec, s[60:61]
    buffer_load_dwordx4 v138, s[24:27], s34 offen offset:640 sc1 lds
    s_mov_b64 exec, -1
    s_waitcnt vmcnt(12)
    s_waitcnt lgkmcnt(2)
    v_mfma_f32_32x32x16_bf16 v[2:17], v[152:155], v[98:101], v[2:17]
    ds_read_b64_tr_b16 v[160:161], v140 offset:128
    ds_read_b64_tr_b16 v[162:163], v140 offset:1664
    s_add_u32 m0, s46, 0
    s_add_u32 s34, s34, 5120
    s_mov_b64 exec, s[60:61]
    buffer_load_dwordx4 v138, s[24:27], s34 offen offset:0 sc1 lds
    s_sub_u32 s34, s34, 16
    buffer_load_dwordx4 v138, s[24:27], s34 offen offset:656 sc1 lds
    s_mov_b64 exec, -1
    v_mfma_f32_32x32x16_bf16 v[50:65], v[152:155], v[102:105], v[50:65]
    s_add_u32 m0, s66, 9216
    s_cmp_ge_u32 s47, 8
    s_cselect_b32 s34, 552960, 0
    s_sub_u32 s34, s43, s34
    s_add_u32 s34, s34, 389120
    buffer_load_dwordx4 v144, s[48:51], s34 offen offset:0 lds
    s_waitcnt lgkmcnt(2)
    v_mfma_f32_32x32x16_bf16 v[18:33], v[156:159], v[98:101], v[18:33]
    s_waitcnt vmcnt(12)
    ds_read_b64_tr_b16 v[152:153], v140 offset:3072
    ds_read_b64_tr_b16 v[154:155], v140 offset:4608
    buffer_load_dwordx4 v145, s[48:51], s34 offen offset:1024 lds
    v_mfma_f32_32x32x16_bf16 v[66:81], v[156:159], v[102:105], v[66:81]
    buffer_load_dwordx4 v146, s[48:51], s34 offen offset:2048 lds
    s_waitcnt lgkmcnt(2)
    v_mfma_f32_32x32x16_bf16 v[34:49], v[160:163], v[98:101], v[34:49]
    ds_read_b64_tr_b16 v[156:157], v140 offset:3136
    ds_read_b64_tr_b16 v[158:159], v140 offset:4672
    s_cmp_ge_u32 s47, 8
    s_cselect_b32 s35, 27648, 0
    s_sub_u32 s35, s41, s35
    s_add_u32 s35, s35, 19456
    buffer_load_dwordx4 v[122:125], v138, s[24:27], s35 offen sc1
    v_mfma_f32_32x32x16_bf16 v[82:97], v[160:163], v[102:105], v[82:97]
    s_add_u32 s35, s35, s42
    buffer_load_dwordx4 v[126:129], v138, s[24:27], s35 offen sc1
    s_waitcnt vmcnt(14)
    s_waitcnt lgkmcnt(2)
    v_mfma_f32_32x32x16_bf16 v[2:17], v[152:155], v[106:109], v[2:17]
    ds_read_b64_tr_b16 v[160:161], v140 offset:3200
    ds_read_b64_tr_b16 v[162:163], v140 offset:4736
    s_add_u32 m0, s66, 0
    s_cmp_ge_u32 s47, 7
    s_cselect_b32 s34, 552960, 0
    s_sub_u32 s34, s43, s34
    s_add_u32 s34, s34, 409600
    buffer_load_dwordx4 v144, s[48:51], s34 offen offset:0 lds
    v_mfma_f32_32x32x16_bf16 v[50:65], v[152:155], v[110:113], v[50:65]
    buffer_load_dwordx4 v145, s[48:51], s34 offen offset:1024 lds
    s_waitcnt lgkmcnt(2)
    v_mfma_f32_32x32x16_bf16 v[18:33], v[156:159], v[106:109], v[18:33]
    s_waitcnt vmcnt(13)
    ds_read_b64_tr_b16 v[152:153], v140 offset:6144
    ds_read_b64_tr_b16 v[154:155], v140 offset:7680
    buffer_load_dwordx4 v146, s[48:51], s34 offen offset:2048 lds
    v_mfma_f32_32x32x16_bf16 v[66:81], v[156:159], v[110:113], v[66:81]
    s_cmp_ge_u32 s47, 7
    s_cselect_b32 s35, 27648, 0
    s_sub_u32 s35, s41, s35
    s_add_u32 s35, s35, 20480
    buffer_load_dwordx4 v[98:101], v138, s[24:27], s35 offen sc1
    s_barrier
    s_waitcnt lgkmcnt(2)
    v_mfma_f32_32x32x16_bf16 v[34:49], v[160:163], v[106:109], v[34:49]
    ds_read_b64_tr_b16 v[156:157], v140 offset:6208
    ds_read_b64_tr_b16 v[158:159], v140 offset:7744
    s_add_u32 s35, s35, s42
    buffer_load_dwordx4 v[102:105], v138, s[24:27], s35 offen sc1
    v_mfma_f32_32x32x16_bf16 v[82:97], v[160:163], v[110:113], v[82:97]
    s_add_u32 m0, s45, 5120
    s_add_u32 s34, s40, 133120
    s_mov_b64 exec, s[60:61]
    buffer_load_dwordx4 v138, s[24:27], s34 offen offset:0 sc1 lds
    s_mov_b64 exec, -1
    s_waitcnt vmcnt(15)
    s_waitcnt lgkmcnt(2)
    v_mfma_f32_32x32x16_bf16 v[2:17], v[152:155], v[114:117], v[2:17]
    ds_read_b64_tr_b16 v[160:161], v140 offset:6272
    ds_read_b64_tr_b16 v[162:163], v140 offset:7808
    s_mov_b64 exec, s[60:61]
    buffer_load_dwordx4 v138, s[24:27], s34 offen offset:640 sc1 lds
    s_add_u32 m0, s46, 5248
    s_add_u32 s34, s34, 5120
    buffer_load_dwordx4 v138, s[24:27], s34 offen offset:0 sc1 lds
    s_mov_b64 exec, -1
    v_mfma_f32_32x32x16_bf16 v[50:65], v[152:155], v[118:121], v[50:65]
    s_sub_u32 s34, s34, 16
    s_mov_b64 exec, s[60:61]
    buffer_load_dwordx4 v138, s[24:27], s34 offen offset:656 sc1 lds
    s_add_u32 m0, s66, 3072
    s_cmp_ge_u32 s47, 6
    s_cselect_b32 s34, 552960, 0
    s_sub_u32 s34, s43, s34
    s_add_u32 s34, s34, 430080
    s_mov_b64 exec, -1
    buffer_load_dwordx4 v144, s[48:51], s34 offen offset:0 lds
    s_waitcnt lgkmcnt(2)
    v_mfma_f32_32x32x16_bf16 v[18:33], v[156:159], v[114:117], v[18:33]
    s_waitcnt vmcnt(12)
    ds_read_b64_tr_b16 v[152:153], v140 offset:9216
    ds_read_b64_tr_b16 v[154:155], v140 offset:10752
    buffer_load_dwordx4 v145, s[48:51], s34 offen offset:1024 lds
    v_mfma_f32_32x32x16_bf16 v[66:81], v[156:159], v[118:121], v[66:81]
    buffer_load_dwordx4 v146, s[48:51], s34 offen offset:2048 lds
    s_waitcnt lgkmcnt(2)
    v_mfma_f32_32x32x16_bf16 v[34:49], v[160:163], v[114:117], v[34:49]
    ds_read_b64_tr_b16 v[156:157], v140 offset:9280
    ds_read_b64_tr_b16 v[158:159], v140 offset:10816
    s_cmp_ge_u32 s47, 6
    s_cselect_b32 s35, 27648, 0
    s_sub_u32 s35, s41, s35
    s_add_u32 s35, s35, 21504
    buffer_load_dwordx4 v[106:109], v138, s[24:27], s35 offen sc1
    v_mfma_f32_32x32x16_bf16 v[82:97], v[160:163], v[118:121], v[82:97]
    s_add_u32 s35, s35, s42
    buffer_load_dwordx4 v[110:113], v138, s[24:27], s35 offen sc1
    s_waitcnt vmcnt(14)
    s_waitcnt lgkmcnt(2)
    v_mfma_f32_32x32x16_bf16 v[2:17], v[152:155], v[122:125], v[2:17]
    ds_read_b64_tr_b16 v[160:161], v140 offset:9344
    ds_read_b64_tr_b16 v[162:163], v140 offset:10880
    s_add_u32 m0, s66, 6144
    s_cmp_ge_u32 s47, 5
    s_cselect_b32 s34, 552960, 0
    s_sub_u32 s34, s43, s34
    s_add_u32 s34, s34, 450560
    buffer_load_dwordx4 v144, s[48:51], s34 offen offset:0 lds
    v_mfma_f32_32x32x16_bf16 v[50:65], v[152:155], v[126:129], v[50:65]
    buffer_load_dwordx4 v145, s[48:51], s34 offen offset:1024 lds
    s_waitcnt lgkmcnt(2)
    v_mfma_f32_32x32x16_bf16 v[18:33], v[156:159], v[122:125], v[18:33]
    s_waitcnt vmcnt(13)
    ds_read_b64_tr_b16 v[152:153], v140 offset:0
    ds_read_b64_tr_b16 v[154:155], v140 offset:1536
    buffer_load_dwordx4 v146, s[48:51], s34 offen offset:2048 lds
    v_mfma_f32_32x32x16_bf16 v[66:81], v[156:159], v[126:129], v[66:81]
    s_cmp_ge_u32 s47, 5
    s_cselect_b32 s35, 27648, 0
    s_sub_u32 s35, s41, s35
    s_add_u32 s35, s35, 22528
    buffer_load_dwordx4 v[114:117], v138, s[24:27], s35 offen sc1
    s_waitcnt lgkmcnt(2)
    v_mfma_f32_32x32x16_bf16 v[34:49], v[160:163], v[122:125], v[34:49]
    ds_read_b64_tr_b16 v[156:157], v140 offset:64
    ds_read_b64_tr_b16 v[158:159], v140 offset:1600
    s_add_u32 s35, s35, s42
    buffer_load_dwordx4 v[118:121], v138, s[24:27], s35 offen sc1
    v_mfma_f32_32x32x16_bf16 v[82:97], v[160:163], v[126:129], v[82:97]
    s_waitcnt vmcnt(14)
    s_waitcnt lgkmcnt(2)
    v_mfma_f32_32x32x16_bf16 v[2:17], v[152:155], v[98:101], v[2:17]
    ds_read_b64_tr_b16 v[160:161], v140 offset:128
    ds_read_b64_tr_b16 v[162:163], v140 offset:1664
    s_add_u32 m0, s66, 9216
    s_cmp_ge_u32 s47, 4
    s_cselect_b32 s34, 552960, 0
    s_sub_u32 s34, s43, s34
    s_add_u32 s34, s34, 471040
    buffer_load_dwordx4 v144, s[48:51], s34 offen offset:0 lds
    v_mfma_f32_32x32x16_bf16 v[50:65], v[152:155], v[102:105], v[50:65]
    buffer_load_dwordx4 v145, s[48:51], s34 offen offset:1024 lds
    s_barrier
    s_waitcnt lgkmcnt(2)
    v_mfma_f32_32x32x16_bf16 v[18:33], v[156:159], v[98:101], v[18:33]
    s_waitcnt vmcnt(9)
    ds_read_b64_tr_b16 v[152:153], v140 offset:3072
    ds_read_b64_tr_b16 v[154:155], v140 offset:4608
    buffer_load_dwordx4 v146, s[48:51], s34 offen offset:2048 lds
    s_cmp_ge_u32 s47, 4
    s_cselect_b32 s35, 27648, 0
    s_sub_u32 s35, s41, s35
    s_add_u32 s35, s35, 23552
    buffer_load_dwordx4 v[122:125], v138, s[24:27], s35 offen sc1
    v_mfma_f32_32x32x16_bf16 v[66:81], v[156:159], v[102:105], v[66:81]
    s_add_u32 s35, s35, s42
    buffer_load_dwordx4 v[126:129], v138, s[24:27], s35 offen sc1
    s_add_u32 m0, s45, 10240
    s_add_u32 s34, s40, 143360
    s_mov_b64 exec, s[60:61]
    buffer_load_dwordx4 v138, s[24:27], s34 offen offset:0 sc1 lds
    s_mov_b64 exec, -1
    s_waitcnt lgkmcnt(2)
    v_mfma_f32_32x32x16_bf16 v[34:49], v[160:163], v[98:101], v[34:49]
    ds_read_b64_tr_b16 v[156:157], v140 offset:3136
    ds_read_b64_tr_b16 v[158:159], v140 offset:4672
    s_mov_b64 exec, s[60:61]
    buffer_load_dwordx4 v138, s[24:27], s34 offen offset:640 sc1 lds
    s_add_u32 m0, s46, 10496
    s_add_u32 s34, s34, 5120
    buffer_load_dwordx4 v138, s[24:27], s34 offen offset:0 sc1 lds
    s_mov_b64 exec, -1
    v_mfma_f32_32x32x16_bf16 v[82:97], v[160:163], v[102:105], v[82:97]
    s_sub_u32 s34, s34, 16
    s_mov_b64 exec, s[60:61]
    buffer_load_dwordx4 v138, s[24:27], s34 offen offset:656 sc1 lds
    s_mov_b64 exec, -1
    s_waitcnt vmcnt(14)
    s_waitcnt lgkmcnt(2)
    v_mfma_f32_32x32x16_bf16 v[2:17], v[152:155], v[106:109], v[2:17]
    ds_read_b64_tr_b16 v[160:161], v140 offset:3200
    ds_read_b64_tr_b16 v[162:163], v140 offset:4736
    s_add_u32 m0, s66, 24576
    s_add_u32 s34, s68, 76800
    buffer_load_dwordx4 v144, s[52:55], s34 offen offset:0 lds
    buffer_load_dwordx4 v145, s[52:55], s34 offen offset:1024 lds
    v_mfma_f32_32x32x16_bf16 v[50:65], v[152:155], v[110:113], v[50:65]
    buffer_load_dwordx4 v146, s[52:55], s34 offen offset:2048 lds
    s_add_u32 m0, s66, 0
    s_cmp_ge_u32 s47, 3
    s_cselect_b32 s34, 552960, 0
    s_sub_u32 s34, s43, s34
    s_add_u32 s34, s34, 491520
    buffer_load_dwordx4 v144, s[48:51], s34 offen offset:0 lds
    s_waitcnt lgkmcnt(2)
    v_mfma_f32_32x32x16_bf16 v[18:33], v[156:159], v[106:109], v[18:33]
    s_waitcnt vmcnt(15)
    ds_read_b64_tr_b16 v[152:153], v140 offset:6144
    ds_read_b64_tr_b16 v[154:155], v140 offset:7680
    buffer_load_dwordx4 v145, s[48:51], s34 offen offset:1024 lds
    v_mfma_f32_32x32x16_bf16 v[66:81], v[156:159], v[110:113], v[66:81]
    buffer_load_dwordx4 v146, s[48:51], s34 offen offset:2048 lds
    s_waitcnt lgkmcnt(2)
    v_mfma_f32_32x32x16_bf16 v[34:49], v[160:163], v[106:109], v[34:49]
    ds_read_b64_tr_b16 v[156:157], v140 offset:6208
    ds_read_b64_tr_b16 v[158:159], v140 offset:7744
    s_cmp_ge_u32 s47, 3
    s_cselect_b32 s35, 27648, 0
    s_sub_u32 s35, s41, s35
    s_add_u32 s35, s35, 24576
    buffer_load_dwordx4 v[98:101], v138, s[24:27], s35 offen sc1
    v_mfma_f32_32x32x16_bf16 v[82:97], v[160:163], v[110:113], v[82:97]
    s_add_u32 s35, s35, s42
    buffer_load_dwordx4 v[102:105], v138, s[24:27], s35 offen sc1
    s_waitcnt vmcnt(17)
    s_waitcnt lgkmcnt(2)
    v_mfma_f32_32x32x16_bf16 v[2:17], v[152:155], v[114:117], v[2:17]
    ds_read_b64_tr_b16 v[160:161], v140 offset:6272
    ds_read_b64_tr_b16 v[162:163], v140 offset:7808
    s_add_u32 m0, s66, 3072
    s_cmp_ge_u32 s47, 2
    s_cselect_b32 s34, 552960, 0
    s_sub_u32 s34, s43, s34
    s_add_u32 s34, s34, 512000
    buffer_load_dwordx4 v144, s[48:51], s34 offen offset:0 lds
    v_mfma_f32_32x32x16_bf16 v[50:65], v[152:155], v[118:121], v[50:65]
    buffer_load_dwordx4 v145, s[48:51], s34 offen offset:1024 lds
    s_waitcnt lgkmcnt(2)
    v_mfma_f32_32x32x16_bf16 v[18:33], v[156:159], v[114:117], v[18:33]
    s_waitcnt vmcnt(16)
    ds_read_b64_tr_b16 v[152:153], v140 offset:9216
    ds_read_b64_tr_b16 v[154:155], v140 offset:10752
    buffer_load_dwordx4 v146, s[48:51], s34 offen offset:2048 lds
    v_mfma_f32_32x32x16_bf16 v[66:81], v[156:159], v[118:121], v[66:81]
    s_cmp_ge_u32 s47, 2
    s_cselect_b32 s35, 27648, 0
    s_sub_u32 s35, s41, s35
    s_add_u32 s35, s35, 25600
    buffer_load_dwordx4 v[106:109], v138, s[24:27], s35 offen sc1
    s_barrier
    s_waitcnt lgkmcnt(2)
    v_mfma_f32_32x32x16_bf16 v[34:49], v[160:163], v[114:117], v[34:49]
    ds_read_b64_tr_b16 v[156:157], v140 offset:9280
    ds_read_b64_tr_b16 v[158:159], v140 offset:10816
    s_add_u32 s35, s35, s42
    buffer_load_dwordx4 v[110:113], v138, s[24:27], s35 offen sc1
    v_mfma_f32_32x32x16_bf16 v[82:97], v[160:163], v[118:121], v[82:97]
    s_add_u32 m0, s45, 15360
    s_add_u32 s34, s40, 153600
    s_mov_b64 exec, s[60:61]
    buffer_load_dwordx4 v138, s[24:27], s34 offen offset:0 sc1 lds
    s_mov_b64 exec, -1
    s_waitcnt vmcnt(18)
    s_waitcnt lgkmcnt(2)
    v_mfma_f32_32x32x16_bf16 v[2:17], v[152:155], v[122:125], v[2:17]
    ds_read_b64_tr_b16 v[160:161], v140 offset:9344
    ds_read_b64_tr_b16 v[162:163], v140 offset:10880
    s_mov_b64 exec, s[60:61]
    buffer_load_dwordx4 v138, s[24:27], s34 offen offset:640 sc1 lds
    s_add_u32 m0, s46, 15744
    s_add_u32 s34, s34, 5120
    buffer_load_dwordx4 v138, s[24:27], s34 offen offset:0 sc1 lds
    s_mov_b64 exec, -1
    v_mfma_f32_32x32x16_bf16 v[50:65], v[152:155], v[126:129], v[50:65]
    s_sub_u32 s34, s34, 16
    s_mov_b64 exec, s[60:61]
    buffer_load_dwordx4 v138, s[24:27], s34 offen offset:656 sc1 lds
    s_add_u32 m0, s66, 6144
    s_cmp_ge_u32 s47, 1
    s_cselect_b32 s34, 552960, 0
    s_sub_u32 s34, s43, s34
    s_add_u32 s34, s34, 532480
    s_mov_b64 exec, -1
    buffer_load_dwordx4 v144, s[48:51], s34 offen offset:0 lds
    s_waitcnt lgkmcnt(2)
    v_mfma_f32_32x32x16_bf16 v[18:33], v[156:159], v[122:125], v[18:33]
    s_waitcnt vmcnt(12)
    ds_read_b64_tr_b16 v[152:153], v140 offset:0
    ds_read_b64_tr_b16 v[154:155], v140 offset:1536
    buffer_load_dwordx4 v145, s[48:51], s34 offen offset:1024 lds
    v_mfma_f32_32x32x16_bf16 v[66:81], v[156:159], v[126:129], v[66:81]
    buffer_load_dwordx4 v146, s[48:51], s34 offen offset:2048 lds
    s_waitcnt lgkmcnt(2)
    v_mfma_f32_32x32x16_bf16 v[34:49], v[160:163], v[122:125], v[34:49]
    ds_read_b64_tr_b16 v[156:157], v140 offset:64
    ds_read_b64_tr_b16 v[158:159], v140 offset:1600
    s_cmp_ge_u32 s47, 1
    s_cselect_b32 s35, 27648, 0
    s_sub_u32 s35, s41, s35
    s_add_u32 s35, s35, 26624
    buffer_load_dwordx4 v[114:117], v138, s[24:27], s35 offen sc1
    v_mfma_f32_32x32x16_bf16 v[82:97], v[160:163], v[126:129], v[82:97]
    s_add_u32 s35, s35, s42
    buffer_load_dwordx4 v[118:121], v138, s[24:27], s35 offen sc1
    s_waitcnt vmcnt(14)
    s_waitcnt lgkmcnt(2)
    v_mfma_f32_32x32x16_bf16 v[2:17], v[152:155], v[98:101], v[2:17]
    ds_read_b64_tr_b16 v[160:161], v140 offset:128
    ds_read_b64_tr_b16 v[162:163], v140 offset:1664
    v_mfma_f32_32x32x16_bf16 v[50:65], v[152:155], v[102:105], v[50:65]
    s_waitcnt lgkmcnt(2)
    v_mfma_f32_32x32x16_bf16 v[18:33], v[156:159], v[98:101], v[18:33]
    s_waitcnt vmcnt(11)
    ds_read_b64_tr_b16 v[152:153], v140 offset:3072
    ds_read_b64_tr_b16 v[154:155], v140 offset:4608
    v_mfma_f32_32x32x16_bf16 v[66:81], v[156:159], v[102:105], v[66:81]
    s_waitcnt lgkmcnt(2)
    v_mfma_f32_32x32x16_bf16 v[34:49], v[160:163], v[98:101], v[34:49]
    ds_read_b64_tr_b16 v[156:157], v140 offset:3136
    ds_read_b64_tr_b16 v[158:159], v140 offset:4672
    v_mfma_f32_32x32x16_bf16 v[82:97], v[160:163], v[102:105], v[82:97]
    s_waitcnt vmcnt(9)
    s_waitcnt lgkmcnt(2)
    v_mfma_f32_32x32x16_bf16 v[2:17], v[152:155], v[106:109], v[2:17]
    ds_read_b64_tr_b16 v[160:161], v140 offset:3200
    ds_read_b64_tr_b16 v[162:163], v140 offset:4736
    v_mfma_f32_32x32x16_bf16 v[50:65], v[152:155], v[110:113], v[50:65]
    s_barrier
    s_waitcnt lgkmcnt(2)
    v_mfma_f32_32x32x16_bf16 v[18:33], v[156:159], v[106:109], v[18:33]
    s_waitcnt vmcnt(2)
    ds_read_b64_tr_b16 v[152:153], v140 offset:6144
    ds_read_b64_tr_b16 v[154:155], v140 offset:7680
    v_mfma_f32_32x32x16_bf16 v[66:81], v[156:159], v[110:113], v[66:81]
    s_waitcnt lgkmcnt(2)
    v_mfma_f32_32x32x16_bf16 v[34:49], v[160:163], v[106:109], v[34:49]
    ds_read_b64_tr_b16 v[156:157], v140 offset:6208
    ds_read_b64_tr_b16 v[158:159], v140 offset:7744
    v_mfma_f32_32x32x16_bf16 v[82:97], v[160:163], v[110:113], v[82:97]
    s_waitcnt vmcnt(0)
    s_waitcnt lgkmcnt(2)
    v_mfma_f32_32x32x16_bf16 v[2:17], v[152:155], v[114:117], v[2:17]
    ds_read_b64_tr_b16 v[160:161], v140 offset:6272
    ds_read_b64_tr_b16 v[162:163], v140 offset:7808
    v_mfma_f32_32x32x16_bf16 v[50:65], v[152:155], v[118:121], v[50:65]
    s_waitcnt lgkmcnt(2)
    v_mfma_f32_32x32x16_bf16 v[18:33], v[156:159], v[114:117], v[18:33]
    v_mfma_f32_32x32x16_bf16 v[66:81], v[156:159], v[118:121], v[66:81]
    s_waitcnt lgkmcnt(0)
    v_mfma_f32_32x32x16_bf16 v[34:49], v[160:163], v[114:117], v[34:49]
    v_mfma_f32_32x32x16_bf16 v[82:97], v[160:163], v[118:121], v[82:97]
    s_nop 7
    s_nop 3
    ds_write_b128 v132, v[50:53] offset:0
    ds_write_b128 v132, v[54:57] offset:1024
    ds_write_b128 v132, v[58:61] offset:2048
    ds_write_b128 v132, v[62:65] offset:3072
    ds_write_b128 v132, v[66:69] offset:4096
    ds_write_b128 v132, v[70:73] offset:5120
    ds_write_b128 v132, v[74:77] offset:6144
    ds_write_b128 v132, v[78:81] offset:7168
    ds_write_b128 v132, v[82:85] offset:8192
    ds_write_b128 v132, v[86:89] offset:9216
    ds_write_b128 v132, v[90:93] offset:10240
    ds_write_b128 v132, v[94:97] offset:11264
    s_waitcnt lgkmcnt(0)
    s_barrier
    ds_read_b128 v[50:53], v133 offset:0
    ds_read_b128 v[54:57], v133 offset:1024
    ds_read_b128 v[58:61], v133 offset:2048
    ds_read_b128 v[62:65], v133 offset:3072
    ds_read_b128 v[66:69], v133 offset:4096
    ds_read_b128 v[70:73], v133 offset:5120
    ds_read_b128 v[74:77], v133 offset:6144
    ds_read_b128 v[78:81], v133 offset:7168
    ds_read_b128 v[82:85], v133 offset:8192
    ds_read_b128 v[86:89], v133 offset:9216
    ds_read_b128 v[90:93], v133 offset:10240
    ds_read_b128 v[94:97], v133 offset:11264
    buffer_load_dwordx4 v[98:101], v143, s[56:59], 0 offen offset:0
    buffer_load_dwordx4 v[102:105], v143, s[56:59], 0 offen offset:32
    buffer_load_dwordx4 v[106:109], v143, s[56:59], 0 offen offset:64
    buffer_load_dwordx4 v[110:113], v143, s[56:59], 0 offen offset:96
    buffer_load_dwordx4 v[114:117], v143, s[56:59], 0 offen offset:128
    buffer_load_dwordx4 v[118:121], v143, s[56:59], 0 offen offset:160
    s_add_u32 m0, s66, 27648
    s_add_u32 s34, s68, 0
    buffer_load_dwordx4 v148, s[52:55], s34 offen offset:0 lds
    buffer_load_dwordx4 v149, s[52:55], s34 offen offset:1024 lds
    buffer_load_dwordx4 v150, s[52:55], s34 offen offset:2048 lds
    s_waitcnt lgkmcnt(0)
    s_barrier
    s_add_u32 m0, s66, 0
    s_add_u32 s34, s44, 0
    buffer_load_dwordx4 v144, s[52:55], s34 offen offset:0 lds
    buffer_load_dwordx4 v145, s[52:55], s34 offen offset:1024 lds
    buffer_load_dwordx4 v146, s[52:55], s34 offen offset:2048 lds
    s_add_u32 m0, s66, 3072
    s_add_u32 s34, s44, 25600
    buffer_load_dwordx4 v144, s[52:55], s34 offen offset:0 lds
    buffer_load_dwordx4 v145, s[52:55], s34 offen offset:1024 lds
    buffer_load_dwordx4 v146, s[52:55], s34 offen offset:2048 lds
    s_add_u32 m0, s66, 6144
    s_add_u32 s34, s44, 51200
    buffer_load_dwordx4 v144, s[52:55], s34 offen offset:0 lds
    buffer_load_dwordx4 v145, s[52:55], s34 offen offset:1024 lds
    buffer_load_dwordx4 v146, s[52:55], s34 offen offset:2048 lds
    s_add_u32 m0, s66, 9216
    s_add_u32 s34, s44, 76800
    buffer_load_dwordx4 v144, s[52:55], s34 offen offset:0 lds
    buffer_load_dwordx4 v145, s[52:55], s34 offen offset:1024 lds
    buffer_load_dwordx4 v146, s[52:55], s34 offen offset:2048 lds
    s_mov_b32 s48, s20
    s_mov_b32 s49, s21
    s_mov_b32 s50, 2621440
    s_mov_b32 s51, 0x00020000
    s_mul_i32 s41, s64, 40960
    s_add_u32 s41, s41, 14942208
    s_lshl_b32 s34, s63, 12
    s_add_u32 s42, s41, s34
    s_add_u32 s42, s42, 32768
    s_lshl_b32 s34, s63, 14
    s_add_u32 s41, s41, s34
    s_lshl_b32 s37, s64, 12
    s_lshl_b32 s34, s63, 9
    s_add_u32 s37, s37, s34
    s_add_u32 s37, s37, 17825792
    s_mov_b32 s36, 1048576
    s_xor_b32 s34, s69, 0
    s_lshl_b32 s34, s34, 10
    s_add_u32 s56, s42, s34
    s_lshl2_add_u32 s52, s34, s41
    s_xor_b32 s34, s69, 1
    s_lshl_b32 s34, s34, 10
    s_add_u32 s57, s42, s34
    s_lshl2_add_u32 s53, s34, s41
    s_xor_b32 s34, s69, 2
    s_lshl_b32 s34, s34, 10
    s_add_u32 s58, s42, s34
    s_lshl2_add_u32 s54, s34, s41
    s_xor_b32 s34, s69, 3
    s_lshl_b32 s34, s34, 10
    s_add_u32 s59, s42, s34
    s_lshl2_add_u32 s55, s34, s41
    s_add_u32 s67, s65, 40960
    s_mul_i32 s43, s62, 30720
    s_mul_i32 s44, s38, 10240
    s_add_u32 s44, s44, 122880
    s_xor_b32 s45, s38, 2
    s_mul_i32 s45, s45, 10240
    s_add_u32 s45, s45, 122880
    s_lshl_b32 s34, s3, 10
    s_lshl4_add_u32 s34, s62, s34
    s_add_u32 s34, s34, 17563648
L_rs3:
    s_waitcnt vmcnt(0)
    v_cmp_ne_u32 vcc, s33, v165
    s_cbranch_vccz L_rsx3
    s_sub_u32 s36, s36, 1
    s_cbranch_scc1 L_rsx3
    buffer_load_dwordx2 v[164:165], v167, s[24:27], s34 offen offset:8 sc1
    s_branch L_rs3
L_rsx3:
    s_mov_b32 s36, 1048576
    s_barrier
    v_bfe_u32 v1, v0, 2, 2
    v_lshlrev_b32 v1, 7, v1
    v_and_b32 v130, 3, v0
    v_lshl_add_u32 v1, v130, 2, v1
    buffer_load_dword v130, v1, s[24:27], s37 offen sc1
    v_subrev_u32 v140, s43, v140
    v_subrev_u32 v141, s43, v141
    v_add_u32 v132, s44, v138
    v_add_u32 v133, s45, v138
    v_mul_f32 v164, v164, v164
    v_pk_add_f32 v[2:3], v[2:3], v[50:51]
    v_lshlrev_b32 v165, 16, v98
    v_and_b32 v166, 0xffff0000, v98
    v_fma_f32 v2, v2, v164, v165
    v_fma_f32 v3, v3, v164, v166
    v_pk_add_f32 v[4:5], v[4:5], v[52:53]
    v_lshlrev_b32 v165, 16, v99
    v_and_b32 v166, 0xffff0000, v99
    v_fma_f32 v4, v4, v164, v165
    v_fma_f32 v5, v5, v164, v166
    v_pk_add_f32 v[6:7], v[6:7], v[54:55]
    v_lshlrev_b32 v165, 16, v100
    v_and_b32 v166, 0xffff0000, v100
    v_fma_f32 v6, v6, v164, v165
    v_fma_f32 v7, v7, v164, v166
    v_pk_add_f32 v[8:9], v[8:9], v[56:57]
    v_lshlrev_b32 v165, 16, v101
    v_and_b32 v166, 0xffff0000, v101
    v_fma_f32 v8, v8, v164, v165
    v_fma_f32 v9, v9, v164, v166
    v_pk_add_f32 v[10:11], v[10:11], v[58:59]
    v_lshlrev_b32 v165, 16, v102
    v_and_b32 v166, 0xffff0000, v102
    v_fma_f32 v10, v10, v164, v165
    v_fma_f32 v11, v11, v164, v166
    v_pk_add_f32 v[12:13], v[12:13], v[60:61]
    v_lshlrev_b32 v165, 16, v103
    v_and_b32 v166, 0xffff0000, v103
    v_fma_f32 v12, v12, v164, v165
    v_fma_f32 v13, v13, v164, v166
    v_pk_add_f32 v[14:15], v[14:15], v[62:63]
    v_lshlrev_b32 v165, 16, v104
    v_and_b32 v166, 0xffff0000, v104
    v_fma_f32 v14, v14, v164, v165
    v_fma_f32 v15, v15, v164, v166
    v_pk_add_f32 v[16:17], v[16:17], v[64:65]
    v_lshlrev_b32 v165, 16, v105
    v_and_b32 v166, 0xffff0000, v105
    v_fma_f32 v16, v16, v164, v165
    v_fma_f32 v17, v17, v164, v166
    v_pk_add_f32 v[18:19], v[18:19], v[66:67]
    v_lshlrev_b32 v165, 16, v106
    v_and_b32 v166, 0xffff0000, v106
    v_fma_f32 v18, v18, v164, v165
    v_fma_f32 v19, v19, v164, v166
    v_pk_add_f32 v[20:21], v[20:21], v[68:69]
    v_lshlrev_b32 v165, 16, v107
    v_and_b32 v166, 0xffff0000, v107
    v_fma_f32 v20, v20, v164, v165
    v_fma_f32 v21, v21, v164, v166
    v_pk_add_f32 v[22:23], v[22:23], v[70:71]
    v_lshlrev_b32 v165, 16, v108
    v_and_b32 v166, 0xffff0000, v108
    v_fma_f32 v22, v22, v164, v165
    v_fma_f32 v23, v23, v164, v166
    v_pk_add_f32 v[24:25], v[24:25], v[72:73]
    v_lshlrev_b32 v165, 16, v109
    v_and_b32 v166, 0xffff0000, v109
    v_fma_f32 v24, v24, v164, v165
    v_fma_f32 v25, v25, v164, v166
    v_pk_add_f32 v[26:27], v[26:27], v[74:75]
    v_lshlrev_b32 v165, 16, v110
    v_and_b32 v166, 0xffff0000, v110
    v_fma_f32 v26, v26, v164, v165
    v_fma_f32 v27, v27, v164, v166
    v_pk_add_f32 v[28:29], v[28:29], v[76:77]
    v_lshlrev_b32 v165, 16, v111
    v_and_b32 v166, 0xffff0000, v111
    v_fma_f32 v28, v28, v164, v165
    v_fma_f32 v29, v29, v164, v166
    v_pk_add_f32 v[30:31], v[30:31], v[78:79]
    v_lshlrev_b32 v165, 16, v112
    v_and_b32 v166, 0xffff0000, v112
    v_fma_f32 v30, v30, v164, v165
    v_fma_f32 v31, v31, v164, v166
    v_pk_add_f32 v[32:33], v[32:33], v[80:81]
    v_lshlrev_b32 v165, 16, v113
    v_and_b32 v166, 0xffff0000, v113
    v_fma_f32 v32, v32, v164, v165
    v_fma_f32 v33, v33, v164, v166
    v_pk_add_f32 v[34:35], v[34:35], v[82:83]
    v_lshlrev_b32 v165, 16, v114
    v_and_b32 v166, 0xffff0000, v114
    v_fma_f32 v34, v34, v164, v165
    v_fma_f32 v35, v35, v164, v166
    v_pk_add_f32 v[36:37], v[36:37], v[84:85]
    v_lshlrev_b32 v165, 16, v115
    v_and_b32 v166, 0xffff0000, v115
    v_fma_f32 v36, v36, v164, v165
    v_fma_f32 v37, v37, v164, v166
    v_pk_add_f32 v[38:39], v[38:39], v[86:87]
    v_lshlrev_b32 v165, 16, v116
    v_and_b32 v166, 0xffff0000, v116
    v_fma_f32 v38, v38, v164, v165
    v_fma_f32 v39, v39, v164, v166
    v_pk_add_f32 v[40:41], v[40:41], v[88:89]
    v_lshlrev_b32 v165, 16, v117
    v_and_b32 v166, 0xffff0000, v117
    v_fma_f32 v40, v40, v164, v165
    v_fma_f32 v41, v41, v164, v166
    v_pk_add_f32 v[42:43], v[42:43], v[90:91]
    v_lshlrev_b32 v165, 16, v118
    v_and_b32 v166, 0xffff0000, v118
    v_fma_f32 v42, v42, v164, v165
    v_fma_f32 v43, v43, v164, v166
    v_pk_add_f32 v[44:45], v[44:45], v[92:93]
    v_lshlrev_b32 v165, 16, v119
    v_and_b32 v166, 0xffff0000, v119
    v_fma_f32 v44, v44, v164, v165
    v_fma_f32 v45, v45, v164, v166
    v_pk_add_f32 v[46:47], v[46:47], v[94:95]
    v_lshlrev_b32 v165, 16, v120
    v_and_b32 v166, 0xffff0000, v120
    v_fma_f32 v46, v46, v164, v165
    v_fma_f32 v47, v47, v164, v166
    v_pk_add_f32 v[48:49], v[48:49], v[96:97]
    v_lshlrev_b32 v165, 16, v121
    v_and_b32 v166, 0xffff0000, v121
    v_fma_f32 v48, v48, v164, v165
    v_fma_f32 v49, v49, v164, v166
    s_cmp_eq_u32 s63, 0
    s_cbranch_scc0 L_hi3
L_lo3:
    ds_read_b64_tr_b16 v[152:153], v140 offset:128
    ds_read_b64_tr_b16 v[154:155], v140 offset:1664
    ds_read_b64_tr_b16 v[156:157], v140 offset:0
    ds_read_b64_tr_b16 v[158:159], v140 offset:1536
    ds_read_b64_tr_b16 v[160:161], v140 offset:64
    ds_read_b64_tr_b16 v[162:163], v140 offset:1600
L_palo3:
    s_waitcnt vmcnt(0)
    v_cmp_ne_u32 vcc, s33, v130
    s_nop 1
    s_and_b32 s34, vcc_lo, 0xffff
    s_cbranch_scc0 L_galo3
    s_sub_u32 s36, s36, 1
    s_cbranch_scc1 L_galo3
    buffer_load_dword v130, v1, s[24:27], s37 offen sc1
    s_branch L_palo3
L_galo3:
    buffer_load_dwordx4 v[50:53], v138, s[24:27], s52 offen offset:0 sc1
    buffer_load_dwordx4 v[54:57], v138, s[24:27], s52 offen offset:1024 sc1
    buffer_load_dwordx4 v[58:61], v138, s[24:27], s52 offen offset:2048 sc1
    buffer_load_dwordx4 v[62:65], v138, s[24:27], s52 offen offset:3072 sc1
    buffer_load_dwordx2 v[66:67], v139, s[24:27], s56 offen sc1
    buffer_load_dwordx2 v[68:69], v139, s[24:27], s56 offen offset:512 sc1
    buffer_load_dwordx4 v[70:73], v138, s[24:27], s53 offen offset:0 sc1
    buffer_load_dwordx4 v[74:77], v138, s[24:27], s53 offen offset:1024 sc1
    buffer_load_dwordx4 v[78:81], v138, s[24:27], s53 offen offset:2048 sc1
    s_waitcnt vmcnt(8)
    s_waitcnt lgkmcnt(4)
    v_mfma_f32_32x32x16_bf16 v[34:49], v[152:155], v[50:53], v[34:49]
    ds_read_b64_tr_b16 v[152:153], v140 offset:3200
    ds_read_b64_tr_b16 v[154:155], v140 offset:4736
    buffer_load_dwordx4 v[82:85], v138, s[24:27], s53 offen offset:3072 sc1
    s_waitcnt lgkmcnt(4)
    v_mfma_f32_32x32x16_bf16 v[2:17], v[156:159], v[50:53], v[2:17]
    ds_read_b64_tr_b16 v[156:157], v140 offset:3072
    ds_read_b64_tr_b16 v[158:159], v140 offset:4608
    buffer_load_dwordx2 v[86:87], v139, s[24:27], s57 offen sc1
    buffer_load_dwordx2 v[88:89], v139, s[24:27], s57 offen offset:512 sc1
    s_waitcnt lgkmcnt(4)
    v_mfma_f32_32x32x16_bf16 v[18:33], v[160:163], v[50:53], v[18:33]
    ds_read_b64_tr_b16 v[160:161], v140 offset:3136
    ds_read_b64_tr_b16 v[162:163], v140 offset:4672
    s_waitcnt vmcnt(10)
    s_waitcnt lgkmcnt(4)
    v_mfma_f32_32x32x16_bf16 v[34:49], v[152:155], v[54:57], v[34:49]
    ds_read_b64_tr_b16 v[152:153], v140 offset:6272
    ds_read_b64_tr_b16 v[154:155], v140 offset:7808
    buffer_load_dwordx4 v[90:93], v138, s[24:27], s54 offen offset:0 sc1
    s_waitcnt lgkmcnt(4)
    v_mfma_f32_32x32x16_bf16 v[2:17], v[156:159], v[54:57], v[2:17]
    ds_read_b64_tr_b16 v[156:157], v140 offset:6144
    ds_read_b64_tr_b16 v[158:159], v140 offset:7680
    buffer_load_dwordx4 v[94:97], v138, s[24:27], s54 offen offset:1024 sc1
    s_waitcnt lgkmcnt(4)
    v_mfma_f32_32x32x16_bf16 v[18:33], v[160:163], v[54:57], v[18:33]
    ds_read_b64_tr_b16 v[160:161], v140 offset:6208
    ds_read_b64_tr_b16 v[162:163], v140 offset:7744
    s_waitcnt vmcnt(11)
    s_waitcnt lgkmcnt(4)
    v_mfma_f32_32x32x16_bf16 v[34:49], v[152:155], v[58:61], v[34:49]
    ds_read_b64_tr_b16 v[152:153], v140 offset:9344
    ds_read_b64_tr_b16 v[154:155], v140 offset:10880
    buffer_load_dwordx4 v[98:101], v138, s[24:27], s54 offen offset:2048 sc1
    s_waitcnt lgkmcnt(4)
    v_mfma_f32_32x32x16_bf16 v[2:17], v[156:159], v[58:61], v[2:17]
    ds_read_b64_tr_b16 v[156:157], v140 offset:9216
    ds_read_b64_tr_b16 v[158:159], v140 offset:10752
    buffer_load_dwordx4 v[102:105], v138, s[24:27], s54 offen offset:3072 sc1
    s_waitcnt lgkmcnt(4)
    v_mfma_f32_32x32x16_bf16 v[18:33], v[160:163], v[58:61], v[18:33]
    ds_read_b64_tr_b16 v[160:161], v140 offset:9280
    ds_read_b64_tr_b16 v[162:163], v140 offset:10816
    s_waitcnt vmcnt(12)
    s_waitcnt lgkmcnt(4)
    v_mfma_f32_32x32x16_bf16 v[34:49], v[152:155], v[62:65], v[34:49]
    ds_read_b64_tr_b16 v[152:153], v140 offset:12416
    ds_read_b64_tr_b16 v[154:155], v140 offset:13952
    buffer_load_dwordx2 v[106:107], v139, s[24:27], s58 offen sc1
    buffer_load_dwordx2 v[108:109], v139, s[24:27], s58 offen offset:512 sc1
    s_waitcnt lgkmcnt(4)
    v_mfma_f32_32x32x16_bf16 v[2:17], v[156:159], v[62:65], v[2:17]
    ds_read_b64_tr_b16 v[156:157], v140 offset:12288
    ds_read_b64_tr_b16 v[158:159], v140 offset:13824
    buffer_load_dwordx4 v[110:113], v138, s[24:27], s55 offen offset:0 sc1
    s_waitcnt lgkmcnt(4)
    v_mfma_f32_32x32x16_bf16 v[18:33], v[160:163], v[62:65], v[18:33]
    ds_read_b64_tr_b16 v[160:161], v140 offset:12352
    ds_read_b64_tr_b16 v[162:163], v140 offset:13888
    s_waitcnt vmcnt(13)
    s_waitcnt lgkmcnt(4)
    v_mfma_f32_32x32x16_bf16 v[34:49], v[152:155], v[66:69], v[34:49]
    ds_read_b64_tr_b16 v[152:153], v140 offset:15488
    ds_read_b64_tr_b16 v[154:155], v140 offset:17024
    buffer_load_dwordx4 v[114:117], v138, s[24:27], s55 offen offset:1024 sc1
    s_waitcnt lgkmcnt(4)
    v_mfma_f32_32x32x16_bf16 v[2:17], v[156:159], v[66:69], v[2:17]
    ds_read_b64_tr_b16 v[156:157], v140 offset:15360
    ds_read_b64_tr_b16 v[158:159], v140 offset:16896
    buffer_load_dwordx4 v[118:121], v138, s[24:27], s55 offen offset:2048 sc1
    s_waitcnt lgkmcnt(4)
    v_mfma_f32_32x32x16_bf16 v[18:33], v[160:163], v[66:69], v[18:33]
    ds_read_b64_tr_b16 v[160:161], v140 offset:15424
    ds_read_b64_tr_b16 v[162:163], v140 offset:16960
    s_waitcnt vmcnt(14)
    s_waitcnt lgkmcnt(4)
    v_mfma_f32_32x32x16_bf16 v[34:49], v[152:155], v[70:73], v[34:49]
    ds_read_b64_tr_b16 v[152:153], v140 offset:18560
    ds_read_b64_tr_b16 v[154:155], v140 offset:20096
    buffer_load_dwordx4 v[122:125], v138, s[24:27], s55 offen offset:3072 sc1
    s_waitcnt lgkmcnt(4)
    v_mfma_f32_32x32x16_bf16 v[2:17], v[156:159], v[70:73], v[2:17]
    ds_read_b64_tr_b16 v[156:157], v140 offset:18432
    ds_read_b64_tr_b16 v[158:159], v140 offset:19968
    buffer_load_dwordx2 v[126:127], v139, s[24:27], s59 offen sc1
    buffer_load_dwordx2 v[128:129], v139, s[24:27], s59 offen offset:512 sc1
    s_waitcnt lgkmcnt(4)
    v_mfma_f32_32x32x16_bf16 v[18:33], v[160:163], v[70:73], v[18:33]
    ds_read_b64_tr_b16 v[160:161], v140 offset:18496
    ds_read_b64_tr_b16 v[162:163], v140 offset:20032
    s_waitcnt vmcnt(16)
    s_waitcnt lgkmcnt(4)
    v_mfma_f32_32x32x16_bf16 v[34:49], v[152:155], v[74:77], v[34:49]
    ds_read_b64_tr_b16 v[152:153], v140 offset:21632
    ds_read_b64_tr_b16 v[154:155], v140 offset:23168
    s_waitcnt lgkmcnt(4)
    v_mfma_f32_32x32x16_bf16 v[2:17], v[156:159], v[74:77], v[2:17]
    ds_read_b64_tr_b16 v[156:157], v140 offset:21504
    ds_read_b64_tr_b16 v[158:159], v140 offset:23040
    s_waitcnt lgkmcnt(4)
    v_mfma_f32_32x32x16_bf16 v[18:33], v[160:163], v[74:77], v[18:33]
    ds_read_b64_tr_b16 v[160:161], v140 offset:21568
    ds_read_b64_tr_b16 v[162:163], v140 offset:23104
    s_waitcnt vmcnt(15)
    s_waitcnt lgkmcnt(4)
    v_mfma_f32_32x32x16_bf16 v[34:49], v[152:155], v[78:81], v[34:49]
    ds_read_b64_tr_b16 v[152:153], v140 offset:24704
    ds_read_b64_tr_b16 v[154:155], v140 offset:26240
    s_waitcnt lgkmcnt(4)
    v_mfma_f32_32x32x16_bf16 v[2:17], v[156:159], v[78:81], v[2:17]
    ds_read_b64_tr_b16 v[156:157], v140 offset:24576
    ds_read_b64_tr_b16 v[158:159], v140 offset:26112
    s_waitcnt lgkmcnt(4)
    v_mfma_f32_32x32x16_bf16 v[18:33], v[160:163], v[78:81], v[18:33]
    ds_read_b64_tr_b16 v[160:161], v140 offset:24640
    ds_read_b64_tr_b16 v[162:163], v140 offset:26176
    s_waitcnt vmcnt(14)
    s_waitcnt lgkmcnt(4)
    v_mfma_f32_32x32x16_bf16 v[34:49], v[152:155], v[82:85], v[34:49]
    ds_read_b64_tr_b16 v[152:153], v140 offset:27776
    ds_read_b64_tr_b16 v[154:155], v140 offset:29312
    s_waitcnt lgkmcnt(4)
    v_mfma_f32_32x32x16_bf16 v[2:17], v[156:159], v[82:85], v[2:17]
    ds_read_b64_tr_b16 v[156:157], v140 offset:27648
    ds_read_b64_tr_b16 v[158:159], v140 offset:29184
    s_waitcnt lgkmcnt(4)
    v_mfma_f32_32x32x16_bf16 v[18:33], v[160:163], v[82:85], v[18:33]
    ds_read_b64_tr_b16 v[160:161], v140 offset:27712
    ds_read_b64_tr_b16 v[162:163], v140 offset:29248
    s_waitcnt vmcnt(12)
    s_waitcnt lgkmcnt(4)
    v_mfma_f32_32x32x16_bf16 v[34:49], v[152:155], v[86:89], v[34:49]
    ds_read_b64_tr_b16 v[152:153], v140 offset:30848
    ds_read_b64_tr_b16 v[154:155], v140 offset:32384
    s_waitcnt lgkmcnt(4)
    v_mfma_f32_32x32x16_bf16 v[2:17], v[156:159], v[86:89], v[2:17]
    ds_read_b64_tr_b16 v[156:157], v140 offset:30720
    ds_read_b64_tr_b16 v[158:159], v140 offset:32256
    s_waitcnt lgkmcnt(4)
    v_mfma_f32_32x32x16_bf16 v[18:33], v[160:163], v[86:89], v[18:33]
    ds_read_b64_tr_b16 v[160:161], v140 offset:30784
    ds_read_b64_tr_b16 v[162:163], v140 offset:32320
    s_waitcnt vmcnt(11)
    s_waitcnt lgkmcnt(4)
    v_mfma_f32_32x32x16_bf16 v[34:49], v[152:155], v[90:93], v[34:49]
    ds_read_b64_tr_b16 v[152:153], v140 offset:33920
    ds_read_b64_tr_b16 v[154:155], v140 offset:35456
    s_waitcnt lgkmcnt(4)
    v_mfma_f32_32x32x16_bf16 v[2:17], v[156:159], v[90:93], v[2:17]
    ds_read_b64_tr_b16 v[156:157], v140 offset:33792
    ds_read_b64_tr_b16 v[158:159], v140 offset:35328
    s_waitcnt lgkmcnt(4)
    v_mfma_f32_32x32x16_bf16 v[18:33], v[160:163], v[90:93], v[18:33]
    ds_read_b64_tr_b16 v[160:161], v140 offset:33856
    ds_read_b64_tr_b16 v[162:163], v140 offset:35392
    s_waitcnt vmcnt(10)
    s_waitcnt lgkmcnt(4)
    v_mfma_f32_32x32x16_bf16 v[34:49], v[152:155], v[94:97], v[34:49]
    ds_read_b64_tr_b16 v[152:153], v140 offset:36992
    ds_read_b64_tr_b16 v[154:155], v140 offset:38528
    s_waitcnt lgkmcnt(4)
    v_mfma_f32_32x32x16_bf16 v[2:17], v[156:159], v[94:97], v[2:17]
    ds_read_b64_tr_b16 v[156:157], v140 offset:36864
    ds_read_b64_tr_b16 v[158:159], v140 offset:38400
    s_waitcnt lgkmcnt(4)
    v_mfma_f32_32x32x16_bf16 v[18:33], v[160:163], v[94:97], v[18:33]
    ds_read_b64_tr_b16 v[160:161], v140 offset:36928
    ds_read_b64_tr_b16 v[162:163], v140 offset:38464
    s_waitcnt vmcnt(9)
    s_waitcnt lgkmcnt(4)
    v_mfma_f32_32x32x16_bf16 v[34:49], v[152:155], v[98:101], v[34:49]
    ds_read_b64_tr_b16 v[152:153], v140 offset:40064
    ds_read_b64_tr_b16 v[154:155], v140 offset:41600
    s_waitcnt lgkmcnt(4)
    v_mfma_f32_32x32x16_bf16 v[2:17], v[156:159], v[98:101], v[2:17]
    ds_read_b64_tr_b16 v[156:157], v140 offset:39936
    ds_read_b64_tr_b16 v[158:159], v140 offset:41472
    s_waitcnt lgkmcnt(4)
    v_mfma_f32_32x32x16_bf16 v[18:33], v[160:163], v[98:101], v[18:33]
    ds_read_b64_tr_b16 v[160:161], v140 offset:40000
    ds_read_b64_tr_b16 v[162:163], v140 offset:41536
    s_waitcnt vmcnt(8)
    s_waitcnt lgkmcnt(4)
    v_mfma_f32_32x32x16_bf16 v[34:49], v[152:155], v[102:105], v[34:49]
    ds_read_b64_tr_b16 v[152:153], v140 offset:43136
    ds_read_b64_tr_b16 v[154:155], v140 offset:44672
    s_waitcnt lgkmcnt(4)
    v_mfma_f32_32x32x16_bf16 v[2:17], v[156:159], v[102:105], v[2:17]
    ds_read_b64_tr_b16 v[156:157], v140 offset:43008
    ds_read_b64_tr_b16 v[158:159], v140 offset:44544
    s_waitcnt lgkmcnt(4)
    v_mfma_f32_32x32x16_bf16 v[18:33], v[160:163], v[102:105], v[18:33]
    ds_read_b64_tr_b16 v[160:161], v140 offset:43072
    ds_read_b64_tr_b16 v[162:163], v140 offset:44608
    s_waitcnt vmcnt(6)
    s_waitcnt lgkmcnt(4)
    v_mfma_f32_32x32x16_bf16 v[34:49], v[152:155], v[106:109], v[34:49]
    ds_read_b64_tr_b16 v[152:153], v140 offset:46208
    ds_read_b64_tr_b16 v[154:155], v140 offset:47744
    s_waitcnt lgkmcnt(4)
    v_mfma_f32_32x32x16_bf16 v[2:17], v[156:159], v[106:109], v[2:17]
    ds_read_b64_tr_b16 v[156:157], v140 offset:49280
    ds_read_b64_tr_b16 v[158:159], v140 offset:50816
    s_waitcnt lgkmcnt(4)
    v_mfma_f32_32x32x16_bf16 v[18:33], v[160:163], v[106:109], v[18:33]
    ds_read_b64_tr_b16 v[160:161], v140 offset:52352
    ds_read_b64_tr_b16 v[162:163], v140 offset:53888
    s_waitcnt vmcnt(5)
    s_waitcnt lgkmcnt(4)
    v_mfma_f32_32x32x16_bf16 v[34:49], v[152:155], v[110:113], v[34:49]
    ds_read_b64_tr_b16 v[152:153], v140 offset:55424
    ds_read_b64_tr_b16 v[154:155], v140 offset:56960
    s_waitcnt vmcnt(4)
    s_waitcnt lgkmcnt(4)
    v_mfma_f32_32x32x16_bf16 v[34:49], v[156:159], v[114:117], v[34:49]
    ds_read_b64_tr_b16 v[156:157], v140 offset:58496
    ds_read_b64_tr_b16 v[158:159], v140 offset:60032
    s_waitcnt vmcnt(3)
    s_waitcnt lgkmcnt(4)
    v_mfma_f32_32x32x16_bf16 v[34:49], v[160:163], v[118:121], v[34:49]
    ds_read_b64_tr_b16 v[160:161], v140 offset:46080
    ds_read_b64_tr_b16 v[162:163], v140 offset:47616
    s_waitcnt vmcnt(2)
    s_waitcnt lgkmcnt(4)
    v_mfma_f32_32x32x16_bf16 v[34:49], v[152:155], v[122:125], v[34:49]
    ds_read_b64_tr_b16 v[152:153], v140 offset:46144
    ds_read_b64_tr_b16 v[154:155], v140 offset:47680
    s_waitcnt vmcnt(0)
    s_waitcnt lgkmcnt(4)
    v_mfma_f32_32x32x16_bf16 v[34:49], v[156:159], v[126:129], v[34:49]
    ds_read_b64_tr_b16 v[156:157], v140 offset:49152
    ds_read_b64_tr_b16 v[158:159], v140 offset:50688
    s_waitcnt lgkmcnt(4)
    v_mfma_f32_32x32x16_bf16 v[2:17], v[160:163], v[110:113], v[2:17]
    ds_read_b64_tr_b16 v[160:161], v140 offset:49216
    ds_read_b64_tr_b16 v[162:163], v140 offset:50752
    s_waitcnt lgkmcnt(4)
    v_mfma_f32_32x32x16_bf16 v[18:33], v[152:155], v[110:113], v[18:33]
    ds_read_b64_tr_b16 v[152:153], v140 offset:52224
    ds_read_b64_tr_b16 v[154:155], v140 offset:53760
    s_waitcnt lgkmcnt(4)
    v_mfma_f32_32x32x16_bf16 v[2:17], v[156:159], v[114:117], v[2:17]
    ds_read_b64_tr_b16 v[156:157], v140 offset:52288
    ds_read_b64_tr_b16 v[158:159], v140 offset:53824
    ds_write_b128 v132, v[34:37] offset:0
    s_waitcnt lgkmcnt(5)
    v_mfma_f32_32x32x16_bf16 v[18:33], v[160:163], v[114:117], v[18:33]
    ds_read_b64_tr_b16 v[160:161], v140 offset:55296
    ds_read_b64_tr_b16 v[162:163], v140 offset:56832
    ds_write_b128 v132, v[38:41] offset:1024
    s_waitcnt lgkmcnt(6)
    v_mfma_f32_32x32x16_bf16 v[2:17], v[152:155], v[118:121], v[2:17]
    ds_read_b64_tr_b16 v[152:153], v140 offset:55360
    ds_read_b64_tr_b16 v[154:155], v140 offset:56896
    ds_write_b128 v132, v[42:45] offset:2048
    s_waitcnt lgkmcnt(7)
    v_mfma_f32_32x32x16_bf16 v[18:33], v[156:159], v[118:121], v[18:33]
    ds_read_b64_tr_b16 v[156:157], v140 offset:58368
    ds_read_b64_tr_b16 v[158:159], v140 offset:59904
    ds_write_b128 v132, v[46:49] offset:3072
    s_waitcnt lgkmcnt(7)
    v_mfma_f32_32x32x16_bf16 v[2:17], v[160:163], v[122:125], v[2:17]
    ds_read_b64_tr_b16 v[160:161], v140 offset:58432
    ds_read_b64_tr_b16 v[162:163], v140 offset:59968
    s_waitcnt lgkmcnt(6)
    v_mfma_f32_32x32x16_bf16 v[18:33], v[152:155], v[122:125], v[18:33]
    s_waitcnt lgkmcnt(2)
    s_barrier
    ds_read_b128 v[50:53], v133 offset:0
    ds_read_b128 v[54:57], v133 offset:1024
    ds_read_b128 v[58:61], v133 offset:2048
    ds_read_b128 v[62:65], v133 offset:3072
    ds_read_b128 v[66:69], v133 offset:4096
    ds_read_b128 v[70:73], v133 offset:5120
    ds_read_b128 v[74:77], v133 offset:6144
    ds_read_b128 v[78:81], v133 offset:7168
    s_nop 0
    v_mfma_f32_32x32x16_bf16 v[2:17], v[156:159], v[126:129], v[2:17]
    s_waitcnt lgkmcnt(8)
    v_mfma_f32_32x32x16_bf16 v[18:33], v[160:163], v[126:129], v[18:33]
    s_nop 8
    s_waitcnt lgkmcnt(6)
    v_pk_add_f32 v[2:3], v[2:3], v[50:51]
    v_pk_add_f32 v[4:5], v[4:5], v[52:53]
    v_pk_add_f32 v[6:7], v[6:7], v[54:55]
    v_pk_add_f32 v[8:9], v[8:9], v[56:57]
    v_cvt_pk_bf16_f32 v2, v2, v3
    v_cvt_pk_bf16_f32 v3, v4, v5
    v_cvt_pk_bf16_f32 v4, v6, v7
    v_cvt_pk_bf16_f32 v5, v8, v9
    s_waitcnt lgkmcnt(4)
    v_pk_add_f32 v[10:11], v[10:11], v[58:59]
    v_pk_add_f32 v[12:13], v[12:13], v[60:61]
    v_pk_add_f32 v[14:15], v[14:15], v[62:63]
    v_pk_add_f32 v[16:17], v[16:17], v[64:65]
    v_cvt_pk_bf16_f32 v10, v10, v11
    v_cvt_pk_bf16_f32 v11, v12, v13
    v_cvt_pk_bf16_f32 v12, v14, v15
    v_cvt_pk_bf16_f32 v13, v16, v17
    s_nop 1
    v_permlane16_swap_b32 v2, v10
    v_permlane16_swap_b32 v3, v11
    v_permlane16_swap_b32 v4, v12
    v_permlane16_swap_b32 v5, v13
    buffer_store_dwordx4 v[2:5], v142, s[48:51], s65 offen offset:0 sc1
    buffer_store_dwordx4 v[10:13], v142, s[48:51], s67 offen offset:0 sc1
    s_waitcnt lgkmcnt(2)
    v_pk_add_f32 v[18:19], v[18:19], v[66:67]
    v_pk_add_f32 v[20:21], v[20:21], v[68:69]
    v_pk_add_f32 v[22:23], v[22:23], v[70:71]
    v_pk_add_f32 v[24:25], v[24:25], v[72:73]
    v_cvt_pk_bf16_f32 v18, v18, v19
    v_cvt_pk_bf16_f32 v19, v20, v21
    v_cvt_pk_bf16_f32 v20, v22, v23
    v_cvt_pk_bf16_f32 v21, v24, v25
    s_waitcnt lgkmcnt(0)
    v_pk_add_f32 v[26:27], v[26:27], v[74:75]
    v_pk_add_f32 v[28:29], v[28:29], v[76:77]
    v_pk_add_f32 v[30:31], v[30:31], v[78:79]
    v_pk_add_f32 v[32:33], v[32:33], v[80:81]
    v_cvt_pk_bf16_f32 v26, v26, v27
    v_cvt_pk_bf16_f32 v27, v28, v29
    v_cvt_pk_bf16_f32 v28, v30, v31
    v_cvt_pk_bf16_f32 v29, v32, v33
    s_nop 1
    v_permlane16_swap_b32 v18, v26
    v_permlane16_swap_b32 v19, v27
    v_permlane16_swap_b32 v20, v28
    v_permlane16_swap_b32 v21, v29
    buffer_store_dwordx4 v[18:21], v142, s[48:51], s65 offen offset:64 sc1
    buffer_store_dwordx4 v[26:29], v142, s[48:51], s67 offen offset:64 sc1
    s_endpgm
L_hi3:
    ds_read_b64_tr_b16 v[152:153], v140 offset:0
    ds_read_b64_tr_b16 v[154:155], v140 offset:1536
    ds_read_b64_tr_b16 v[156:157], v140 offset:64
    ds_read_b64_tr_b16 v[158:159], v140 offset:1600
    ds_read_b64_tr_b16 v[160:161], v140 offset:128
    ds_read_b64_tr_b16 v[162:163], v140 offset:1664
L_pahi3:
    s_waitcnt vmcnt(0)
    v_cmp_ne_u32 vcc, s33, v130
    s_nop 1
    s_and_b32 s34, vcc_lo, 0xffff
    s_cbranch_scc0 L_gahi3
    s_sub_u32 s36, s36, 1
    s_cbranch_scc1 L_gahi3
    buffer_load_dword v130, v1, s[24:27], s37 offen sc1
    s_branch L_pahi3
L_gahi3:
    buffer_load_dwordx4 v[50:53], v138, s[24:27], s52 offen offset:0 sc1
    buffer_load_dwordx4 v[54:57], v138, s[24:27], s52 offen offset:1024 sc1
    buffer_load_dwordx4 v[58:61], v138, s[24:27], s52 offen offset:2048 sc1
    buffer_load_dwordx4 v[62:65], v138, s[24:27], s52 offen offset:3072 sc1
    buffer_load_dwordx2 v[66:67], v139, s[24:27], s56 offen sc1
    buffer_load_dwordx2 v[68:69], v139, s[24:27], s56 offen offset:512 sc1
    buffer_load_dwordx4 v[70:73], v138, s[24:27], s53 offen offset:0 sc1
    buffer_load_dwordx4 v[74:77], v138, s[24:27], s53 offen offset:1024 sc1
    buffer_load_dwordx4 v[78:81], v138, s[24:27], s53 offen offset:2048 sc1
    s_waitcnt vmcnt(8)
    s_waitcnt lgkmcnt(4)
    v_mfma_f32_32x32x16_bf16 v[2:17], v[152:155], v[50:53], v[2:17]
    ds_read_b64_tr_b16 v[152:153], v140 offset:3072
    ds_read_b64_tr_b16 v[154:155], v140 offset:4608
    buffer_load_dwordx4 v[82:85], v138, s[24:27], s53 offen offset:3072 sc1
    s_waitcnt lgkmcnt(4)
    v_mfma_f32_32x32x16_bf16 v[18:33], v[156:159], v[50:53], v[18:33]
    ds_read_b64_tr_b16 v[156:157], v140 offset:3136
    ds_read_b64_tr_b16 v[158:159], v140 offset:4672
    buffer_load_dwordx2 v[86:87], v139, s[24:27], s57 offen sc1
    buffer_load_dwordx2 v[88:89], v139, s[24:27], s57 offen offset:512 sc1
    s_waitcnt lgkmcnt(4)
    v_mfma_f32_32x32x16_bf16 v[34:49], v[160:163], v[50:53], v[34:49]
    ds_read_b64_tr_b16 v[160:161], v140 offset:3200
    ds_read_b64_tr_b16 v[162:163], v140 offset:4736
    s_waitcnt vmcnt(10)
    s_waitcnt lgkmcnt(4)
    v_mfma_f32_32x32x16_bf16 v[2:17], v[152:155], v[54:57], v[2:17]
    ds_read_b64_tr_b16 v[152:153], v140 offset:6144
    ds_read_b64_tr_b16 v[154:155], v140 offset:7680
    buffer_load_dwordx4 v[90:93], v138, s[24:27], s54 offen offset:0 sc1
    s_waitcnt lgkmcnt(4)
    v_mfma_f32_32x32x16_bf16 v[18:33], v[156:159], v[54:57], v[18:33]
    ds_read_b64_tr_b16 v[156:157], v140 offset:6208
    ds_read_b64_tr_b16 v[158:159], v140 offset:7744
    buffer_load_dwordx4 v[94:97], v138, s[24:27], s54 offen offset:1024 sc1
    s_waitcnt lgkmcnt(4)
    v_mfma_f32_32x32x16_bf16 v[34:49], v[160:163], v[54:57], v[34:49]
    ds_read_b64_tr_b16 v[160:161], v140 offset:6272
    ds_read_b64_tr_b16 v[162:163], v140 offset:7808
    s_waitcnt vmcnt(11)
    s_waitcnt lgkmcnt(4)
    v_mfma_f32_32x32x16_bf16 v[2:17], v[152:155], v[58:61], v[2:17]
    ds_read_b64_tr_b16 v[152:153], v140 offset:9216
    ds_read_b64_tr_b16 v[154:155], v140 offset:10752
    buffer_load_dwordx4 v[98:101], v138, s[24:27], s54 offen offset:2048 sc1
    s_waitcnt lgkmcnt(4)
    v_mfma_f32_32x32x16_bf16 v[18:33], v[156:159], v[58:61], v[18:33]
    ds_read_b64_tr_b16 v[156:157], v140 offset:9280
    ds_read_b64_tr_b16 v[158:159], v140 offset:10816
    buffer_load_dwordx4 v[102:105], v138, s[24:27], s54 offen offset:3072 sc1
    s_waitcnt lgkmcnt(4)
    v_mfma_f32_32x32x16_bf16 v[34:49], v[160:163], v[58:61], v[34:49]
    ds_read_b64_tr_b16 v[160:161], v140 offset:9344
    ds_read_b64_tr_b16 v[162:163], v140 offset:10880
    s_waitcnt vmcnt(12)
    s_waitcnt lgkmcnt(4)
    v_mfma_f32_32x32x16_bf16 v[2:17], v[152:155], v[62:65], v[2:17]
    ds_read_b64_tr_b16 v[152:153], v140 offset:12288
    ds_read_b64_tr_b16 v[154:155], v140 offset:13824
    buffer_load_dwordx2 v[106:107], v139, s[24:27], s58 offen sc1
    buffer_load_dwordx2 v[108:109], v139, s[24:27], s58 offen offset:512 sc1
    s_waitcnt lgkmcnt(4)
    v_mfma_f32_32x32x16_bf16 v[18:33], v[156:159], v[62:65], v[18:33]
    ds_read_b64_tr_b16 v[156:157], v140 offset:12352
    ds_read_b64_tr_b16 v[158:159], v140 offset:13888
    buffer_load_dwordx4 v[110:113], v138, s[24:27], s55 offen offset:0 sc1
    s_waitcnt lgkmcnt(4)
    v_mfma_f32_32x32x16_bf16 v[34:49], v[160:163], v[62:65], v[34:49]
    ds_read_b64_tr_b16 v[160:161], v140 offset:12416
    ds_read_b64_tr_b16 v[162:163], v140 offset:13952
    s_waitcnt vmcnt(13)
    s_waitcnt lgkmcnt(4)
    v_mfma_f32_32x32x16_bf16 v[2:17], v[152:155], v[66:69], v[2:17]
    ds_read_b64_tr_b16 v[152:153], v140 offset:15360
    ds_read_b64_tr_b16 v[154:155], v140 offset:16896
    buffer_load_dwordx4 v[114:117], v138, s[24:27], s55 offen offset:1024 sc1
    s_waitcnt lgkmcnt(4)
    v_mfma_f32_32x32x16_bf16 v[18:33], v[156:159], v[66:69], v[18:33]
    ds_read_b64_tr_b16 v[156:157], v140 offset:15424
    ds_read_b64_tr_b16 v[158:159], v140 offset:16960
    buffer_load_dwordx4 v[118:121], v138, s[24:27], s55 offen offset:2048 sc1
    s_waitcnt lgkmcnt(4)
    v_mfma_f32_32x32x16_bf16 v[34:49], v[160:163], v[66:69], v[34:49]
    ds_read_b64_tr_b16 v[160:161], v140 offset:15488
    ds_read_b64_tr_b16 v[162:163], v140 offset:17024
    s_waitcnt vmcnt(14)
    s_waitcnt lgkmcnt(4)
    v_mfma_f32_32x32x16_bf16 v[2:17], v[152:155], v[70:73], v[2:17]
    ds_read_b64_tr_b16 v[152:153], v140 offset:18432
    ds_read_b64_tr_b16 v[154:155], v140 offset:19968
    buffer_load_dwordx4 v[122:125], v138, s[24:27], s55 offen offset:3072 sc1
    s_waitcnt lgkmcnt(4)
    v_mfma_f32_32x32x16_bf16 v[18:33], v[156:159], v[70:73], v[18:33]
    ds_read_b64_tr_b16 v[156:157], v140 offset:18496
    ds_read_b64_tr_b16 v[158:159], v140 offset:20032
    buffer_load_dwordx2 v[126:127], v139, s[24:27], s59 offen sc1
    buffer_load_dwordx2 v[128:129], v139, s[24:27], s59 offen offset:512 sc1
    s_waitcnt lgkmcnt(4)
    v_mfma_f32_32x32x16_bf16 v[34:49], v[160:163], v[70:73], v[34:49]
    ds_read_b64_tr_b16 v[160:161], v140 offset:18560
    ds_read_b64_tr_b16 v[162:163], v140 offset:20096
    s_waitcnt vmcnt(16)
    s_waitcnt lgkmcnt(4)
    v_mfma_f32_32x32x16_bf16 v[2:17], v[152:155], v[74:77], v[2:17]
    ds_read_b64_tr_b16 v[152:153], v140 offset:21504
    ds_read_b64_tr_b16 v[154:155], v140 offset:23040
    s_waitcnt lgkmcnt(4)
    v_mfma_f32_32x32x16_bf16 v[18:33], v[156:159], v[74:77], v[18:33]
    ds_read_b64_tr_b16 v[156:157], v140 offset:21568
    ds_read_b64_tr_b16 v[158:159], v140 offset:23104
    s_waitcnt lgkmcnt(4)
    v_mfma_f32_32x32x16_bf16 v[34:49], v[160:163], v[74:77], v[34:49]
    ds_read_b64_tr_b16 v[160:161], v140 offset:21632
    ds_read_b64_tr_b16 v[162:163], v140 offset:23168
    s_waitcnt vmcnt(15)
    s_waitcnt lgkmcnt(4)
    v_mfma_f32_32x32x16_bf16 v[2:17], v[152:155], v[78:81], v[2:17]
    ds_read_b64_tr_b16 v[152:153], v140 offset:24576
    ds_read_b64_tr_b16 v[154:155], v140 offset:26112
    s_waitcnt lgkmcnt(4)
    v_mfma_f32_32x32x16_bf16 v[18:33], v[156:159], v[78:81], v[18:33]
    ds_read_b64_tr_b16 v[156:157], v140 offset:24640
    ds_read_b64_tr_b16 v[158:159], v140 offset:26176
    s_waitcnt lgkmcnt(4)
    v_mfma_f32_32x32x16_bf16 v[34:49], v[160:163], v[78:81], v[34:49]
    ds_read_b64_tr_b16 v[160:161], v140 offset:24704
    ds_read_b64_tr_b16 v[162:163], v140 offset:26240
    s_waitcnt vmcnt(14)
    s_waitcnt lgkmcnt(4)
    v_mfma_f32_32x32x16_bf16 v[2:17], v[152:155], v[82:85], v[2:17]
    ds_read_b64_tr_b16 v[152:153], v140 offset:27648
    ds_read_b64_tr_b16 v[154:155], v140 offset:29184
    s_waitcnt lgkmcnt(4)
    v_mfma_f32_32x32x16_bf16 v[18:33], v[156:159], v[82:85], v[18:33]
    ds_read_b64_tr_b16 v[156:157], v140 offset:27712
    ds_read_b64_tr_b16 v[158:159], v140 offset:29248
    s_waitcnt lgkmcnt(4)
    v_mfma_f32_32x32x16_bf16 v[34:49], v[160:163], v[82:85], v[34:49]
    ds_read_b64_tr_b16 v[160:161], v140 offset:27776
    ds_read_b64_tr_b16 v[162:163], v140 offset:29312
    s_waitcnt vmcnt(12)
    s_waitcnt lgkmcnt(4)
    v_mfma_f32_32x32x16_bf16 v[2:17], v[152:155], v[86:89], v[2:17]
    ds_read_b64_tr_b16 v[152:153], v140 offset:30720
    ds_read_b64_tr_b16 v[154:155], v140 offset:32256
    s_waitcnt lgkmcnt(4)
    v_mfma_f32_32x32x16_bf16 v[18:33], v[156:159], v[86:89], v[18:33]
    ds_read_b64_tr_b16 v[156:157], v140 offset:30784
    ds_read_b64_tr_b16 v[158:159], v140 offset:32320
    s_waitcnt lgkmcnt(4)
    v_mfma_f32_32x32x16_bf16 v[34:49], v[160:163], v[86:89], v[34:49]
    ds_read_b64_tr_b16 v[160:161], v140 offset:33792
    ds_read_b64_tr_b16 v[162:163], v140 offset:35328
    s_waitcnt vmcnt(11)
    s_waitcnt lgkmcnt(4)
    v_mfma_f32_32x32x16_bf16 v[2:17], v[152:155], v[90:93], v[2:17]
    ds_read_b64_tr_b16 v[152:153], v140 offset:33856
    ds_read_b64_tr_b16 v[154:155], v140 offset:35392
    s_waitcnt lgkmcnt(4)
    v_mfma_f32_32x32x16_bf16 v[18:33], v[156:159], v[90:93], v[18:33]
    ds_read_b64_tr_b16 v[156:157], v140 offset:36864
    ds_read_b64_tr_b16 v[158:159], v140 offset:38400
    s_waitcnt vmcnt(10)
    s_waitcnt lgkmcnt(4)
    v_mfma_f32_32x32x16_bf16 v[2:17], v[160:163], v[94:97], v[2:17]
    ds_read_b64_tr_b16 v[160:161], v140 offset:36928
    ds_read_b64_tr_b16 v[162:163], v140 offset:38464
    s_waitcnt lgkmcnt(4)
    v_mfma_f32_32x32x16_bf16 v[18:33], v[152:155], v[94:97], v[18:33]
    ds_read_b64_tr_b16 v[152:153], v140 offset:39936
    ds_read_b64_tr_b16 v[154:155], v140 offset:41472
    s_waitcnt vmcnt(9)
    s_waitcnt lgkmcnt(4)
    v_mfma_f32_32x32x16_bf16 v[2:17], v[156:159], v[98:101], v[2:17]
    ds_read_b64_tr_b16 v[156:157], v140 offset:40000
    ds_read_b64_tr_b16 v[158:159], v140 offset:41536
    s_waitcnt lgkmcnt(4)
    v_mfma_f32_32x32x16_bf16 v[18:33], v[160:163], v[98:101], v[18:33]
    ds_read_b64_tr_b16 v[160:161], v140 offset:43008
    ds_read_b64_tr_b16 v[162:163], v140 offset:44544
    s_waitcnt vmcnt(8)
    s_waitcnt lgkmcnt(4)
    v_mfma_f32_32x32x16_bf16 v[2:17], v[152:155], v[102:105], v[2:17]
    ds_read_b64_tr_b16 v[152:153], v140 offset:43072
    ds_read_b64_tr_b16 v[154:155], v140 offset:44608
    s_waitcnt lgkmcnt(4)
    v_mfma_f32_32x32x16_bf16 v[18:33], v[156:159], v[102:105], v[18:33]
    ds_read_b64_tr_b16 v[156:157], v140 offset:46080
    ds_read_b64_tr_b16 v[158:159], v140 offset:47616
    s_waitcnt vmcnt(6)
    s_waitcnt lgkmcnt(4)
    v_mfma_f32_32x32x16_bf16 v[2:17], v[160:163], v[106:109], v[2:17]
    ds_read_b64_tr_b16 v[160:161], v140 offset:46144
    ds_read_b64_tr_b16 v[162:163], v140 offset:47680
    s_waitcnt lgkmcnt(4)
    v_mfma_f32_32x32x16_bf16 v[18:33], v[152:155], v[106:109], v[18:33]
    ds_read_b64_tr_b16 v[152:153], v140 offset:49152
    ds_read_b64_tr_b16 v[154:155], v140 offset:50688
    s_waitcnt vmcnt(5)
    s_waitcnt lgkmcnt(4)
    v_mfma_f32_32x32x16_bf16 v[2:17], v[156:159], v[110:113], v[2:17]
    ds_read_b64_tr_b16 v[156:157], v140 offset:49216
    ds_read_b64_tr_b16 v[158:159], v140 offset:50752
    s_waitcnt lgkmcnt(4)
    v_mfma_f32_32x32x16_bf16 v[18:33], v[160:163], v[110:113], v[18:33]
    ds_read_b64_tr_b16 v[160:161], v140 offset:52224
    ds_read_b64_tr_b16 v[162:163], v140 offset:53760
    s_waitcnt vmcnt(4)
    s_waitcnt lgkmcnt(4)
    v_mfma_f32_32x32x16_bf16 v[2:17], v[152:155], v[114:117], v[2:17]
    ds_read_b64_tr_b16 v[152:153], v140 offset:52288
    ds_read_b64_tr_b16 v[154:155], v140 offset:53824
    s_waitcnt lgkmcnt(4)
    v_mfma_f32_32x32x16_bf16 v[18:33], v[156:159], v[114:117], v[18:33]
    ds_read_b64_tr_b16 v[156:157], v140 offset:55296
    ds_read_b64_tr_b16 v[158:159], v140 offset:56832
    s_waitcnt vmcnt(3)
    s_waitcnt lgkmcnt(4)
    v_mfma_f32_32x32x16_bf16 v[2:17], v[160:163], v[118:121], v[2:17]
    ds_read_b64_tr_b16 v[160:161], v140 offset:55360
    ds_read_b64_tr_b16 v[162:163], v140 offset:56896
    s_waitcnt lgkmcnt(4)
    v_mfma_f32_32x32x16_bf16 v[18:33], v[152:155], v[118:121], v[18:33]
    ds_read_b64_tr_b16 v[152:153], v140 offset:58368
    ds_read_b64_tr_b16 v[154:155], v140 offset:59904
    s_waitcnt vmcnt(2)
    s_waitcnt lgkmcnt(4)
    v_mfma_f32_32x32x16_bf16 v[2:17], v[156:159], v[122:125], v[2:17]
    ds_read_b64_tr_b16 v[156:157], v140 offset:58432
    ds_read_b64_tr_b16 v[158:159], v140 offset:59968
    s_waitcnt lgkmcnt(4)
    v_mfma_f32_32x32x16_bf16 v[18:33], v[160:163], v[122:125], v[18:33]
    ds_read_b64_tr_b16 v[160:161], v140 offset:30848
    ds_read_b64_tr_b16 v[162:163], v140 offset:32384
    s_waitcnt vmcnt(0)
    s_waitcnt lgkmcnt(4)
    v_mfma_f32_32x32x16_bf16 v[2:17], v[152:155], v[126:129], v[2:17]
    ds_read_b64_tr_b16 v[152:153], v140 offset:33920
    ds_read_b64_tr_b16 v[154:155], v140 offset:35456
    s_waitcnt lgkmcnt(4)
    v_mfma_f32_32x32x16_bf16 v[18:33], v[156:159], v[126:129], v[18:33]
    ds_read_b64_tr_b16 v[156:157], v140 offset:36992
    ds_read_b64_tr_b16 v[158:159], v140 offset:38528
    s_waitcnt lgkmcnt(4)
    v_mfma_f32_32x32x16_bf16 v[34:49], v[160:163], v[90:93], v[34:49]
    ds_read_b64_tr_b16 v[160:161], v140 offset:40064
    ds_read_b64_tr_b16 v[162:163], v140 offset:41600
    s_waitcnt lgkmcnt(4)
    v_mfma_f32_32x32x16_bf16 v[34:49], v[152:155], v[94:97], v[34:49]
    ds_read_b64_tr_b16 v[152:153], v140 offset:43136
    ds_read_b64_tr_b16 v[154:155], v140 offset:44672
    s_waitcnt lgkmcnt(4)
    v_mfma_f32_32x32x16_bf16 v[34:49], v[156:159], v[98:101], v[34:49]
    ds_read_b64_tr_b16 v[156:157], v140 offset:46208
    ds_read_b64_tr_b16 v[158:159], v140 offset:47744
    ds_write_b128 v132, v[2:5] offset:0
    ds_write_b128 v132, v[6:9] offset:1024
    s_waitcnt lgkmcnt(6)
    v_mfma_f32_32x32x16_bf16 v[34:49], v[160:163], v[102:105], v[34:49]
    ds_read_b64_tr_b16 v[160:161], v140 offset:49280
    ds_read_b64_tr_b16 v[162:163], v140 offset:50816
    ds_write_b128 v132, v[10:13] offset:2048
    ds_write_b128 v132, v[14:17] offset:3072
    s_waitcnt lgkmcnt(8)
    v_mfma_f32_32x32x16_bf16 v[34:49], v[152:155], v[106:109], v[34:49]
    ds_read_b64_tr_b16 v[152:153], v140 offset:52352
    ds_read_b64_tr_b16 v[154:155], v140 offset:53888
    ds_write_b128 v132, v[18:21] offset:4096
    ds_write_b128 v132, v[22:25] offset:5120
    s_waitcnt lgkmcnt(10)
    v_mfma_f32_32x32x16_bf16 v[34:49], v[156:159], v[110:113], v[34:49]
    ds_read_b64_tr_b16 v[156:157], v140 offset:55424
    ds_read_b64_tr_b16 v[158:159], v140 offset:56960
    ds_write_b128 v132, v[26:29] offset:6144
    ds_write_b128 v132, v[30:33] offset:7168
    s_waitcnt lgkmcnt(10)
    v_mfma_f32_32x32x16_bf16 v[34:49], v[160:163], v[114:117], v[34:49]
    ds_read_b64_tr_b16 v[160:161], v140 offset:58496
    ds_read_b64_tr_b16 v[162:163], v140 offset:60032
    s_waitcnt lgkmcnt(8)
    v_mfma_f32_32x32x16_bf16 v[34:49], v[152:155], v[118:121], v[34:49]
    s_waitcnt lgkmcnt(2)
    s_barrier
    ds_read_b128 v[50:53], v133 offset:0
    ds_read_b128 v[54:57], v133 offset:1024
    ds_read_b128 v[58:61], v133 offset:2048
    ds_read_b128 v[62:65], v133 offset:3072
    s_nop 0
    v_mfma_f32_32x32x16_bf16 v[34:49], v[156:159], v[122:125], v[34:49]
    s_waitcnt lgkmcnt(4)
    v_mfma_f32_32x32x16_bf16 v[34:49], v[160:163], v[126:129], v[34:49]
    s_nop 10
    s_waitcnt lgkmcnt(2)
    v_pk_add_f32 v[34:35], v[34:35], v[50:51]
    v_pk_add_f32 v[36:37], v[36:37], v[52:53]
    v_pk_add_f32 v[38:39], v[38:39], v[54:55]
    v_pk_add_f32 v[40:41], v[40:41], v[56:57]
    v_cvt_pk_bf16_f32 v34, v34, v35
    v_cvt_pk_bf16_f32 v35, v36, v37
    v_cvt_pk_bf16_f32 v36, v38, v39
    v_cvt_pk_bf16_f32 v37, v40, v41
    s_waitcnt lgkmcnt(0)
    v_pk_add_f32 v[42:43], v[42:43], v[58:59]
    v_pk_add_f32 v[44:45], v[44:45], v[60:61]
    v_pk_add_f32 v[46:47], v[46:47], v[62:63]
    v_pk_add_f32 v[48:49], v[48:49], v[64:65]
    v_cvt_pk_bf16_f32 v42, v42, v43
    v_cvt_pk_bf16_f32 v43, v44, v45
    v_cvt_pk_bf16_f32 v44, v46, v47
    v_cvt_pk_bf16_f32 v45, v48, v49
    s_nop 1
    v_permlane16_swap_b32 v34, v42
    v_permlane16_swap_b32 v35, v43
    v_permlane16_swap_b32 v36, v44
    v_permlane16_swap_b32 v37, v45
    buffer_store_dwordx4 v[34:37], v142, s[48:51], s65 offen offset:128 sc1
    buffer_store_dwordx4 v[42:45], v142, s[48:51], s67 offen offset:128 sc1
    s_or_b32 s34, s2, s62
    s_cbranch_scc1 L_noep
    v_mov_b32 v1, s33
    v_mov_b32 v130, 0
    s_mov_b32 s34, 18087936
    s_mov_b64 exec, 1
    buffer_store_dword v1, v130, s[24:27], s34 offen sc1
L_noep:
    s_endpgm
L_p2_2:
    s_barrier
    s_add_u32 m0, s45, 15360
    s_add_u32 s34, s40, 30720
    s_mov_b64 exec, s[60:61]
    buffer_load_dwordx4 v138, s[24:27], s34 offen offset:0 sc1 lds
    buffer_load_dwordx4 v138, s[24:27], s34 offen offset:640 sc1 lds
    s_add_u32 m0, s46, 15744
    s_add_u32 s34, s34, 5120
    buffer_load_dwordx4 v138, s[24:27], s34 offen offset:0 sc1 lds
    s_sub_u32 s34, s34, 16
    buffer_load_dwordx4 v138, s[24:27], s34 offen offset:656 sc1 lds
    s_add_u32 m0, s66, 0
    s_cmp_ge_u32 s47, 27
    s_cselect_b32 s34, 552960, 0
    s_sub_u32 s34, s43, s34
    s_add_u32 s34, s34, 0
    s_mov_b64 exec, -1
    buffer_load_dwordx4 v144, s[48:51], s34 offen offset:0 lds
    buffer_load_dwordx4 v145, s[48:51], s34 offen offset:1024 lds
    s_waitcnt vmcnt(10)
    s_mov_b64 exec, 1
    buffer_store_dword v131, v1, s[24:27], s37 offen sc1
    s_mov_b64 exec, -1
    s_lshl_b32 s37, s3, 11
    s_add_u32 s37, s37, 17694720
    s_mov_b32 s36, 1048576
    s_waitcnt vmcnt(7)
    s_barrier
    s_add_u32 m0, s45, 0
    s_add_u32 s34, s40, 40960
    s_mov_b64 exec, s[60:61]
    buffer_load_dwordx4 v138, s[24:27], s34 offen offset:0 sc1 lds
    buffer_load_dwordx4 v138, s[24:27], s34 offen offset:640 sc1 lds
    s_add_u32 m0, s46, 0
    s_add_u32 s34, s34, 5120
    buffer_load_dwordx4 v138, s[24:27], s34 offen offset:0 sc1 lds
    s_sub_u32 s34, s34, 16
    buffer_load_dwordx4 v138, s[24:27], s34 offen offset:656 sc1 lds
    s_add_u32 m0, s66, 2048
    s_cmp_ge_u32 s47, 26
    s_cselect_b32 s34, 552960, 0
    s_sub_u32 s34, s43, s34
    s_add_u32 s34, s34, 20480
    s_mov_b64 exec, -1
    buffer_load_dwordx4 v144, s[48:51], s34 offen offset:0 lds
    buffer_load_dwordx4 v145, s[48:51], s34 offen offset:1024 lds
    s_add_u32 m0, s66, 4096
    s_cmp_ge_u32 s47, 25
    s_cselect_b32 s34, 552960, 0
    s_sub_u32 s34, s43, s34
    s_add_u32 s34, s34, 40960
    buffer_load_dwordx4 v144, s[48:51], s34 offen offset:0 lds
    buffer_load_dwordx4 v145, s[48:51], s34 offen offset:1024 lds
    s_add_u32 m0, s66, 8192
    s_add_u32 s34, s44, 0
    buffer_load_dwordx4 v148, s[52:55], s34 offen offset:0 lds
    buffer_load_dwordx4 v149, s[52:55], s34 offen offset:1024 lds
    s_mov_b32 s56, s4
    s_mov_b32 s57, s5
    s_mov_b32 s58, 2621440
    s_mov_b32 s59, 0x00020000
    s_lshl_b32 s34, s38, 11
    s_add_u32 m0, s34, 81920
    s_lshl2_add_u32 s34, s3, s38
    s_mul_i32 s34, s34, 20480
    buffer_load_dwordx4 v144, s[56:59], s34 offen offset:0 lds
    buffer_load_dwordx4 v145, s[56:59], s34 offen offset:1024 lds
    s_mov_b32 s56, s18
    s_mov_b32 s57, s19
    s_mov_b32 s58, 1280
    s_mov_b32 s59, 0x00020000
    s_mov_b32 m0, 90112
    s_mov_b32 s34, 0
    buffer_load_dwordx4 v144, s[56:59], s34 offen offset:0 lds
    buffer_load_dword v130, v1, s[24:27], s37 offen sc1
    s_waitcnt vmcnt(17)
    s_barrier
    s_setprio 3
L_poll2_2:
    s_waitcnt vmcnt(0)
    v_cmp_ne_u32 vcc, s33, v130
    s_nop 1
    s_cmp_eq_u64 vcc, 0
    s_cbranch_scc1 L_poll2x_2
    s_sub_u32 s36, s36, 1
    s_cbranch_scc1 L_poll2x_2
    buffer_load_dword v130, v1, s[24:27], s37 offen sc1
    s_branch L_poll2_2
L_poll2x_2:
    s_setprio 0
    s_cmp_ge_u32 s47, 27
    s_cselect_b32 s35, 27648, 0
    s_sub_u32 s35, s41, s35
    s_add_u32 s35, s35, 0
    buffer_load_dwordx4 v[98:101], v138, s[24:27], s35 offen sc1
    s_add_u32 s35, s35, s42
    buffer_load_dwordx4 v[102:105], v138, s[24:27], s35 offen sc1
    s_add_u32 m0, s45, 5120
    s_add_u32 s34, s40, 51200
    s_mov_b64 exec, s[60:61]
    buffer_load_dwordx4 v138, s[24:27], s34 offen offset:0 sc1 lds
    buffer_load_dwordx4 v138, s[24:27], s34 offen offset:640 sc1 lds
    s_add_u32 m0, s46, 5248
    s_add_u32 s34, s34, 5120
    buffer_load_dwordx4 v138, s[24:27], s34 offen offset:0 sc1 lds
    s_sub_u32 s34, s34, 16
    buffer_load_dwordx4 v138, s[24:27], s34 offen offset:656 sc1 lds
    s_cmp_ge_u32 s47, 26
    s_cselect_b32 s35, 27648, 0
    s_sub_u32 s35, s41, s35
    s_add_u32 s35, s35, 1024
    s_mov_b64 exec, -1
    buffer_load_dwordx4 v[106:109], v138, s[24:27], s35 offen sc1
    s_add_u32 s35, s35, s42
    buffer_load_dwordx4 v[110:113], v138, s[24:27], s35 offen sc1
    s_cmp_ge_u32 s47, 25
    s_cselect_b32 s35, 27648, 0
    s_sub_u32 s35, s41, s35
    s_add_u32 s35, s35, 2048
    buffer_load_dwordx4 v[114:117], v138, s[24:27], s35 offen sc1
    s_add_u32 s35, s35, s42
    buffer_load_dwordx4 v[118:121], v138, s[24:27], s35 offen sc1
    s_add_u32 m0, s66, 10240
    s_add_u32 s34, s68, 0
    buffer_load_dwordx4 v144, s[52:55], s34 offen offset:0 lds
    buffer_load_dwordx4 v145, s[52:55], s34 offen offset:1024 lds
    s_lshl_b32 s34, s3, 10
    s_lshl4_add_u32 s34, s62, s34
    s_add_u32 s34, s34, 17563648
    buffer_load_dwordx2 v[164:165], v167, s[24:27], s34 offen offset:8 sc1
    ds_read_b64_tr_b16 v[152:153], v140 offset:0
    ds_read_b64_tr_b16 v[154:155], v140 offset:1024
    ds_read_b64_tr_b16 v[156:157], v141 offset:0
    ds_read_b64_tr_b16 v[158:159], v141 offset:1024
    s_barrier
    s_waitcnt vmcnt(11)
    s_waitcnt lgkmcnt(2)
    v_mfma_f32_32x32x16_bf16 v[2:17], v[152:155], v[98:101], 0
    ds_read_b64_tr_b16 v[160:161], v140 offset:2048
    ds_read_b64_tr_b16 v[162:163], v140 offset:3072
    s_add_u32 m0, s45, 10240
    s_add_u32 s34, s40, 61440
    s_mov_b64 exec, s[60:61]
    buffer_load_dwordx4 v138, s[24:27], s34 offen offset:0 sc1 lds
    buffer_load_dwordx4 v138, s[24:27], s34 offen offset:640 sc1 lds
    s_add_u32 m0, s46, 10496
    s_add_u32 s34, s34, 5120
    buffer_load_dwordx4 v138, s[24:27], s34 offen offset:0 sc1 lds
    s_mov_b64 exec, -1
    v_mfma_f32_32x32x16_bf16 v[50:65], v[152:155], v[102:105], 0
    s_sub_u32 s34, s34, 16
    s_mov_b64 exec, s[60:61]
    buffer_load_dwordx4 v138, s[24:27], s34 offen offset:656 sc1 lds
    s_add_u32 m0, s66, 6144
    s_cmp_ge_u32 s47, 24
    s_cselect_b32 s34, 552960, 0
    s_sub_u32 s34, s43, s34
    s_add_u32 s34, s34, 61440
    s_mov_b64 exec, -1
    buffer_load_dwordx4 v144, s[48:51], s34 offen offset:0 lds
    s_waitcnt lgkmcnt(2)
    v_mfma_f32_32x32x16_bf16 v[18:33], v[156:159], v[98:101], 0
    ds_read_b64_tr_b16 v[152:153], v141 offset:2048
    ds_read_b64_tr_b16 v[154:155], v141 offset:3072
    buffer_load_dwordx4 v145, s[48:51], s34 offen offset:1024 lds
    v_mfma_f32_32x32x16_bf16 v[66:81], v[156:159], v[102:105], 0
    s_cmp_ge_u32 s47, 24
    s_cselect_b32 s35, 27648, 0
    s_sub_u32 s35, s41, s35
    s_add_u32 s35, s35, 3072
    buffer_load_dwordx4 v[122:125], v138, s[24:27], s35 offen sc1
    s_waitcnt vmcnt(12)
    s_waitcnt lgkmcnt(2)
    v_mfma_f32_32x32x16_bf16 v[2:17], v[160:163], v[106:109], v[2:17]
    ds_read_b64_tr_b16 v[156:157], v140 offset:4096
    ds_read_b64_tr_b16 v[158:159], v140 offset:5120
    s_add_u32 s35, s35, s42
    buffer_load_dwordx4 v[126:129], v138, s[24:27], s35 offen sc1
    s_add_u32 m0, s66, 0
    s_cmp_ge_u32 s47, 23
    s_cselect_b32 s34, 552960, 0
    s_sub_u32 s34, s43, s34
    s_add_u32 s34, s34, 81920
    buffer_load_dwordx4 v144, s[48:51], s34 offen offset:0 lds
    v_mfma_f32_32x32x16_bf16 v[50:65], v[160:163], v[110:113], v[50:65]
    buffer_load_dwordx4 v145, s[48:51], s34 offen offset:1024 lds
    s_waitcnt lgkmcnt(2)
    v_mfma_f32_32x32x16_bf16 v[18:33], v[152:155], v[106:109], v[18:33]
    ds_read_b64_tr_b16 v[160:161], v141 offset:4096
    ds_read_b64_tr_b16 v[162:163], v141 offset:5120
    s_cmp_ge_u32 s47, 23
    s_cselect_b32 s35, 27648, 0
    s_sub_u32 s35, s41, s35
    s_add_u32 s35, s35, 4096
    buffer_load_dwordx4 v[98:101], v138, s[24:27], s35 offen sc1
    v_mfma_f32_32x32x16_bf16 v[66:81], v[152:155], v[110:113], v[66:81]
    s_add_u32 s35, s35, s42
    buffer_load_dwordx4 v[102:105], v138, s[24:27], s35 offen sc1
    s_waitcnt vmcnt(15)
    s_waitcnt lgkmcnt(2)
    v_mfma_f32_32x32x16_bf16 v[2:17], v[156:159], v[114:117], v[2:17]
    s_waitcnt vmcnt(6)
    ds_read_b64_tr_b16 v[152:153], v140 offset:6144
    ds_read_b64_tr_b16 v[154:155], v140 offset:7168
    s_add_u32 m0, s66, 2048
    s_cmp_ge_u32 s47, 22
    s_cselect_b32 s34, 552960, 0
    s_sub_u32 s34, s43, s34
    s_add_u32 s34, s34, 102400
    buffer_load_dwordx4 v144, s[48:51], s34 offen offset:0 lds
    buffer_load_dwordx4 v145, s[48:51], s34 offen offset:1024 lds
    v_mfma_f32_32x32x16_bf16 v[50:65], v[156:159], v[118:121], v[50:65]
    s_cmp_ge_u32 s47, 22
    s_cselect_b32 s35, 27648, 0
    s_sub_u32 s35, s41, s35
    s_add_u32 s35, s35, 5120
    buffer_load_dwordx4 v[106:109], v138, s[24:27], s35 offen sc1
    s_waitcnt lgkmcnt(2)
    v_mfma_f32_32x32x16_bf16 v[18:33], v[160:163], v[114:117], v[18:33]
    ds_read_b64_tr_b16 v[156:157], v141 offset:6144
    ds_read_b64_tr_b16 v[158:159], v141 offset:7168
    s_add_u32 s35, s35, s42
    buffer_load_dwordx4 v[110:113], v138, s[24:27], s35 offen sc1
    v_mfma_f32_32x32x16_bf16 v[66:81], v[160:163], v[118:121], v[66:81]
    s_barrier
    s_waitcnt vmcnt(8)
    s_waitcnt lgkmcnt(2)
    v_mfma_f32_32x32x16_bf16 v[2:17], v[152:155], v[122:125], v[2:17]
    s_waitcnt vmcnt(6)
    ds_read_b64_tr_b16 v[160:161], v140 offset:0
    ds_read_b64_tr_b16 v[162:163], v140 offset:1024
    s_add_u32 m0, s45, 15360
    s_add_u32 s34, s40, 71680
    s_mov_b64 exec, s[60:61]
    buffer_load_dwordx4 v138, s[24:27], s34 offen offset:0 sc1 lds
    buffer_load_dwordx4 v138, s[24:27], s34 offen offset:640 sc1 lds
    s_add_u32 m0, s46, 15744
    s_add_u32 s34, s34, 5120
    buffer_load_dwordx4 v138, s[24:27], s34 offen offset:0 sc1 lds
    s_mov_b64 exec, -1
    v_mfma_f32_32x32x16_bf16 v[50:65], v[152:155], v[126:129], v[50:65]
    s_sub_u32 s34, s34, 16
    s_mov_b64 exec, s[60:61]
    buffer_load_dwordx4 v138, s[24:27], s34 offen offset:656 sc1 lds
    s_add_u32 m0, s66, 4096
    s_cmp_ge_u32 s47, 21
    s_cselect_b32 s34, 552960, 0
    s_sub_u32 s34, s43, s34
    s_add_u32 s34, s34, 122880
    s_mov_b64 exec, -1
    buffer_load_dwordx4 v144, s[48:51], s34 offen offset:0 lds
    s_waitcnt lgkmcnt(2)
    v_mfma_f32_32x32x16_bf16 v[18:33], v[156:159], v[122:125], v[18:33]
    ds_read_b64_tr_b16 v[152:153], v141 offset:0
    ds_read_b64_tr_b16 v[154:155], v141 offset:1024
    buffer_load_dwordx4 v145, s[48:51], s34 offen offset:1024 lds
    v_mfma_f32_32x32x16_bf16 v[66:81], v[156:159], v[126:129], v[66:81]
    s_cmp_ge_u32 s47, 21
    s_cselect_b32 s35, 27648, 0
    s_sub_u32 s35, s41, s35
    s_add_u32 s35, s35, 6144
    buffer_load_dwordx4 v[114:117], v138, s[24:27], s35 offen sc1
    s_waitcnt vmcnt(11)
    s_waitcnt lgkmcnt(2)
    v_mfma_f32_32x32x16_bf16 v[2:17], v[160:163], v[98:101], v[2:17]
    s_waitcnt vmcnt(9)
    ds_read_b64_tr_b16 v[156:157], v140 offset:2048
    ds_read_b64_tr_b16 v[158:159], v140 offset:3072
    s_add_u32 s35, s35, s42
    buffer_load_dwordx4 v[118:121], v138, s[24:27], s35 offen sc1
    s_add_u32 m0, s66, 6144
    s_cmp_ge_u32 s47, 20
    s_cselect_b32 s34, 552960, 0
    s_sub_u32 s34, s43, s34
    s_add_u32 s34, s34, 143360
    buffer_load_dwordx4 v144, s[48:51], s34 offen offset:0 lds
    v_mfma_f32_32x32x16_bf16 v[50:65], v[160:163], v[102:105], v[50:65]
    buffer_load_dwordx4 v145, s[48:51], s34 offen offset:1024 lds
    s_waitcnt lgkmcnt(2)
    v_mfma_f32_32x32x16_bf16 v[18:33], v[152:155], v[98:101], v[18:33]
    ds_read_b64_tr_b16 v[160:161], v141 offset:2048
    ds_read_b64_tr_b16 v[162:163], v141 offset:3072
    s_cmp_ge_u32 s47, 20
    s_cselect_b32 s35, 27648, 0
    s_sub_u32 s35, s41, s35
    s_add_u32 s35, s35, 7168
    buffer_load_dwordx4 v[122:125], v138, s[24:27], s35 offen sc1
    v_mfma_f32_32x32x16_bf16 v[66:81], v[152:155], v[102:105], v[66:81]
    s_add_u32 s35, s35, s42
    buffer_load_dwordx4 v[126:129], v138, s[24:27], s35 offen sc1
    s_waitcnt vmcnt(12)
    s_waitcnt lgkmcnt(2)
    v_mfma_f32_32x32x16_bf16 v[2:17], v[156:159], v[106:109], v[2:17]
    s_waitcnt vmcnt(6)
    ds_read_b64_tr_b16 v[152:153], v140 offset:4096
    ds_read_b64_tr_b16 v[154:155], v140 offset:5120
    s_add_u32 m0, s66, 0
    s_cmp_ge_u32 s47, 19
    s_cselect_b32 s34, 552960, 0
    s_sub_u32 s34, s43, s34
    s_add_u32 s34, s34, 163840
    buffer_load_dwordx4 v144, s[48:51], s34 offen offset:0 lds
    buffer_load_dwordx4 v145, s[48:51], s34 offen offset:1024 lds
    v_mfma_f32_32x32x16_bf16 v[50:65], v[156:159], v[110:113], v[50:65]
    s_cmp_ge_u32 s47, 19
    s_cselect_b32 s35, 27648, 0
    s_sub_u32 s35, s41, s35
    s_add_u32 s35, s35, 8192
    buffer_load_dwordx4 v[98:101], v138, s[24:27], s35 offen sc1
    s_waitcnt lgkmcnt(2)
    v_mfma_f32_32x32x16_bf16 v[18:33], v[160:163], v[106:109], v[18:33]
    ds_read_b64_tr_b16 v[156:157], v141 offset:4096
    ds_read_b64_tr_b16 v[158:159], v141 offset:5120
    s_add_u32 s35, s35, s42
    buffer_load_dwordx4 v[102:105], v138, s[24:27], s35 offen sc1
    v_mfma_f32_32x32x16_bf16 v[66:81], v[160:163], v[110:113], v[66:81]
    s_barrier
    s_waitcnt vmcnt(8)
    s_waitcnt lgkmcnt(2)
    v_mfma_f32_32x32x16_bf16 v[2:17], v[152:155], v[114:117], v[2:17]
    s_waitcnt vmcnt(6)
    ds_read_b64_tr_b16 v[160:161], v140 offset:6144
    ds_read_b64_tr_b16 v[162:163], v140 offset:7168
    s_add_u32 m0, s45, 0
    s_add_u32 s34, s40, 81920
    s_mov_b64 exec, s[60:61]
    buffer_load_dwordx4 v138, s[24:27], s34 offen offset:0 sc1 lds
    buffer_load_dwordx4 v138, s[24:27], s34 offen offset:640 sc1 lds
    s_add_u32 m0, s46, 0
    s_add_u32 s34, s34, 5120
    buffer_load_dwordx4 v138, s[24:27], s34 offen offset:0 sc1 lds
    s_sub_u32 s34, s34, 16
    buffer_load_dwordx4 v138, s[24:27], s34 offen offset:656 sc1 lds
    s_mov_b64 exec, -1
    v_mfma_f32_32x32x16_bf16 v[50:65], v[152:155], v[118:121], v[50:65]
    s_add_u32 m0, s66, 12288
    s_add_u32 s34, s68, 25600
    buffer_load_dwordx4 v144, s[52:55], s34 offen offset:0 lds
    buffer_load_dwordx4 v145, s[52:55], s34 offen offset:1024 lds
    s_waitcnt lgkmcnt(2)
    v_mfma_f32_32x32x16_bf16 v[18:33], v[156:159], v[114:117], v[18:33]
    ds_read_b64_tr_b16 v[152:153], v141 offset:6144
    ds_read_b64_tr_b16 v[154:155], v141 offset:7168
    s_add_u32 m0, s66, 2048
    s_cmp_ge_u32 s47, 18
    s_cselect_b32 s34, 552960, 0
    s_sub_u32 s34, s43, s34
    s_add_u32 s34, s34, 184320
    buffer_load_dwordx4 v144, s[48:51], s34 offen offset:0 lds
    buffer_load_dwordx4 v145, s[48:51], s34 offen offset:1024 lds
    v_mfma_f32_32x32x16_bf16 v[66:81], v[156:159], v[118:121], v[66:81]
    s_cmp_ge_u32 s47, 18
    s_cselect_b32 s35, 27648, 0
    s_sub_u32 s35, s41, s35
    s_add_u32 s35, s35, 9216
    buffer_load_dwordx4 v[106:109], v138, s[24:27], s35 offen sc1
    s_waitcnt vmcnt(13)
    s_waitcnt lgkmcnt(2)
    v_mfma_f32_32x32x16_bf16 v[2:17], v[160:163], v[122:125], v[2:17]
    s_waitcnt vmcnt(11)
    ds_read_b64_tr_b16 v[156:157], v140 offset:0
    ds_read_b64_tr_b16 v[158:159], v140 offset:1024
    s_add_u32 s35, s35, s42
    buffer_load_dwordx4 v[110:113], v138, s[24:27], s35 offen sc1
    s_add_u32 m0, s66, 4096
    s_cmp_ge_u32 s47, 17
    s_cselect_b32 s34, 552960, 0
    s_sub_u32 s34, s43, s34
    s_add_u32 s34, s34, 204800
    buffer_load_dwordx4 v144, s[48:51], s34 offen offset:0 lds
    v_mfma_f32_32x32x16_bf16 v[50:65], v[160:163], v[126:129], v[50:65]
    buffer_load_dwordx4 v145, s[48:51], s34 offen offset:1024 lds
    s_waitcnt lgkmcnt(2)
    v_mfma_f32_32x32x16_bf16 v[18:33], v[152:155], v[122:125], v[18:33]
    ds_read_b64_tr_b16 v[160:161], v141 offset:0
    ds_read_b64_tr_b16 v[162:163], v141 offset:1024
    s_cmp_ge_u32 s47, 17
    s_cselect_b32 s35, 27648, 0
    s_sub_u32 s35, s41, s35
    s_add_u32 s35, s35, 10240
    buffer_load_dwordx4 v[114:117], v138, s[24:27], s35 offen sc1
    v_mfma_f32_32x32x16_bf16 v[66:81], v[152:155], v[126:129], v[66:81]
    s_add_u32 s35, s35, s42
    buffer_load_dwordx4 v[118:121], v138, s[24:27], s35 offen sc1
    s_waitcnt vmcnt(14)
    s_waitcnt lgkmcnt(2)
    v_mfma_f32_32x32x16_bf16 v[2:17], v[156:159], v[98:101], v[2:17]
    s_waitcnt vmcnt(6)
    ds_read_b64_tr_b16 v[152:153], v140 offset:2048
    ds_read_b64_tr_b16 v[154:155], v140 offset:3072
    s_add_u32 m0, s66, 6144
    s_cmp_ge_u32 s47, 16
    s_cselect_b32 s34, 552960, 0
    s_sub_u32 s34, s43, s34
    s_add_u32 s34, s34, 225280
    buffer_load_dwordx4 v144, s[48:51], s34 offen offset:0 lds
    buffer_load_dwordx4 v145, s[48:51], s34 offen offset:1024 lds
    v_mfma_f32_32x32x16_bf16 v[50:65], v[156:159], v[102:105], v[50:65]
    s_cmp_ge_u32 s47, 16
    s_cselect_b32 s35, 27648, 0
    s_sub_u32 s35, s41, s35
    s_add_u32 s35, s35, 11264
    buffer_load_dwordx4 v[122:125], v138, s[24:27], s35 offen sc1
    s_barrier
    s_waitcnt lgkmcnt(2)
    v_mfma_f32_32x32x16_bf16 v[18:33], v[160:163], v[98:101], v[18:33]
    ds_read_b64_tr_b16 v[156:157], v141 offset:2048
    ds_read_b64_tr_b16 v[158:159], v141 offset:3072
    s_add_u32 s35, s35, s42
    buffer_load_dwordx4 v[126:129], v138, s[24:27], s35 offen sc1
    s_add_u32 m0, s45, 5120
    s_add_u32 s34, s40, 92160
    s_mov_b64 exec, s[60:61]
    buffer_load_dwordx4 v138, s[24:27], s34 offen offset:0 sc1 lds
    s_mov_b64 exec, -1
    v_mfma_f32_32x32x16_bf16 v[66:81], v[160:163], v[102:105], v[66:81]
    s_mov_b64 exec, s[60:61]
    buffer_load_dwordx4 v138, s[24:27], s34 offen offset:640 sc1 lds
    s_mov_b64 exec, -1
    s_waitcnt vmcnt(10)
    s_waitcnt lgkmcnt(2)
    v_mfma_f32_32x32x16_bf16 v[2:17], v[152:155], v[106:109], v[2:17]
    s_waitcnt vmcnt(8)
    ds_read_b64_tr_b16 v[160:161], v140 offset:4096
    ds_read_b64_tr_b16 v[162:163], v140 offset:5120
    s_add_u32 m0, s46, 5248
    s_add_u32 s34, s34, 5120
    s_mov_b64 exec, s[60:61]
    buffer_load_dwordx4 v138, s[24:27], s34 offen offset:0 sc1 lds
    s_sub_u32 s34, s34, 16
    buffer_load_dwordx4 v138, s[24:27], s34 offen offset:656 sc1 lds
    s_mov_b64 exec, -1
    v_mfma_f32_32x32x16_bf16 v[50:65], v[152:155], v[110:113], v[50:65]
    s_add_u32 m0, s66, 0
    s_cmp_ge_u32 s47, 15
    s_cselect_b32 s34, 552960, 0
    s_sub_u32 s34, s43, s34
    s_add_u32 s34, s34, 245760
    buffer_load_dwordx4 v144, s[48:51], s34 offen offset:0 lds
    buffer_load_dwordx4 v145, s[48:51], s34 offen offset:1024 lds
    s_waitcnt lgkmcnt(2)
    v_mfma_f32_32x32x16_bf16 v[18:33], v[156:159], v[106:109], v[18:33]
    ds_read_b64_tr_b16 v[152:153], v141 offset:4096
    ds_read_b64_tr_b16 v[154:155], v141 offset:5120
    s_cmp_ge_u32 s47, 15
    s_cselect_b32 s35, 27648, 0
    s_sub_u32 s35, s41, s35
    s_add_u32 s35, s35, 12288
    buffer_load_dwordx4 v[98:101], v138, s[24:27], s35 offen sc1
    v_mfma_f32_32x32x16_bf16 v[66:81], v[156:159], v[110:113], v[66:81]
    s_add_u32 s35, s35, s42
    buffer_load_dwordx4 v[102:105], v138, s[24:27], s35 offen sc1
    s_waitcnt vmcnt(12)
    s_waitcnt lgkmcnt(2)
    v_mfma_f32_32x32x16_bf16 v[2:17], v[160:163], v[114:117], v[2:17]
    s_waitcnt vmcnt(10)
    ds_read_b64_tr_b16 v[156:157], v140 offset:6144
    ds_read_b64_tr_b16 v[158:159], v140 offset:7168
    s_add_u32 m0, s66, 2048
    s_cmp_ge_u32 s47, 14
    s_cselect_b32 s34, 552960, 0
    s_sub_u32 s34, s43, s34
    s_add_u32 s34, s34, 266240
    buffer_load_dwordx4 v144, s[48:51], s34 offen offset:0 lds
    buffer_load_dwordx4 v145, s[48:51], s34 offen offset:1024 lds
    v_mfma_f32_32x32x16_bf16 v[50:65], v[160:163], v[118:121], v[50:65]
    s_cmp_ge_u32 s47, 14
    s_cselect_b32 s35, 27648, 0
    s_sub_u32 s35, s41, s35
    s_add_u32 s35, s35, 13312
    buffer_load_dwordx4 v[106:109], v138, s[24:27], s35 offen sc1
    s_waitcnt lgkmcnt(2)
    v_mfma_f32_32x32x16_bf16 v[18:33], v[152:155], v[114:117], v[18:33]
    ds_read_b64_tr_b16 v[160:161], v141 offset:6144
    ds_read_b64_tr_b16 v[162:163], v141 offset:7168
    s_add_u32 s35, s35, s42
    buffer_load_dwordx4 v[110:113], v138, s[24:27], s35 offen sc1
    v_mfma_f32_32x32x16_bf16 v[66:81], v[152:155], v[118:121], v[66:81]
    s_waitcnt vmcnt(12)
    s_waitcnt lgkmcnt(2)
    v_mfma_f32_32x32x16_bf16 v[2:17], v[156:159], v[122:125], v[2:17]
    s_waitcnt vmcnt(6)
    ds_read_b64_tr_b16 v[152:153], v140 offset:0
    ds_read_b64_tr_b16 v[154:155], v140 offset:1024
    s_add_u32 m0, s66, 4096
    s_cmp_ge_u32 s47, 13
    s_cselect_b32 s34, 552960, 0
    s_sub_u32 s34, s43, s34
    s_add_u32 s34, s34, 286720
    buffer_load_dwordx4 v144, s[48:51], s34 offen offset:0 lds
    buffer_load_dwordx4 v145, s[48:51], s34 offen offset:1024 lds
    v_mfma_f32_32x32x16_bf16 v[50:65], v[156:159], v[126:129], v[50:65]
    s_cmp_ge_u32 s47, 13
    s_cselect_b32 s35, 27648, 0
    s_sub_u32 s35, s41, s35
    s_add_u32 s35, s35, 14336
    buffer_load_dwordx4 v[114:117], v138, s[24:27], s35 offen sc1
    s_barrier
    s_waitcnt lgkmcnt(2)
    v_mfma_f32_32x32x16_bf16 v[18:33], v[160:163], v[122:125], v[18:33]
    ds_read_b64_tr_b16 v[156:157], v141 offset:0
    ds_read_b64_tr_b16 v[158:159], v141 offset:1024
    s_add_u32 s35, s35, s42
    buffer_load_dwordx4 v[118:121], v138, s[24:27], s35 offen sc1
    s_add_u32 m0, s45, 10240
    s_add_u32 s34, s40, 102400
    s_mov_b64 exec, s[60:61]
    buffer_load_dwordx4 v138, s[24:27], s34 offen offset:0 sc1 lds
    s_mov_b64 exec, -1
    v_mfma_f32_32x32x16_bf16 v[66:81], v[160:163], v[126:129], v[66:81]
    s_mov_b64 exec, s[60:61]
    buffer_load_dwordx4 v138, s[24:27], s34 offen offset:640 sc1 lds
    s_mov_b64 exec, -1
    s_waitcnt vmcnt(10)
    s_waitcnt lgkmcnt(2)
    v_mfma_f32_32x32x16_bf16 v[2:17], v[152:155], v[98:101], v[2:17]
    s_waitcnt vmcnt(8)
    ds_read_b64_tr_b16 v[160:161], v140 offset:2048
    ds_read_b64_tr_b16 v[162:163], v140 offset:3072
    s_add_u32 m0, s46, 10496
    s_add_u32 s34, s34, 5120
    s_mov_b64 exec, s[60:61]
    buffer_load_dwordx4 v138, s[24:27], s34 offen offset:0 sc1 lds
    s_sub_u32 s34, s34, 16
    buffer_load_dwordx4 v138, s[24:27], s34 offen offset:656 sc1 lds
    s_mov_b64 exec, -1
    v_mfma_f32_32x32x16_bf16 v[50:65], v[152:155], v[102:105], v[50:65]
    s_add_u32 m0, s66, 6144
    s_cmp_ge_u32 s47, 12
    s_cselect_b32 s34, 552960, 0
    s_sub_u32 s34, s43, s34
    s_add_u32 s34, s34, 307200
    buffer_load_dwordx4 v144, s[48:51], s34 offen offset:0 lds
    buffer_load_dwordx4 v145, s[48:51], s34 offen offset:1024 lds
    s_waitcnt lgkmcnt(2)
    v_mfma_f32_32x32x16_bf16 v[18:33], v[156:159], v[98:101], v[18:33]
    ds_read_b64_tr_b16 v[152:153], v141 offset:2048
    ds_read_b64_tr_b16 v[154:155], v141 offset:3072
    s_cmp_ge_u32 s47, 12
    s_cselect_b32 s35, 27648, 0
    s_sub_u32 s35, s41, s35
    s_add_u32 s35, s35, 15360
    buffer_load_dwordx4 v[122:125], v138, s[24:27], s35 offen sc1
    v_mfma_f32_32x32x16_bf16 v[66:81], v[156:159], v[102:105], v[66:81]
    s_add_u32 s35, s35, s42
    buffer_load_dwordx4 v[126:129], v138, s[24:27], s35 offen sc1
    s_waitcnt vmcnt(12)
    s_waitcnt lgkmcnt(2)
    v_mfma_f32_32x32x16_bf16 v[2:17], v[160:163], v[106:109], v[2:17]
    s_waitcnt vmcnt(10)
    ds_read_b64_tr_b16 v[156:157], v140 offset:4096
    ds_read_b64_tr_b16 v[158:159], v140 offset:5120
    s_add_u32 m0, s66, 0
    s_cmp_ge_u32 s47, 11
    s_cselect_b32 s34, 552960, 0
    s_sub_u32 s34, s43, s34
    s_add_u32 s34, s34, 327680
    buffer_load_dwordx4 v144, s[48:51], s34 offen offset:0 lds
    buffer_load_dwordx4 v145, s[48:51], s34 offen offset:1024 lds
    v_mfma_f32_32x32x16_bf16 v[50:65], v[160:163], v[110:113], v[50:65]
    s_cmp_ge_u32 s47, 11
    s_cselect_b32 s35, 27648, 0
    s_sub_u32 s35, s41, s35
    s_add_u32 s35, s35, 16384
    buffer_load_dwordx4 v[98:101], v138, s[24:27], s35 offen sc1
    s_waitcnt lgkmcnt(2)
    v_mfma_f32_32x32x16_bf16 v[18:33], v[152:155], v[106:109], v[18:33]
    ds_read_b64_tr_b16 v[160:161], v141 offset:4096
    ds_read_b64_tr_b16 v[162:163], v141 offset:5120
    s_add_u32 s35, s35, s42
    buffer_load_dwordx4 v[102:105], v138, s[24:27], s35 offen sc1
    v_mfma_f32_32x32x16_bf16 v[66:81], v[152:155], v[110:113], v[66:81]
    s_barrier
    s_waitcnt vmcnt(12)
    s_waitcnt lgkmcnt(2)
    v_mfma_f32_32x32x16_bf16 v[2:17], v[156:159], v[114:117], v[2:17]
    s_waitcnt vmcnt(6)
    ds_read_b64_tr_b16 v[152:153], v140 offset:6144
    ds_read_b64_tr_b16 v[154:155], v140 offset:7168
    s_add_u32 m0, s45, 15360
    s_add_u32 s34, s40, 112640
    s_mov_b64 exec, s[60:61]
    buffer_load_dwordx4 v138, s[24:27], s34 offen offset:0 sc1 lds
    buffer_load_dwordx4 v138, s[24:27], s34 offen offset:640 sc1 lds
    s_add_u32 m0, s46, 15744
    s_add_u32 s34, s34, 5120
    buffer_load_dwordx4 v138, s[24:27], s34 offen offset:0 sc1 lds
    s_sub_u32 s34, s34, 16
    buffer_load_dwordx4 v138, s[24:27], s34 offen offset:656 sc1 lds
    s_mov_b64 exec, -1
    v_mfma_f32_32x32x16_bf16 v[50:65], v[156:159], v[118:121], v[50:65]
    s_add_u32 m0, s66, 14336
    s_add_u32 s34, s68, 51200
    buffer_load_dwordx4 v144, s[52:55], s34 offen offset:0 lds
    buffer_load_dwordx4 v145, s[52:55], s34 offen offset:1024 lds
    s_waitcnt lgkmcnt(2)
    v_mfma_f32_32x32x16_bf16 v[18:33], v[160:163], v[114:117], v[18:33]
    ds_read_b64_tr_b16 v[156:157], v141 offset:6144
    ds_read_b64_tr_b16 v[158:159], v141 offset:7168
    s_add_u32 m0, s66, 2048
    s_cmp_ge_u32 s47, 10
    s_cselect_b32 s34, 552960, 0
    s_sub_u32 s34, s43, s34
    s_add_u32 s34, s34, 348160
    buffer_load_dwordx4 v144, s[48:51], s34 offen offset:0 lds
    buffer_load_dwordx4 v145, s[48:51], s34 offen offset:1024 lds
    v_mfma_f32_32x32x16_bf16 v[66:81], v[160:163], v[118:121], v[66:81]
    s_cmp_ge_u32 s47, 10
    s_cselect_b32 s35, 27648, 0
    s_sub_u32 s35, s41, s35
    s_add_u32 s35, s35, 17408
    buffer_load_dwordx4 v[106:109], v138, s[24:27], s35 offen sc1
    s_waitcnt vmcnt(13)
    s_waitcnt lgkmcnt(2)
    v_mfma_f32_32x32x16_bf16 v[2:17], v[152:155], v[122:125], v[2:17]
    s_waitcnt vmcnt(11)
    ds_read_b64_tr_b16 v[160:161], v140 offset:0
    ds_read_b64_tr_b16 v[162:163], v140 offset:1024
    s_add_u32 s35, s35, s42
    buffer_load_dwordx4 v[110:113], v138, s[24:27], s35 offen sc1
    s_add_u32 m0, s66, 4096
    s_cmp_ge_u32 s47, 9
    s_cselect_b32 s34, 552960, 0
    s_sub_u32 s34, s43, s34
    s_add_u32 s34, s34, 368640
    buffer_load_dwordx4 v144, s[48:51], s34 offen offset:0 lds
    v_mfma_f32_32x32x16_bf16 v[50:65], v[152:155], v[126:129], v[50:65]
    buffer_load_dwordx4 v145, s[48:51], s34 offen offset:1024 lds
    s_waitcnt lgkmcnt(2)
    v_mfma_f32_32x32x16_bf16 v[18:33], v[156:159], v[122:125], v[18:33]
    ds_read_b64_tr_b16 v[152:153], v141 offset:0
    ds_read_b64_tr_b16 v[154:155], v141 offset:1024
    s_cmp_ge_u32 s47, 9
    s_cselect_b32 s35, 27648, 0
    s_sub_u32 s35, s41, s35
    s_add_u32 s35, s35, 18432
    buffer_load_dwordx4 v[114:117], v138, s[24:27], s35 offen sc1
    v_mfma_f32_32x32x16_bf16 v[66:81], v[156:159], v[126:129], v[66:81]
    s_add_u32 s35, s35, s42
    buffer_load_dwordx4 v[118:121], v138, s[24:27], s35 offen sc1
    s_waitcnt vmcnt(14)
    s_waitcnt lgkmcnt(2)
    v_mfma_f32_32x32x16_bf16 v[2:17], v[160:163], v[98:101], v[2:17]
    s_waitcnt vmcnt(6)
    ds_read_b64_tr_b16 v[156:157], v140 offset:2048
    ds_read_b64_tr_b16 v[158:159], v140 offset:3072
    s_add_u32 m0, s66, 6144
    s_cmp_ge_u32 s47, 8
    s_cselect_b32 s34, 552960, 0
    s_sub_u32 s34, s43, s34
    s_add_u32 s34, s34, 389120
    buffer_load_dwordx4 v144, s[48:51], s34 offen offset:0 lds
    buffer_load_dwordx4 v145, s[48:51], s34 offen offset:1024 lds
    v_mfma_f32_32x32x16_bf16 v[50:65], v[160:163], v[102:105], v[50:65]
    s_cmp_ge_u32 s47, 8
    s_cselect_b32 s35, 27648, 0
    s_sub_u32 s35, s41, s35
    s_add_u32 s35, s35, 19456
    buffer_load_dwordx4 v[122:125], v138, s[24:27], s35 offen sc1
    s_waitcnt lgkmcnt(2)
    v_mfma_f32_32x32x16_bf16 v[18:33], v[152:155], v[98:101], v[18:33]
    ds_read_b64_tr_b16 v[160:161], v141 offset:2048
    ds_read_b64_tr_b16 v[162:163], v141 offset:3072
    s_add_u32 s35, s35, s42
    buffer_load_dwordx4 v[126:129], v138, s[24:27], s35 offen sc1
    v_mfma_f32_32x32x16_bf16 v[66:81], v[152:155], v[102:105], v[66:81]
    s_barrier
    s_waitcnt vmcnt(8)
    s_waitcnt lgkmcnt(2)
    v_mfma_f32_32x32x16_bf16 v[2:17], v[156:159], v[106:109], v[2:17]
    s_waitcnt vmcnt(6)
    ds_read_b64_tr_b16 v[152:153], v140 offset:4096
    ds_read_b64_tr_b16 v[154:155], v140 offset:5120
    s_add_u32 m0, s45, 0
    s_add_u32 s34, s40, 122880
    s_mov_b64 exec, s[60:61]
    buffer_load_dwordx4 v138, s[24:27], s34 offen offset:0 sc1 lds
    buffer_load_dwordx4 v138, s[24:27], s34 offen offset:640 sc1 lds
    s_add_u32 m0, s46, 0
    s_add_u32 s34, s34, 5120
    buffer_load_dwordx4 v138, s[24:27], s34 offen offset:0 sc1 lds
    s_mov_b64 exec, -1
    v_mfma_f32_32x32x16_bf16 v[50:65], v[156:159], v[110:113], v[50:65]
    s_sub_u32 s34, s34, 16
    s_mov_b64 exec, s[60:61]
    buffer_load_dwordx4 v138, s[24:27], s34 offen offset:656 sc1 lds
    s_add_u32 m0, s66, 0
    s_cmp_ge_u32 s47, 7
    s_cselect_b32 s34, 552960, 0
    s_sub_u32 s34, s43, s34
    s_add_u32 s34, s34, 409600
    s_mov_b64 exec, -1
    buffer_load_dwordx4 v144, s[48:51], s34 offen offset:0 lds
    s_waitcnt lgkmcnt(2)
    v_mfma_f32_32x32x16_bf16 v[18:33], v[160:163], v[106:109], v[18:33]
    ds_read_b64_tr_b16 v[156:157], v141 offset:4096
    ds_read_b64_tr_b16 v[158:159], v141 offset:5120
    buffer_load_dwordx4 v145, s[48:51], s34 offen offset:1024 lds
    v_mfma_f32_32x32x16_bf16 v[66:81], v[160:163], v[110:113], v[66:81]
    s_cmp_ge_u32 s47, 7
    s_cselect_b32 s35, 27648, 0
    s_sub_u32 s35, s41, s35
    s_add_u32 s35, s35, 20480
    buffer_load_dwordx4 v[98:101], v138, s[24:27], s35 offen sc1
    s_waitcnt vmcnt(11)
    s_waitcnt lgkmcnt(2)
    v_mfma_f32_32x32x16_bf16 v[2:17], v[152:155], v[114:117], v[2:17]
    s_waitcnt vmcnt(9)
    ds_read_b64_tr_b16 v[160:161], v140 offset:6144
    ds_read_b64_tr_b16 v[162:163], v140 offset:7168
    s_add_u32 s35, s35, s42
    buffer_load_dwordx4 v[102:105], v138, s[24:27], s35 offen sc1
    s_add_u32 m0, s66, 2048
    s_cmp_ge_u32 s47, 6
    s_cselect_b32 s34, 552960, 0
    s_sub_u32 s34, s43, s34
    s_add_u32 s34, s34, 430080
    buffer_load_dwordx4 v144, s[48:51], s34 offen offset:0 lds
    v_mfma_f32_32x32x16_bf16 v[50:65], v[152:155], v[118:121], v[50:65]
    buffer_load_dwordx4 v145, s[48:51], s34 offen offset:1024 lds
    s_waitcnt lgkmcnt(2)
    v_mfma_f32_32x32x16_bf16 v[18:33], v[156:159], v[114:117], v[18:33]
    ds_read_b64_tr_b16 v[152:153], v141 offset:6144
    ds_read_b64_tr_b16 v[154:155], v141 offset:7168
    s_cmp_ge_u32 s47, 6
    s_cselect_b32 s35, 27648, 0
    s_sub_u32 s35, s41, s35
    s_add_u32 s35, s35, 21504
    buffer_load_dwordx4 v[106:109], v138, s[24:27], s35 offen sc1
    v_mfma_f32_32x32x16_bf16 v[66:81], v[156:159], v[118:121], v[66:81]
    s_add_u32 s35, s35, s42
    buffer_load_dwordx4 v[110:113], v138, s[24:27], s35 offen sc1
    s_waitcnt vmcnt(12)
    s_waitcnt lgkmcnt(2)
    v_mfma_f32_32x32x16_bf16 v[2:17], v[160:163], v[122:125], v[2:17]
    s_waitcnt vmcnt(6)
    ds_read_b64_tr_b16 v[156:157], v140 offset:0
    ds_read_b64_tr_b16 v[158:159], v140 offset:1024
    s_add_u32 m0, s66, 4096
    s_cmp_ge_u32 s47, 5
    s_cselect_b32 s34, 552960, 0
    s_sub_u32 s34, s43, s34
    s_add_u32 s34, s34, 450560
    buffer_load_dwordx4 v144, s[48:51], s34 offen offset:0 lds
    buffer_load_dwordx4 v145, s[48:51], s34 offen offset:1024 lds
    v_mfma_f32_32x32x16_bf16 v[50:65], v[160:163], v[126:129], v[50:65]
    s_cmp_ge_u32 s47, 5
    s_cselect_b32 s35, 27648, 0
    s_sub_u32 s35, s41, s35
    s_add_u32 s35, s35, 22528
    buffer_load_dwordx4 v[114:117], v138, s[24:27], s35 offen sc1
    s_barrier
    s_waitcnt lgkmcnt(2)
    v_mfma_f32_32x32x16_bf16 v[18:33], v[152:155], v[122:125], v[18:33]
    ds_read_b64_tr_b16 v[160:161], v141 offset:0
    ds_read_b64_tr_b16 v[162:163], v141 offset:1024
    s_add_u32 s35, s35, s42
    buffer_load_dwordx4 v[118:121], v138, s[24:27], s35 offen sc1
    s_add_u32 m0, s45, 5120
    s_add_u32 s34, s40, 133120
    s_mov_b64 exec, s[60:61]
    buffer_load_dwordx4 v138, s[24:27], s34 offen offset:0 sc1 lds
    s_mov_b64 exec, -1
    v_mfma_f32_32x32x16_bf16 v[66:81], v[152:155], v[126:129], v[66:81]
    s_mov_b64 exec, s[60:61]
    buffer_load_dwordx4 v138, s[24:27], s34 offen offset:640 sc1 lds
    s_mov_b64 exec, -1
    s_waitcnt vmcnt(10)
    s_waitcnt lgkmcnt(2)
    v_mfma_f32_32x32x16_bf16 v[2:17], v[156:159], v[98:101], v[2:17]
    s_waitcnt vmcnt(8)
    ds_read_b64_tr_b16 v[152:153], v140 offset:2048
    ds_read_b64_tr_b16 v[154:155], v140 offset:3072
    s_add_u32 m0, s46, 5248
    s_add_u32 s34, s34, 5120
    s_mov_b64 exec, s[60:61]
    buffer_load_dwordx4 v138, s[24:27], s34 offen offset:0 sc1 lds
    s_sub_u32 s34, s34, 16
    buffer_load_dwordx4 v138, s[24:27], s34 offen offset:656 sc1 lds
    s_mov_b64 exec, -1
    v_mfma_f32_32x32x16_bf16 v[50:65], v[156:159], v[102:105], v[50:65]
    s_add_u32 m0, s66, 6144
    s_cmp_ge_u32 s47, 4
    s_cselect_b32 s34, 552960, 0
    s_sub_u32 s34, s43, s34
    s_add_u32 s34, s34, 471040
    buffer_load_dwordx4 v144, s[48:51], s34 offen offset:0 lds
    buffer_load_dwordx4 v145, s[48:51], s34 offen offset:1024 lds
    s_waitcnt lgkmcnt(2)
    v_mfma_f32_32x32x16_bf16 v[18:33], v[160:163], v[98:101], v[18:33]
    ds_read_b64_tr_b16 v[156:157], v141 offset:2048
    ds_read_b64_tr_b16 v[158:159], v141 offset:3072
    s_cmp_ge_u32 s47, 4
    s_cselect_b32 s35, 27648, 0
    s_sub_u32 s35, s41, s35
    s_add_u32 s35, s35, 23552
    buffer_load_dwordx4 v[122:125], v138, s[24:27], s35 offen sc1
    v_mfma_f32_32x32x16_bf16 v[66:81], v[160:163], v[102:105], v[66:81]
    s_add_u32 s35, s35, s42
    buffer_load_dwordx4 v[126:129], v138, s[24:27], s35 offen sc1
    s_waitcnt vmcnt(12)
    s_waitcnt lgkmcnt(2)
    v_mfma_f32_32x32x16_bf16 v[2:17], v[152:155], v[106:109], v[2:17]
    s_waitcnt vmcnt(10)
    ds_read_b64_tr_b16 v[160:161], v140 offset:4096
    ds_read_b64_tr_b16 v[162:163], v140 offset:5120
    s_add_u32 m0, s66, 0
    s_cmp_ge_u32 s47, 3
    s_cselect_b32 s34, 552960, 0
    s_sub_u32 s34, s43, s34
    s_add_u32 s34, s34, 491520
    buffer_load_dwordx4 v144, s[48:51], s34 offen offset:0 lds
    buffer_load_dwordx4 v145, s[48:51], s34 offen offset:1024 lds
    v_mfma_f32_32x32x16_bf16 v[50:65], v[152:155], v[110:113], v[50:65]
    s_cmp_ge_u32 s47, 3
    s_cselect_b32 s35, 27648, 0
    s_sub_u32 s35, s41, s35
    s_add_u32 s35, s35, 24576
    buffer_load_dwordx4 v[98:101], v138, s[24:27], s35 offen sc1
    s_waitcnt lgkmcnt(2)
    v_mfma_f32_32x32x16_bf16 v[18:33], v[156:159], v[106:109], v[18:33]
    ds_read_b64_tr_b16 v[152:153], v141 offset:4096
    ds_read_b64_tr_b16 v[154:155], v141 offset:5120
    s_add_u32 s35, s35, s42
    buffer_load_dwordx4 v[102:105], v138, s[24:27], s35 offen sc1
    v_mfma_f32_32x32x16_bf16 v[66:81], v[156:159], v[110:113], v[66:81]
    s_waitcnt vmcnt(12)
    s_waitcnt lgkmcnt(2)
    v_mfma_f32_32x32x16_bf16 v[2:17], v[160:163], v[114:117], v[2:17]
    s_waitcnt vmcnt(6)
    ds_read_b64_tr_b16 v[156:157], v140 offset:6144
    ds_read_b64_tr_b16 v[158:159], v140 offset:7168
    s_add_u32 m0, s66, 2048
    s_cmp_ge_u32 s47, 2
    s_cselect_b32 s34, 552960, 0
    s_sub_u32 s34, s43, s34
    s_add_u32 s34, s34, 512000
    buffer_load_dwordx4 v144, s[48:51], s34 offen offset:0 lds
    buffer_load_dwordx4 v145, s[48:51], s34 offen offset:1024 lds
    v_mfma_f32_32x32x16_bf16 v[50:65], v[160:163], v[118:121], v[50:65]
    s_cmp_ge_u32 s47, 2
    s_cselect_b32 s35, 27648, 0
    s_sub_u32 s35, s41, s35
    s_add_u32 s35, s35, 25600
    buffer_load_dwordx4 v[106:109], v138, s[24:27], s35 offen sc1
    s_barrier
    s_waitcnt lgkmcnt(2)
    v_mfma_f32_32x32x16_bf16 v[18:33], v[152:155], v[114:117], v[18:33]
    ds_read_b64_tr_b16 v[160:161], v141 offset:6144
    ds_read_b64_tr_b16 v[162:163], v141 offset:7168
    s_add_u32 s35, s35, s42
    buffer_load_dwordx4 v[110:113], v138, s[24:27], s35 offen sc1
    s_add_u32 m0, s45, 10240
    s_add_u32 s34, s40, 143360
    s_mov_b64 exec, s[60:61]
    buffer_load_dwordx4 v138, s[24:27], s34 offen offset:0 sc1 lds
    buffer_load_dwordx4 v138, s[24:27], s34 offen offset:640 sc1 lds
    s_mov_b64 exec, -1
    v_mfma_f32_32x32x16_bf16 v[66:81], v[152:155], v[118:121], v[66:81]
    s_add_u32 m0, s46, 10496
    s_add_u32 s34, s34, 5120
    s_mov_b64 exec, s[60:61]
    buffer_load_dwordx4 v138, s[24:27], s34 offen offset:0 sc1 lds
    s_sub_u32 s34, s34, 16
    buffer_load_dwordx4 v138, s[24:27], s34 offen offset:656 sc1 lds
    s_mov_b64 exec, -1
    s_waitcnt vmcnt(12)
    s_waitcnt lgkmcnt(2)
    v_mfma_f32_32x32x16_bf16 v[2:17], v[156:159], v[122:125], v[2:17]
    s_waitcnt vmcnt(10)
    ds_read_b64_tr_b16 v[152:153], v140 offset:0
    ds_read_b64_tr_b16 v[154:155], v140 offset:1024
    s_add_u32 m0, s66, 16384
    s_add_u32 s34, s68, 76800
    buffer_load_dwordx4 v144, s[52:55], s34 offen offset:0 lds
    buffer_load_dwordx4 v145, s[52:55], s34 offen offset:1024 lds
    v_mfma_f32_32x32x16_bf16 v[50:65], v[156:159], v[126:129], v[50:65]
    s_add_u32 m0, s66, 4096
    s_cmp_ge_u32 s47, 1
    s_cselect_b32 s34, 552960, 0
    s_sub_u32 s34, s43, s34
    s_add_u32 s34, s34, 532480
    buffer_load_dwordx4 v144, s[48:51], s34 offen offset:0 lds
    buffer_load_dwordx4 v145, s[48:51], s34 offen offset:1024 lds
    s_waitcnt lgkmcnt(2)
    v_mfma_f32_32x32x16_bf16 v[18:33], v[160:163], v[122:125], v[18:33]
    ds_read_b64_tr_b16 v[156:157], v141 offset:0
    ds_read_b64_tr_b16 v[158:159], v141 offset:1024
    s_cmp_ge_u32 s47, 1
    s_cselect_b32 s35, 27648, 0
    s_sub_u32 s35, s41, s35
    s_add_u32 s35, s35, 26624
    buffer_load_dwordx4 v[114:117], v138, s[24:27], s35 offen sc1
    v_mfma_f32_32x32x16_bf16 v[66:81], v[160:163], v[126:129], v[66:81]
    s_add_u32 s35, s35, s42
    buffer_load_dwordx4 v[118:121], v138, s[24:27], s35 offen sc1
    s_waitcnt vmcnt(14)
    s_waitcnt lgkmcnt(2)
    v_mfma_f32_32x32x16_bf16 v[2:17], v[152:155], v[98:101], v[2:17]
    s_waitcnt vmcnt(12)
    ds_read_b64_tr_b16 v[160:161], v140 offset:2048
    ds_read_b64_tr_b16 v[162:163], v140 offset:3072
    v_mfma_f32_32x32x16_bf16 v[50:65], v[152:155], v[102:105], v[50:65]
    s_waitcnt lgkmcnt(2)
    v_mfma_f32_32x32x16_bf16 v[18:33], v[156:159], v[98:101], v[18:33]
    ds_read_b64_tr_b16 v[152:153], v141 offset:2048
    ds_read_b64_tr_b16 v[154:155], v141 offset:3072
    v_mfma_f32_32x32x16_bf16 v[66:81], v[156:159], v[102:105], v[66:81]
    s_barrier
    s_waitcnt vmcnt(10)
    s_waitcnt lgkmcnt(2)
    v_mfma_f32_32x32x16_bf16 v[2:17], v[160:163], v[106:109], v[2:17]
    s_waitcnt vmcnt(2)
    ds_read_b64_tr_b16 v[156:157], v140 offset:4096
    ds_read_b64_tr_b16 v[158:159], v140 offset:5120
    s_add_u32 m0, s45, 15360
    s_add_u32 s34, s40, 153600
    s_mov_b64 exec, s[60:61]
    buffer_load_dwordx4 v138, s[24:27], s34 offen offset:0 sc1 lds
    buffer_load_dwordx4 v138, s[24:27], s34 offen offset:640 sc1 lds
    s_mov_b64 exec, -1
    v_mfma_f32_32x32x16_bf16 v[50:65], v[160:163], v[110:113], v[50:65]
    s_add_u32 m0, s46, 15744
    s_add_u32 s34, s34, 5120
    s_mov_b64 exec, s[60:61]
    buffer_load_dwordx4 v138, s[24:27], s34 offen offset:0 sc1 lds
    s_mov_b64 exec, -1
    s_waitcnt lgkmcnt(2)
    v_mfma_f32_32x32x16_bf16 v[18:33], v[152:155], v[106:109], v[18:33]
    ds_read_b64_tr_b16 v[160:161], v141 offset:4096
    ds_read_b64_tr_b16 v[162:163], v141 offset:5120
    s_sub_u32 s34, s34, 16
    s_mov_b64 exec, s[60:61]
    buffer_load_dwordx4 v138, s[24:27], s34 offen offset:656 sc1 lds
    s_mov_b64 exec, -1
    v_mfma_f32_32x32x16_bf16 v[66:81], v[152:155], v[110:113], v[66:81]
    s_waitcnt vmcnt(4)
    s_waitcnt lgkmcnt(2)
    v_mfma_f32_32x32x16_bf16 v[2:17], v[156:159], v[114:117], v[2:17]
    v_mfma_f32_32x32x16_bf16 v[50:65], v[156:159], v[118:121], v[50:65]
    s_waitcnt lgkmcnt(0)
    v_mfma_f32_32x32x16_bf16 v[18:33], v[160:163], v[114:117], v[18:33]
    v_mfma_f32_32x32x16_bf16 v[66:81], v[160:163], v[118:121], v[66:81]
    s_nop 7
    s_nop 3
    ds_write_b128 v132, v[50:53] offset:0
    ds_write_b128 v132, v[54:57] offset:1024
    ds_write_b128 v132, v[58:61] offset:2048
    ds_write_b128 v132, v[62:65] offset:3072
    ds_write_b128 v132, v[66:69] offset:4096
    ds_write_b128 v132, v[70:73] offset:5120
    ds_write_b128 v132, v[74:77] offset:6144
    ds_write_b128 v132, v[78:81] offset:7168
    s_waitcnt lgkmcnt(0)
    s_barrier
    ds_read_b128 v[50:53], v133 offset:0
    ds_read_b128 v[54:57], v133 offset:1024
    ds_read_b128 v[58:61], v133 offset:2048
    ds_read_b128 v[62:65], v133 offset:3072
    ds_read_b128 v[66:69], v133 offset:4096
    ds_read_b128 v[70:73], v133 offset:5120
    ds_read_b128 v[74:77], v133 offset:6144
    ds_read_b128 v[78:81], v133 offset:7168
    ds_read_b128 v[98:101], v143 offset:0
    ds_read_b128 v[102:105], v143 offset:32
    ds_read_b128 v[106:109], v134 offset:0
    ds_read_b128 v[110:113], v134 offset:32
    s_add_u32 m0, s66, 18432
    s_add_u32 s34, s68, 0
    buffer_load_dwordx4 v148, s[52:55], s34 offen offset:0 lds
    buffer_load_dwordx4 v149, s[52:55], s34 offen offset:1024 lds
    s_waitcnt lgkmcnt(0)
    s_waitcnt vmcnt(2)
    s_barrier
    s_add_u32 m0, s66, 0
    s_add_u32 s34, s44, 0
    buffer_load_dwordx4 v144, s[52:55], s34 offen offset:0 lds
    buffer_load_dwordx4 v145, s[52:55], s34 offen offset:1024 lds
    s_add_u32 m0, s66, 2048
    s_add_u32 s34, s44, 25600
    buffer_load_dwordx4 v144, s[52:55], s34 offen offset:0 lds
    buffer_load_dwordx4 v145, s[52:55], s34 offen offset:1024 lds
    s_add_u32 m0, s66, 4096
    s_add_u32 s34, s44, 51200
    buffer_load_dwordx4 v144, s[52:55], s34 offen offset:0 lds
    buffer_load_dwordx4 v145, s[52:55], s34 offen offset:1024 lds
    s_add_u32 m0, s66, 6144
    s_add_u32 s34, s44, 76800
    buffer_load_dwordx4 v144, s[52:55], s34 offen offset:0 lds
    buffer_load_dwordx4 v145, s[52:55], s34 offen offset:1024 lds
    s_waitcnt lgkmcnt(0)
    s_barrier
    s_mov_b32 s48, s20
    s_mov_b32 s49, s21
    s_mov_b32 s50, 2621440
    s_mov_b32 s51, 0x00020000
    s_mul_i32 s41, s64, 40960
    s_add_u32 s41, s41, 14942208
    s_lshl_b32 s34, s63, 12
    s_add_u32 s42, s41, s34
    s_add_u32 s42, s42, 32768
    s_lshl_b32 s34, s63, 14
    s_add_u32 s41, s41, s34
    s_lshl_b32 s37, s64, 12
    s_lshl_b32 s34, s63, 9
    s_add_u32 s37, s37, s34
    s_add_u32 s37, s37, 17825792
    s_mov_b32 s36, 1048576
    s_xor_b32 s34, s69, 0
    s_lshl_b32 s34, s34, 10
    s_add_u32 s56, s42, s34
    s_lshl2_add_u32 s52, s34, s41
    s_xor_b32 s34, s69, 1
    s_lshl_b32 s34, s34, 10
    s_add_u32 s57, s42, s34
    s_lshl2_add_u32 s53, s34, s41
    s_xor_b32 s34, s69, 2
    s_lshl_b32 s34, s34, 10
    s_add_u32 s58, s42, s34
    s_lshl2_add_u32 s54, s34, s41
    s_xor_b32 s34, s69, 3
    s_lshl_b32 s34, s34, 10
    s_add_u32 s59, s42, s34
    s_lshl2_add_u32 s55, s34, s41
    s_add_u32 s67, s65, 40960
    s_mul_i32 s43, s62, 20480
    s_mul_i32 s44, s38, 10240
    s_add_u32 s44, s44, 122880
    s_xor_b32 s45, s38, 2
    s_mul_i32 s45, s45, 10240
    s_add_u32 s45, s45, 122880
    s_lshl_b32 s34, s3, 10
    s_lshl4_add_u32 s34, s62, s34
    s_add_u32 s34, s34, 17563648
L_rs2:
    s_waitcnt vmcnt(0)
    v_cmp_ne_u32 vcc, s33, v165
    s_cbranch_vccz L_rsx2
    s_sub_u32 s36, s36, 1
    s_cbranch_scc1 L_rsx2
    buffer_load_dwordx2 v[164:165], v167, s[24:27], s34 offen offset:8 sc1
    s_branch L_rs2
L_rsx2:
    s_mov_b32 s36, 1048576
    s_barrier
    v_bfe_u32 v1, v0, 2, 2
    v_lshlrev_b32 v1, 7, v1
    v_and_b32 v130, 3, v0
    v_lshl_add_u32 v1, v130, 2, v1
    buffer_load_dword v130, v1, s[24:27], s37 offen sc1
    v_subrev_u32 v140, s43, v140
    v_subrev_u32 v141, s43, v141
    v_add_u32 v132, s44, v138
    v_add_u32 v133, s45, v138
    v_mul_f32 v164, v164, v164
    v_pk_add_f32 v[2:3], v[2:3], v[50:51]
    v_lshlrev_b32 v165, 16, v98
    v_and_b32 v166, 0xffff0000, v98
    v_fma_f32 v2, v2, v164, v165
    v_fma_f32 v3, v3, v164, v166
    v_pk_add_f32 v[4:5], v[4:5], v[52:53]
    v_lshlrev_b32 v165, 16, v99
    v_and_b32 v166, 0xffff0000, v99
    v_fma_f32 v4, v4, v164, v165
    v_fma_f32 v5, v5, v164, v166
    v_pk_add_f32 v[6:7], v[6:7], v[54:55]
    v_lshlrev_b32 v165, 16, v100
    v_and_b32 v166, 0xffff0000, v100
    v_fma_f32 v6, v6, v164, v165
    v_fma_f32 v7, v7, v164, v166
    v_pk_add_f32 v[8:9], v[8:9], v[56:57]
    v_lshlrev_b32 v165, 16, v101
    v_and_b32 v166, 0xffff0000, v101
    v_fma_f32 v8, v8, v164, v165
    v_fma_f32 v9, v9, v164, v166
    v_pk_add_f32 v[10:11], v[10:11], v[58:59]
    v_lshlrev_b32 v165, 16, v102
    v_and_b32 v166, 0xffff0000, v102
    v_fma_f32 v10, v10, v164, v165
    v_fma_f32 v11, v11, v164, v166
    v_pk_add_f32 v[12:13], v[12:13], v[60:61]
    v_lshlrev_b32 v165, 16, v103
    v_and_b32 v166, 0xffff0000, v103
    v_fma_f32 v12, v12, v164, v165
    v_fma_f32 v13, v13, v164, v166
    v_pk_add_f32 v[14:15], v[14:15], v[62:63]
    v_lshlrev_b32 v165, 16, v104
    v_and_b32 v166, 0xffff0000, v104
    v_fma_f32 v14, v14, v164, v165
    v_fma_f32 v15, v15, v164, v166
    v_pk_add_f32 v[16:17], v[16:17], v[64:65]
    v_lshlrev_b32 v165, 16, v105
    v_and_b32 v166, 0xffff0000, v105
    v_fma_f32 v16, v16, v164, v165
    v_fma_f32 v17, v17, v164, v166
    v_pk_add_f32 v[18:19], v[18:19], v[66:67]
    v_lshlrev_b32 v165, 16, v106
    v_and_b32 v166, 0xffff0000, v106
    v_fma_f32 v18, v18, v164, v165
    v_fma_f32 v19, v19, v164, v166
    v_pk_add_f32 v[20:21], v[20:21], v[68:69]
    v_lshlrev_b32 v165, 16, v107
    v_and_b32 v166, 0xffff0000, v107
    v_fma_f32 v20, v20, v164, v165
    v_fma_f32 v21, v21, v164, v166
    v_pk_add_f32 v[22:23], v[22:23], v[70:71]
    v_lshlrev_b32 v165, 16, v108
    v_and_b32 v166, 0xffff0000, v108
    v_fma_f32 v22, v22, v164, v165
    v_fma_f32 v23, v23, v164, v166
    v_pk_add_f32 v[24:25], v[24:25], v[72:73]
    v_lshlrev_b32 v165, 16, v109
    v_and_b32 v166, 0xffff0000, v109
    v_fma_f32 v24, v24, v164, v165
    v_fma_f32 v25, v25, v164, v166
    v_pk_add_f32 v[26:27], v[26:27], v[74:75]
    v_lshlrev_b32 v165, 16, v110
    v_and_b32 v166, 0xffff0000, v110
    v_fma_f32 v26, v26, v164, v165
    v_fma_f32 v27, v27, v164, v166
    v_pk_add_f32 v[28:29], v[28:29], v[76:77]
    v_lshlrev_b32 v165, 16, v111
    v_and_b32 v166, 0xffff0000, v111
    v_fma_f32 v28, v28, v164, v165
    v_fma_f32 v29, v29, v164, v166
    v_pk_add_f32 v[30:31], v[30:31], v[78:79]
    v_lshlrev_b32 v165, 16, v112
    v_and_b32 v166, 0xffff0000, v112
    v_fma_f32 v30, v30, v164, v165
    v_fma_f32 v31, v31, v164, v166
    v_pk_add_f32 v[32:33], v[32:33], v[80:81]
    v_lshlrev_b32 v165, 16, v113
    v_and_b32 v166, 0xffff0000, v113
    v_fma_f32 v32, v32, v164, v165
    v_fma_f32 v33, v33, v164, v166
    s_cmp_eq_u32 s63, 0
    s_cbranch_scc0 L_hi2
L_lo2:
    ds_read_b64_tr_b16 v[152:153], v141 offset:0
    ds_read_b64_tr_b16 v[154:155], v141 offset:1024
    ds_read_b64_tr_b16 v[156:157], v140 offset:0
    ds_read_b64_tr_b16 v[158:159], v140 offset:1024
    ds_read_b64_tr_b16 v[160:161], v141 offset:2048
    ds_read_b64_tr_b16 v[162:163], v141 offset:3072
L_palo2:
    s_waitcnt vmcnt(0)
    v_cmp_ne_u32 vcc, s33, v130
    s_nop 1
    s_and_b32 s34, vcc_lo, 0xffff
    s_cbranch_scc0 L_galo2
    s_sub_u32 s36, s36, 1
    s_cbranch_scc1 L_galo2
    buffer_load_dword v130, v1, s[24:27], s37 offen sc1
    s_branch L_palo2
L_galo2:
    buffer_load_dwordx4 v[50:53], v138, s[24:27], s52 offen offset:0 sc1
    buffer_load_dwordx4 v[54:57], v138, s[24:27], s52 offen offset:1024 sc1
    buffer_load_dwordx4 v[58:61], v138, s[24:27], s52 offen offset:2048 sc1
    buffer_load_dwordx4 v[62:65], v138, s[24:27], s52 offen offset:3072 sc1
    buffer_load_dwordx2 v[66:67], v139, s[24:27], s56 offen sc1
    buffer_load_dwordx2 v[68:69], v139, s[24:27], s56 offen offset:512 sc1
    buffer_load_dwordx4 v[70:73], v138, s[24:27], s53 offen offset:0 sc1
    buffer_load_dwordx4 v[74:77], v138, s[24:27], s53 offen offset:1024 sc1
    buffer_load_dwordx4 v[78:81], v138, s[24:27], s53 offen offset:2048 sc1
    s_waitcnt vmcnt(8)
    s_waitcnt lgkmcnt(4)
    v_mfma_f32_32x32x16_bf16 v[18:33], v[152:155], v[50:53], v[18:33]
    ds_read_b64_tr_b16 v[152:153], v140 offset:2048
    ds_read_b64_tr_b16 v[154:155], v140 offset:3072
    buffer_load_dwordx4 v[82:85], v138, s[24:27], s53 offen offset:3072 sc1
    s_waitcnt lgkmcnt(4)
    v_mfma_f32_32x32x16_bf16 v[2:17], v[156:159], v[50:53], v[2:17]
    ds_read_b64_tr_b16 v[156:157], v141 offset:4096
    ds_read_b64_tr_b16 v[158:159], v141 offset:5120
    buffer_load_dwordx2 v[86:87], v139, s[24:27], s57 offen sc1
    buffer_load_dwordx2 v[88:89], v139, s[24:27], s57 offen offset:512 sc1
    s_waitcnt vmcnt(10)
    s_waitcnt lgkmcnt(4)
    v_mfma_f32_32x32x16_bf16 v[18:33], v[160:163], v[54:57], v[18:33]
    ds_read_b64_tr_b16 v[160:161], v140 offset:4096
    ds_read_b64_tr_b16 v[162:163], v140 offset:5120
    buffer_load_dwordx4 v[90:93], v138, s[24:27], s54 offen offset:0 sc1
    s_waitcnt lgkmcnt(4)
    v_mfma_f32_32x32x16_bf16 v[2:17], v[152:155], v[54:57], v[2:17]
    ds_read_b64_tr_b16 v[152:153], v141 offset:6144
    ds_read_b64_tr_b16 v[154:155], v141 offset:7168
    buffer_load_dwordx4 v[94:97], v138, s[24:27], s54 offen offset:1024 sc1
    s_waitcnt vmcnt(11)
    s_waitcnt lgkmcnt(4)
    v_mfma_f32_32x32x16_bf16 v[18:33], v[156:159], v[58:61], v[18:33]
    ds_read_b64_tr_b16 v[156:157], v140 offset:6144
    ds_read_b64_tr_b16 v[158:159], v140 offset:7168
    buffer_load_dwordx4 v[98:101], v138, s[24:27], s54 offen offset:2048 sc1
    s_waitcnt lgkmcnt(4)
    v_mfma_f32_32x32x16_bf16 v[2:17], v[160:163], v[58:61], v[2:17]
    ds_read_b64_tr_b16 v[160:161], v141 offset:8192
    ds_read_b64_tr_b16 v[162:163], v141 offset:9216
    buffer_load_dwordx4 v[102:105], v138, s[24:27], s54 offen offset:3072 sc1
    s_waitcnt vmcnt(12)
    s_waitcnt lgkmcnt(4)
    v_mfma_f32_32x32x16_bf16 v[18:33], v[152:155], v[62:65], v[18:33]
    ds_read_b64_tr_b16 v[152:153], v140 offset:8192
    ds_read_b64_tr_b16 v[154:155], v140 offset:9216
    buffer_load_dwordx2 v[106:107], v139, s[24:27], s58 offen sc1
    buffer_load_dwordx2 v[108:109], v139, s[24:27], s58 offen offset:512 sc1
    s_waitcnt lgkmcnt(4)
    v_mfma_f32_32x32x16_bf16 v[2:17], v[156:159], v[62:65], v[2:17]
    ds_read_b64_tr_b16 v[156:157], v141 offset:10240
    ds_read_b64_tr_b16 v[158:159], v141 offset:11264
    buffer_load_dwordx4 v[110:113], v138, s[24:27], s55 offen offset:0 sc1
    s_waitcnt vmcnt(13)
    s_waitcnt lgkmcnt(4)
    v_mfma_f32_32x32x16_bf16 v[18:33], v[160:163], v[66:69], v[18:33]
    ds_read_b64_tr_b16 v[160:161], v140 offset:10240
    ds_read_b64_tr_b16 v[162:163], v140 offset:11264
    buffer_load_dwordx4 v[114:117], v138, s[24:27], s55 offen offset:1024 sc1
    s_waitcnt lgkmcnt(4)
    v_mfma_f32_32x32x16_bf16 v[2:17], v[152:155], v[66:69], v[2:17]
    ds_read_b64_tr_b16 v[152:153], v141 offset:12288
    ds_read_b64_tr_b16 v[154:155], v141 offset:13312
    buffer_load_dwordx4 v[118:121], v138, s[24:27], s55 offen offset:2048 sc1
    s_waitcnt vmcnt(14)
    s_waitcnt lgkmcnt(4)
    v_mfma_f32_32x32x16_bf16 v[18:33], v[156:159], v[70:73], v[18:33]
    ds_read_b64_tr_b16 v[156:157], v140 offset:12288
    ds_read_b64_tr_b16 v[158:159], v140 offset:13312
    buffer_load_dwordx4 v[122:125], v138, s[24:27], s55 offen offset:3072 sc1
    s_waitcnt lgkmcnt(4)
    v_mfma_f32_32x32x16_bf16 v[2:17], v[160:163], v[70:73], v[2:17]
    ds_read_b64_tr_b16 v[160:161], v141 offset:14336
    ds_read_b64_tr_b16 v[162:163], v141 offset:15360
    buffer_load_dwordx2 v[126:127], v139, s[24:27], s59 offen sc1
    buffer_load_dwordx2 v[128:129], v139, s[24:27], s59 offen offset:512 sc1
    s_waitcnt vmcnt(16)
    s_waitcnt lgkmcnt(4)
    v_mfma_f32_32x32x16_bf16 v[18:33], v[152:155], v[74:77], v[18:33]
    ds_read_b64_tr_b16 v[152:153], v140 offset:14336
    ds_read_b64_tr_b16 v[154:155], v140 offset:15360
    s_waitcnt lgkmcnt(4)
    v_mfma_f32_32x32x16_bf16 v[2:17], v[156:159], v[74:77], v[2:17]
    ds_read_b64_tr_b16 v[156:157], v141 offset:16384
    ds_read_b64_tr_b16 v[158:159], v141 offset:17408
    s_waitcnt vmcnt(15)
    s_waitcnt lgkmcnt(4)
    v_mfma_f32_32x32x16_bf16 v[18:33], v[160:163], v[78:81], v[18:33]
    ds_read_b64_tr_b16 v[160:161], v140 offset:16384
    ds_read_b64_tr_b16 v[162:163], v140 offset:17408
    s_waitcnt lgkmcnt(4)
    v_mfma_f32_32x32x16_bf16 v[2:17], v[152:155], v[78:81], v[2:17]
    ds_read_b64_tr_b16 v[152:153], v141 offset:18432
    ds_read_b64_tr_b16 v[154:155], v141 offset:19456
    s_waitcnt vmcnt(14)
    s_waitcnt lgkmcnt(4)
    v_mfma_f32_32x32x16_bf16 v[18:33], v[156:159], v[82:85], v[18:33]
    ds_read_b64_tr_b16 v[156:157], v140 offset:18432
    ds_read_b64_tr_b16 v[158:159], v140 offset:19456
    s_waitcnt lgkmcnt(4)
    v_mfma_f32_32x32x16_bf16 v[2:17], v[160:163], v[82:85], v[2:17]
    ds_read_b64_tr_b16 v[160:161], v141 offset:20480
    ds_read_b64_tr_b16 v[162:163], v141 offset:21504
    s_waitcnt vmcnt(12)
    s_waitcnt lgkmcnt(4)
    v_mfma_f32_32x32x16_bf16 v[18:33], v[152:155], v[86:89], v[18:33]
    ds_read_b64_tr_b16 v[152:153], v141 offset:22528
    ds_read_b64_tr_b16 v[154:155], v141 offset:23552
    s_waitcnt lgkmcnt(4)
    v_mfma_f32_32x32x16_bf16 v[2:17], v[156:159], v[86:89], v[2:17]
    ds_read_b64_tr_b16 v[156:157], v141 offset:24576
    ds_read_b64_tr_b16 v[158:159], v141 offset:25600
    s_waitcnt vmcnt(11)
    s_waitcnt lgkmcnt(4)
    v_mfma_f32_32x32x16_bf16 v[18:33], v[160:163], v[90:93], v[18:33]
    ds_read_b64_tr_b16 v[160:161], v141 offset:26624
    ds_read_b64_tr_b16 v[162:163], v141 offset:27648
    s_waitcnt vmcnt(10)
    s_waitcnt lgkmcnt(4)
    v_mfma_f32_32x32x16_bf16 v[18:33], v[152:155], v[94:97], v[18:33]
    ds_read_b64_tr_b16 v[152:153], v141 offset:28672
    ds_read_b64_tr_b16 v[154:155], v141 offset:29696
    s_waitcnt vmcnt(9)
    s_waitcnt lgkmcnt(4)
    v_mfma_f32_32x32x16_bf16 v[18:33], v[156:159], v[98:101], v[18:33]
    ds_read_b64_tr_b16 v[156:157], v141 offset:30720
    ds_read_b64_tr_b16 v[158:159], v141 offset:31744
    s_waitcnt vmcnt(8)
    s_waitcnt lgkmcnt(4)
    v_mfma_f32_32x32x16_bf16 v[18:33], v[160:163], v[102:105], v[18:33]
    ds_read_b64_tr_b16 v[160:161], v141 offset:32768
    ds_read_b64_tr_b16 v[162:163], v141 offset:33792
    s_waitcnt vmcnt(6)
    s_waitcnt lgkmcnt(4)
    v_mfma_f32_32x32x16_bf16 v[18:33], v[152:155], v[106:109], v[18:33]
    ds_read_b64_tr_b16 v[152:153], v141 offset:34816
    ds_read_b64_tr_b16 v[154:155], v141 offset:35840
    s_waitcnt vmcnt(5)
    s_waitcnt lgkmcnt(4)
    v_mfma_f32_32x32x16_bf16 v[18:33], v[156:159], v[110:113], v[18:33]
    ds_read_b64_tr_b16 v[156:157], v141 offset:36864
    ds_read_b64_tr_b16 v[158:159], v141 offset:37888
    s_waitcnt vmcnt(4)
    s_waitcnt lgkmcnt(4)
    v_mfma_f32_32x32x16_bf16 v[18:33], v[160:163], v[114:117], v[18:33]
    ds_read_b64_tr_b16 v[160:161], v141 offset:38912
    ds_read_b64_tr_b16 v[162:163], v141 offset:39936
    s_waitcnt vmcnt(3)
    s_waitcnt lgkmcnt(4)
    v_mfma_f32_32x32x16_bf16 v[18:33], v[152:155], v[118:121], v[18:33]
    ds_read_b64_tr_b16 v[152:153], v140 offset:20480
    ds_read_b64_tr_b16 v[154:155], v140 offset:21504
    s_waitcnt vmcnt(2)
    s_waitcnt lgkmcnt(4)
    v_mfma_f32_32x32x16_bf16 v[18:33], v[156:159], v[122:125], v[18:33]
    ds_read_b64_tr_b16 v[156:157], v140 offset:22528
    ds_read_b64_tr_b16 v[158:159], v140 offset:23552
    s_waitcnt vmcnt(0)
    s_waitcnt lgkmcnt(4)
    v_mfma_f32_32x32x16_bf16 v[18:33], v[160:163], v[126:129], v[18:33]
    ds_read_b64_tr_b16 v[160:161], v140 offset:24576
    ds_read_b64_tr_b16 v[162:163], v140 offset:25600
    s_waitcnt lgkmcnt(4)
    v_mfma_f32_32x32x16_bf16 v[2:17], v[152:155], v[90:93], v[2:17]
    ds_read_b64_tr_b16 v[152:153], v140 offset:26624
    ds_read_b64_tr_b16 v[154:155], v140 offset:27648
    s_waitcnt lgkmcnt(4)
    v_mfma_f32_32x32x16_bf16 v[2:17], v[156:159], v[94:97], v[2:17]
    ds_read_b64_tr_b16 v[156:157], v140 offset:28672
    ds_read_b64_tr_b16 v[158:159], v140 offset:29696
    s_waitcnt lgkmcnt(4)
    v_mfma_f32_32x32x16_bf16 v[2:17], v[160:163], v[98:101], v[2:17]
    ds_read_b64_tr_b16 v[160:161], v140 offset:30720
    ds_read_b64_tr_b16 v[162:163], v140 offset:31744
    ds_write_b128 v132, v[18:21] offset:0
    s_waitcnt lgkmcnt(5)
    v_mfma_f32_32x32x16_bf16 v[2:17], v[152:155], v[102:105], v[2:17]
    ds_read_b64_tr_b16 v[152:153], v140 offset:32768
    ds_read_b64_tr_b16 v[154:155], v140 offset:33792
    ds_write_b128 v132, v[22:25] offset:1024
    s_waitcnt lgkmcnt(6)
    v_mfma_f32_32x32x16_bf16 v[2:17], v[156:159], v[106:109], v[2:17]
    ds_read_b64_tr_b16 v[156:157], v140 offset:34816
    ds_read_b64_tr_b16 v[158:159], v140 offset:35840
    ds_write_b128 v132, v[26:29] offset:2048
    s_waitcnt lgkmcnt(7)
    v_mfma_f32_32x32x16_bf16 v[2:17], v[160:163], v[110:113], v[2:17]
    ds_read_b64_tr_b16 v[160:161], v140 offset:36864
    ds_read_b64_tr_b16 v[162:163], v140 offset:37888
    ds_write_b128 v132, v[30:33] offset:3072
    s_waitcnt lgkmcnt(7)
    v_mfma_f32_32x32x16_bf16 v[2:17], v[152:155], v[114:117], v[2:17]
    ds_read_b64_tr_b16 v[152:153], v140 offset:38912
    ds_read_b64_tr_b16 v[154:155], v140 offset:39936
    s_waitcnt lgkmcnt(6)
    v_mfma_f32_32x32x16_bf16 v[2:17], v[156:159], v[118:121], v[2:17]
    s_waitcnt lgkmcnt(2)
    s_barrier
    ds_read_b128 v[50:53], v133 offset:0
    ds_read_b128 v[54:57], v133 offset:1024
    ds_read_b128 v[58:61], v133 offset:2048
    ds_read_b128 v[62:65], v133 offset:3072
    s_nop 0
    v_mfma_f32_32x32x16_bf16 v[2:17], v[160:163], v[122:125], v[2:17]
    s_waitcnt lgkmcnt(4)
    v_mfma_f32_32x32x16_bf16 v[2:17], v[152:155], v[126:129], v[2:17]
    s_nop 10
    s_waitcnt lgkmcnt(2)
    v_pk_add_f32 v[2:3], v[2:3], v[50:51]
    v_pk_add_f32 v[4:5], v[4:5], v[52:53]
    v_pk_add_f32 v[6:7], v[6:7], v[54:55]
    v_pk_add_f32 v[8:9], v[8:9], v[56:57]
    v_cvt_pk_bf16_f32 v2, v2, v3
    v_cvt_pk_bf16_f32 v3, v4, v5
    v_cvt_pk_bf16_f32 v4, v6, v7
    v_cvt_pk_bf16_f32 v5, v8, v9
    s_waitcnt lgkmcnt(0)
    v_pk_add_f32 v[10:11], v[10:11], v[58:59]
    v_pk_add_f32 v[12:13], v[12:13], v[60:61]
    v_pk_add_f32 v[14:15], v[14:15], v[62:63]
    v_pk_add_f32 v[16:17], v[16:17], v[64:65]
    v_cvt_pk_bf16_f32 v10, v10, v11
    v_cvt_pk_bf16_f32 v11, v12, v13
    v_cvt_pk_bf16_f32 v12, v14, v15
    v_cvt_pk_bf16_f32 v13, v16, v17
    s_nop 1
    v_permlane16_swap_b32 v2, v10
    v_permlane16_swap_b32 v3, v11
    v_permlane16_swap_b32 v4, v12
    v_permlane16_swap_b32 v5, v13
    buffer_store_dwordx4 v[2:5], v142, s[48:51], s65 offen offset:0 sc1
    buffer_store_dwordx4 v[10:13], v142, s[48:51], s67 offen offset:0 sc1
    s_endpgm
L_hi2:
    ds_read_b64_tr_b16 v[152:153], v140 offset:0
    ds_read_b64_tr_b16 v[154:155], v140 offset:1024
    ds_read_b64_tr_b16 v[156:157], v141 offset:0
    ds_read_b64_tr_b16 v[158:159], v141 offset:1024
    ds_read_b64_tr_b16 v[160:161], v140 offset:2048
    ds_read_b64_tr_b16 v[162:163], v140 offset:3072
L_pahi2:
    s_waitcnt vmcnt(0)
    v_cmp_ne_u32 vcc, s33, v130
    s_nop 1
    s_and_b32 s34, vcc_lo, 0xffff
    s_cbranch_scc0 L_gahi2
    s_sub_u32 s36, s36, 1
    s_cbranch_scc1 L_gahi2
    buffer_load_dword v130, v1, s[24:27], s37 offen sc1
    s_branch L_pahi2
L_gahi2:
    buffer_load_dwordx4 v[50:53], v138, s[24:27], s52 offen offset:0 sc1
    buffer_load_dwordx4 v[54:57], v138, s[24:27], s52 offen offset:1024 sc1
    buffer_load_dwordx4 v[58:61], v138, s[24:27], s52 offen offset:2048 sc1
    buffer_load_dwordx4 v[62:65], v138, s[24:27], s52 offen offset:3072 sc1
    buffer_load_dwordx2 v[66:67], v139, s[24:27], s56 offen sc1
    buffer_load_dwordx2 v[68:69], v139, s[24:27], s56 offen offset:512 sc1
    buffer_load_dwordx4 v[70:73], v138, s[24:27], s53 offen offset:0 sc1
    buffer_load_dwordx4 v[74:77], v138, s[24:27], s53 offen offset:1024 sc1
    buffer_load_dwordx4 v[78:81], v138, s[24:27], s53 offen offset:2048 sc1
    s_waitcnt vmcnt(8)
    s_waitcnt lgkmcnt(4)
    v_mfma_f32_32x32x16_bf16 v[2:17], v[152:155], v[50:53], v[2:17]
    ds_read_b64_tr_b16 v[152:153], v141 offset:2048
    ds_read_b64_tr_b16 v[154:155], v141 offset:3072
    buffer_load_dwordx4 v[82:85], v138, s[24:27], s53 offen offset:3072 sc1
    s_waitcnt lgkmcnt(4)
    v_mfma_f32_32x32x16_bf16 v[18:33], v[156:159], v[50:53], v[18:33]
    ds_read_b64_tr_b16 v[156:157], v140 offset:4096
    ds_read_b64_tr_b16 v[158:159], v140 offset:5120
    buffer_load_dwordx2 v[86:87], v139, s[24:27], s57 offen sc1
    buffer_load_dwordx2 v[88:89], v139, s[24:27], s57 offen offset:512 sc1
    s_waitcnt vmcnt(10)
    s_waitcnt lgkmcnt(4)
    v_mfma_f32_32x32x16_bf16 v[2:17], v[160:163], v[54:57], v[2:17]
    ds_read_b64_tr_b16 v[160:161], v141 offset:4096
    ds_read_b64_tr_b16 v[162:163], v141 offset:5120
    buffer_load_dwordx4 v[90:93], v138, s[24:27], s54 offen offset:0 sc1
    s_waitcnt lgkmcnt(4)
    v_mfma_f32_32x32x16_bf16 v[18:33], v[152:155], v[54:57], v[18:33]
    ds_read_b64_tr_b16 v[152:153], v140 offset:6144
    ds_read_b64_tr_b16 v[154:155], v140 offset:7168
    buffer_load_dwordx4 v[94:97], v138, s[24:27], s54 offen offset:1024 sc1
    s_waitcnt vmcnt(11)
    s_waitcnt lgkmcnt(4)
    v_mfma_f32_32x32x16_bf16 v[2:17], v[156:159], v[58:61], v[2:17]
    ds_read_b64_tr_b16 v[156:157], v141 offset:6144
    ds_read_b64_tr_b16 v[158:159], v141 offset:7168
    buffer_load_dwordx4 v[98:101], v138, s[24:27], s54 offen offset:2048 sc1
    s_waitcnt lgkmcnt(4)
    v_mfma_f32_32x32x16_bf16 v[18:33], v[160:163], v[58:61], v[18:33]
    ds_read_b64_tr_b16 v[160:161], v140 offset:8192
    ds_read_b64_tr_b16 v[162:163], v140 offset:9216
    buffer_load_dwordx4 v[102:105], v138, s[24:27], s54 offen offset:3072 sc1
    s_waitcnt vmcnt(12)
    s_waitcnt lgkmcnt(4)
    v_mfma_f32_32x32x16_bf16 v[2:17], v[152:155], v[62:65], v[2:17]
    ds_read_b64_tr_b16 v[152:153], v141 offset:8192
    ds_read_b64_tr_b16 v[154:155], v141 offset:9216
    buffer_load_dwordx2 v[106:107], v139, s[24:27], s58 offen sc1
    buffer_load_dwordx2 v[108:109], v139, s[24:27], s58 offen offset:512 sc1
    s_waitcnt lgkmcnt(4)
    v_mfma_f32_32x32x16_bf16 v[18:33], v[156:159], v[62:65], v[18:33]
    ds_read_b64_tr_b16 v[156:157], v140 offset:10240
    ds_read_b64_tr_b16 v[158:159], v140 offset:11264
    buffer_load_dwordx4 v[110:113], v138, s[24:27], s55 offen offset:0 sc1
    s_waitcnt vmcnt(13)
    s_waitcnt lgkmcnt(4)
    v_mfma_f32_32x32x16_bf16 v[2:17], v[160:163], v[66:69], v[2:17]
    ds_read_b64_tr_b16 v[160:161], v141 offset:10240
    ds_read_b64_tr_b16 v[162:163], v141 offset:11264
    buffer_load_dwordx4 v[114:117], v138, s[24:27], s55 offen offset:1024 sc1
    s_waitcnt lgkmcnt(4)
    v_mfma_f32_32x32x16_bf16 v[18:33], v[152:155], v[66:69], v[18:33]
    ds_read_b64_tr_b16 v[152:153], v140 offset:12288
    ds_read_b64_tr_b16 v[154:155], v140 offset:13312
    buffer_load_dwordx4 v[118:121], v138, s[24:27], s55 offen offset:2048 sc1
    s_waitcnt vmcnt(14)
    s_waitcnt lgkmcnt(4)
    v_mfma_f32_32x32x16_bf16 v[2:17], v[156:159], v[70:73], v[2:17]
    ds_read_b64_tr_b16 v[156:157], v141 offset:12288
    ds_read_b64_tr_b16 v[158:159], v141 offset:13312
    buffer_load_dwordx4 v[122:125], v138, s[24:27], s55 offen offset:3072 sc1
    s_waitcnt lgkmcnt(4)
    v_mfma_f32_32x32x16_bf16 v[18:33], v[160:163], v[70:73], v[18:33]
    ds_read_b64_tr_b16 v[160:161], v140 offset:14336
    ds_read_b64_tr_b16 v[162:163], v140 offset:15360
    buffer_load_dwordx2 v[126:127], v139, s[24:27], s59 offen sc1
    buffer_load_dwordx2 v[128:129], v139, s[24:27], s59 offen offset:512 sc1
    s_waitcnt vmcnt(16)
    s_waitcnt lgkmcnt(4)
    v_mfma_f32_32x32x16_bf16 v[2:17], v[152:155], v[74:77], v[2:17]
    ds_read_b64_tr_b16 v[152:153], v141 offset:14336
    ds_read_b64_tr_b16 v[154:155], v141 offset:15360
    s_waitcnt lgkmcnt(4)
    v_mfma_f32_32x32x16_bf16 v[18:33], v[156:159], v[74:77], v[18:33]
    ds_read_b64_tr_b16 v[156:157], v140 offset:16384
    ds_read_b64_tr_b16 v[158:159], v140 offset:17408
    s_waitcnt vmcnt(15)
    s_waitcnt lgkmcnt(4)
    v_mfma_f32_32x32x16_bf16 v[2:17], v[160:163], v[78:81], v[2:17]
    ds_read_b64_tr_b16 v[160:161], v141 offset:16384
    ds_read_b64_tr_b16 v[162:163], v141 offset:17408
    s_waitcnt lgkmcnt(4)
    v_mfma_f32_32x32x16_bf16 v[18:33], v[152:155], v[78:81], v[18:33]
    ds_read_b64_tr_b16 v[152:153], v140 offset:18432
    ds_read_b64_tr_b16 v[154:155], v140 offset:19456
    s_waitcnt vmcnt(14)
    s_waitcnt lgkmcnt(4)
    v_mfma_f32_32x32x16_bf16 v[2:17], v[156:159], v[82:85], v[2:17]
    ds_read_b64_tr_b16 v[156:157], v141 offset:18432
    ds_read_b64_tr_b16 v[158:159], v141 offset:19456
    s_waitcnt lgkmcnt(4)
    v_mfma_f32_32x32x16_bf16 v[18:33], v[160:163], v[82:85], v[18:33]
    ds_read_b64_tr_b16 v[160:161], v140 offset:20480
    ds_read_b64_tr_b16 v[162:163], v140 offset:21504
    s_waitcnt vmcnt(12)
    s_waitcnt lgkmcnt(4)
    v_mfma_f32_32x32x16_bf16 v[2:17], v[152:155], v[86:89], v[2:17]
    ds_read_b64_tr_b16 v[152:153], v140 offset:22528
    ds_read_b64_tr_b16 v[154:155], v140 offset:23552
    s_waitcnt lgkmcnt(4)
    v_mfma_f32_32x32x16_bf16 v[18:33], v[156:159], v[86:89], v[18:33]
    ds_read_b64_tr_b16 v[156:157], v140 offset:24576
    ds_read_b64_tr_b16 v[158:159], v140 offset:25600
    s_waitcnt vmcnt(11)
    s_waitcnt lgkmcnt(4)
    v_mfma_f32_32x32x16_bf16 v[2:17], v[160:163], v[90:93], v[2:17]
    ds_read_b64_tr_b16 v[160:161], v140 offset:26624
    ds_read_b64_tr_b16 v[162:163], v140 offset:27648
    s_waitcnt vmcnt(10)
    s_waitcnt lgkmcnt(4)
    v_mfma_f32_32x32x16_bf16 v[2:17], v[152:155], v[94:97], v[2:17]
    ds_read_b64_tr_b16 v[152:153], v140 offset:28672
    ds_read_b64_tr_b16 v[154:155], v140 offset:29696
    s_waitcnt vmcnt(9)
    s_waitcnt lgkmcnt(4)
    v_mfma_f32_32x32x16_bf16 v[2:17], v[156:159], v[98:101], v[2:17]
    ds_read_b64_tr_b16 v[156:157], v140 offset:30720
    ds_read_b64_tr_b16 v[158:159], v140 offset:31744
    s_waitcnt vmcnt(8)
    s_waitcnt lgkmcnt(4)
    v_mfma_f32_32x32x16_bf16 v[2:17], v[160:163], v[102:105], v[2:17]
    ds_read_b64_tr_b16 v[160:161], v140 offset:32768
    ds_read_b64_tr_b16 v[162:163], v140 offset:33792
    s_waitcnt vmcnt(6)
    s_waitcnt lgkmcnt(4)
    v_mfma_f32_32x32x16_bf16 v[2:17], v[152:155], v[106:109], v[2:17]
    ds_read_b64_tr_b16 v[152:153], v140 offset:34816
    ds_read_b64_tr_b16 v[154:155], v140 offset:35840
    s_waitcnt vmcnt(5)
    s_waitcnt lgkmcnt(4)
    v_mfma_f32_32x32x16_bf16 v[2:17], v[156:159], v[110:113], v[2:17]
    ds_read_b64_tr_b16 v[156:157], v140 offset:36864
    ds_read_b64_tr_b16 v[158:159], v140 offset:37888
    s_waitcnt vmcnt(4)
    s_waitcnt lgkmcnt(4)
    v_mfma_f32_32x32x16_bf16 v[2:17], v[160:163], v[114:117], v[2:17]
    ds_read_b64_tr_b16 v[160:161], v140 offset:38912
    ds_read_b64_tr_b16 v[162:163], v140 offset:39936
    s_waitcnt vmcnt(3)
    s_waitcnt lgkmcnt(4)
    v_mfma_f32_32x32x16_bf16 v[2:17], v[152:155], v[118:121], v[2:17]
    ds_read_b64_tr_b16 v[152:153], v141 offset:20480
    ds_read_b64_tr_b16 v[154:155], v141 offset:21504
    s_waitcnt vmcnt(2)
    s_waitcnt lgkmcnt(4)
    v_mfma_f32_32x32x16_bf16 v[2:17], v[156:159], v[122:125], v[2:17]
    ds_read_b64_tr_b16 v[156:157], v141 offset:22528
    ds_read_b64_tr_b16 v[158:159], v141 offset:23552
    s_waitcnt vmcnt(0)
    s_waitcnt lgkmcnt(4)
    v_mfma_f32_32x32x16_bf16 v[2:17], v[160:163], v[126:129], v[2:17]
    ds_read_b64_tr_b16 v[160:161], v141 offset:24576
    ds_read_b64_tr_b16 v[162:163], v141 offset:25600
    s_waitcnt lgkmcnt(4)
    v_mfma_f32_32x32x16_bf16 v[18:33], v[152:155], v[90:93], v[18:33]
    ds_read_b64_tr_b16 v[152:153], v141 offset:26624
    ds_read_b64_tr_b16 v[154:155], v141 offset:27648
    s_waitcnt lgkmcnt(4)
    v_mfma_f32_32x32x16_bf16 v[18:33], v[156:159], v[94:97], v[18:33]
    ds_read_b64_tr_b16 v[156:157], v141 offset:28672
    ds_read_b64_tr_b16 v[158:159], v141 offset:29696
    s_waitcnt lgkmcnt(4)
    v_mfma_f32_32x32x16_bf16 v[18:33], v[160:163], v[98:101], v[18:33]
    ds_read_b64_tr_b16 v[160:161], v141 offset:30720
    ds_read_b64_tr_b16 v[162:163], v141 offset:31744
    ds_write_b128 v132, v[2:5] offset:0
    s_waitcnt lgkmcnt(5)
    v_mfma_f32_32x32x16_bf16 v[18:33], v[152:155], v[102:105], v[18:33]
    ds_read_b64_tr_b16 v[152:153], v141 offset:32768
    ds_read_b64_tr_b16 v[154:155], v141 offset:33792
    ds_write_b128 v132, v[6:9] offset:1024
    s_waitcnt lgkmcnt(6)
    v_mfma_f32_32x32x16_bf16 v[18:33], v[156:159], v[106:109], v[18:33]
    ds_read_b64_tr_b16 v[156:157], v141 offset:34816
    ds_read_b64_tr_b16 v[158:159], v141 offset:35840
    ds_write_b128 v132, v[10:13] offset:2048
    s_waitcnt lgkmcnt(7)
    v_mfma_f32_32x32x16_bf16 v[18:33], v[160:163], v[110:113], v[18:33]
    ds_read_b64_tr_b16 v[160:161], v141 offset:36864
    ds_read_b64_tr_b16 v[162:163], v141 offset:37888
    ds_write_b128 v132, v[14:17] offset:3072
    s_waitcnt lgkmcnt(7)
    v_mfma_f32_32x32x16_bf16 v[18:33], v[152:155], v[114:117], v[18:33]
    ds_read_b64_tr_b16 v[152:153], v141 offset:38912
    ds_read_b64_tr_b16 v[154:155], v141 offset:39936
    s_waitcnt lgkmcnt(6)
    v_mfma_f32_32x32x16_bf16 v[18:33], v[156:159], v[118:121], v[18:33]
    s_waitcnt lgkmcnt(2)
    s_barrier
    ds_read_b128 v[50:53], v133 offset:0
    ds_read_b128 v[54:57], v133 offset:1024
    ds_read_b128 v[58:61], v133 offset:2048
    ds_read_b128 v[62:65], v133 offset:3072
    s_nop 0
    v_mfma_f32_32x32x16_bf16 v[18:33], v[160:163], v[122:125], v[18:33]
    s_waitcnt lgkmcnt(4)
    v_mfma_f32_32x32x16_bf16 v[18:33], v[152:155], v[126:129], v[18:33]
    s_nop 10
    s_waitcnt lgkmcnt(2)
    v_pk_add_f32 v[18:19], v[18:19], v[50:51]
    v_pk_add_f32 v[20:21], v[20:21], v[52:53]
    v_pk_add_f32 v[22:23], v[22:23], v[54:55]
    v_pk_add_f32 v[24:25], v[24:25], v[56:57]
    v_cvt_pk_bf16_f32 v18, v18, v19
    v_cvt_pk_bf16_f32 v19, v20, v21
    v_cvt_pk_bf16_f32 v20, v22, v23
    v_cvt_pk_bf16_f32 v21, v24, v25
    s_waitcnt lgkmcnt(0)
    v_pk_add_f32 v[26:27], v[26:27], v[58:59]
    v_pk_add_f32 v[28:29], v[28:29], v[60:61]
    v_pk_add_f32 v[30:31], v[30:31], v[62:63]
    v_pk_add_f32 v[32:33], v[32:33], v[64:65]
    v_cvt_pk_bf16_f32 v26, v26, v27
    v_cvt_pk_bf16_f32 v27, v28, v29
    v_cvt_pk_bf16_f32 v28, v30, v31
    v_cvt_pk_bf16_f32 v29, v32, v33
    s_nop 1
    v_permlane16_swap_b32 v18, v26
    v_permlane16_swap_b32 v19, v27
    v_permlane16_swap_b32 v20, v28
    v_permlane16_swap_b32 v21, v29
    buffer_store_dwordx4 v[18:21], v142, s[48:51], s65 offen offset:64 sc1
    buffer_store_dwordx4 v[26:29], v142, s[48:51], s67 offen offset:64 sc1
    s_endpgm
L_done:
    s_endpgm
.section .rodata,"a"
.p2align 6
.amdhsa_kernel parallel_sum__softmax_full_mha__dense_activation_squared_relu__prompt_kernel
  .amdhsa_next_free_vgpr 168
  .amdhsa_next_free_sgpr 70
  .amdhsa_accum_offset 168
  .amdhsa_group_segment_fixed_size 0
  .amdhsa_kernarg_size 88
  .amdhsa_user_sgpr_count 2
  .amdhsa_user_sgpr_kernarg_segment_ptr 1
  .amdhsa_system_sgpr_workgroup_id_x 1
.end_amdhsa_kernel
```
